```python
import torch

def _softmax(x, axis=-1):
    return torch.softmax(x, dim=axis)
def _gelu(x):
    return torch.nn.functional.gelu(x, approximate="tanh")
def _silu(x):
    return torch.nn.functional.silu(x)
def _sigmoid(x):
    return torch.sigmoid(x)
def _layernorm(x, axis=-1, eps=1e-5):
    m = x.mean(dim=axis, keepdim=True)
    v = x.var(dim=axis, keepdim=True, unbiased=False)
    return (x - m) / torch.sqrt(v + eps)
def _scatter_add(tgt, idx, src, axis=0):
    return tgt.clone().index_add_(axis, idx, src)
def _segment_sum(src, seg, n):
    out = torch.zeros((n,) + src.shape[1:], dtype=src.dtype)
    return out.index_add_(0, seg, src)
def _pad(x, pw):
    flat = tuple(v for pair in reversed(pw) for v in pair)
    return torch.nn.functional.pad(x, flat)

kernel_name = 'gated_mix__ssm_conv_s4__linear_attn_block__prompt'

def setup_inputs():

    _w = (lambda a: (lambda t: t.to(torch.bfloat16) if t.is_floating_point() else t)(torch.as_tensor(a)))
    def _A_setup():
        B, L, D, N = 1, 2048, 1024, 128
        A_re = -(lambda _x: torch.exp(torch.as_tensor(_x)))((lambda *s: torch.randn(*s, dtype=torch.bfloat16) * 3.2)(D, N))
        A_im = torch.pi * (lambda *s: torch.randn(*s, dtype=torch.bfloat16) * 0.05)(D, N)
        B_re = (lambda *s: torch.randn(*s, dtype=torch.bfloat16) * 0.2)(D, N)
        B_im = (lambda *s: torch.randn(*s, dtype=torch.bfloat16) * 0.2)(D, N)
        C_re = (lambda *s: torch.randn(*s, dtype=torch.bfloat16) * 0.2)(D, N)
        C_im = (lambda *s: torch.randn(*s, dtype=torch.bfloat16) * 0.2)(D, N)
        log_dt = (lambda *s: torch.randn(*s, dtype=torch.bfloat16) * 0.05)(D) * 0.5 - 4.0
        Dskip = (lambda *s: torch.randn(*s, dtype=torch.bfloat16) * 0.1)(D)
        return {
            "u": _w((lambda *s: torch.randn(*s, dtype=torch.bfloat16) * 0.05)(B, L, D)),
            "A_re": _w(A_re),
            "A_im": _w(A_im),
            "B_re": _w(B_re),
            "B_im": _w(B_im),
            "C_re": _w(C_re),
            "C_im": _w(C_im),
            "log_dt": _w(log_dt),
            "Dskip": _w(Dskip),
        }
    _A_in = _A_setup()

    def _B_setup():
        B, S, D = 1, 2048, 1024
        return {
            "x": _w((lambda *s: torch.randn(*s, dtype=torch.bfloat16) * 0.05)(B, S, D)),
            "wqkv": _w((lambda *s: torch.randn(*s, dtype=torch.bfloat16) * 0.8)(D, 3 * D)),
            "wo": _w((lambda *s: torch.randn(*s, dtype=torch.bfloat16) * 0.05)(D, D)),
        }
    _B_in = _B_setup()

    return {
        "A_u": _A_in["u"],
        "A_A_re": _A_in["A_re"],
        "A_A_im": _A_in["A_im"],
        "A_B_re": _A_in["B_re"],
        "A_B_im": _A_in["B_im"],
        "A_C_re": _A_in["C_re"],
        "A_C_im": _A_in["C_im"],
        "A_log_dt": _A_in["log_dt"],
        "A_Dskip": _A_in["Dskip"],
        "B_x": _B_in["x"],
        "B_wqkv": _B_in["wqkv"],
        "B_wo": _B_in["wo"],
        "gate_w": _w((lambda *s: torch.randn(*s, dtype=torch.bfloat16) * 0.05)(1024) * 16.0),
    }

def reference(A_u, A_A_re, A_A_im, A_B_re, A_B_im, A_C_re, A_C_im, A_log_dt, A_Dskip, B_x, B_wqkv, B_wo, gate_w):
    def _A_ref(u, A_re, A_im, B_re, B_im, C_re, C_im, log_dt, Dskip):
        Bsz, L, D = u.shape
        dt = torch.exp(log_dt)[:, None]
        A = A_re + 1j * A_im
        Bc = B_re + 1j * B_im
        Cc = C_re + 1j * C_im
        logdA = dt * A
        dB = dt * Bc
        l = (lambda x, dt: x.to(dt))(torch.arange(L), A_re.dtype)
        P = torch.exp(logdA[:, :, None] * l[None, None, :])
        K = torch.einsum("dn,dnl,dn->dl", Cc, P, dB).real
        L2 = 2 * L
        Kp = _pad(K, ((0, 0), (0, L)))
        up = (lambda x, *d: x.permute(*d))(u, 0, 2, 1)
        up = _pad(up, ((0, 0), (0, 0), (0, L)))
        Kf = (lambda x, axes=(-2,-1): torch.fft.rfft2(x.float(), dim=axes))(Kp[:, None, :], axes=(-2, -1))
        Uf = (lambda x, axes=(-2,-1): torch.fft.rfft2(x.float(), dim=axes))(up[:, :, None, :], axes=(-2, -1))
        Yf = Uf * Kf[None, :, :, :]
        y = (lambda x, s, axes=(-2,-1): torch.fft.irfft2(x, s=s, dim=axes).to(torch.bfloat16))(Yf, (1, L2), axes=(-2, -1))[:, :, 0, :L]
        y = (lambda x, *d: x.permute(*d))(y, 0, 2, 1) + u * Dskip[None, None, :]
        return y

    def _B_ref(x, wqkv, wo):
        B, S, D = x.shape
        H = 32; Dh = D // H
        qkv = (lambda x, *d: x.permute(*d))((x @ wqkv).reshape(B, S, 3, H, Dh), 2, 0, 3, 1, 4)
        q, k, v = qkv[0], qkv[1], qkv[2]
        phi = lambda t: torch.where(t > 0, t + 1, torch.exp(t)) + 1e-6
        pq, pk = phi(q), phi(k)
        kv = torch.einsum("bhsd,bhse->bhde", pk, v)
        z = torch.einsum("bhsd->bhd", pk)
        num = torch.einsum("bhqd,bhde->bhqe", pq, kv)
        den = torch.einsum("bhqd,bhd->bhq", pq, z)[..., None] + 1e-6
        o = num / den
        return (lambda x, *d: x.permute(*d))(o, 0, 2, 1, 3).reshape(B, S, D) @ wo

    x = A_u
    g = _sigmoid((x * gate_w).sum(-1, keepdims=True))
    a = _A_ref(x, A_A_re, A_A_im, A_B_re, A_B_im, A_C_re, A_C_im, A_log_dt, A_Dskip)
    b = _B_ref(x, B_wqkv, B_wo)
    return g * a + (1 - g) * b
```

```asm
; @launch kernel=k1_kernel grid=(512,1,1) block=(256,1,1) lds=69632
; @launch kernel=k2_kernel grid=(256,1,1) block=(256,1,1) lds=163840
; @launch kernel=k3_kernel grid=(256,1,1) block=(256,1,1) lds=12288
.amdgcn_target "amdgcn-amd-amdhsa--gfx950"
.text
.globl k1_kernel
.p2align 8
.type k1_kernel,@function
k1_kernel:
s_cmp_ge_u32 s2, 512
s_cbranch_scc1 K1_END
s_load_dwordx16 s[24:39], s[0:1], 0
s_load_dwordx2 s[40:41], s[0:1], 80
s_load_dwordx2 s[42:43], s[0:1], 120
s_mov_b32 s60, 0x7fff
v_and_b32 v1, 63, v0
v_lshrrev_b32 v2, 6, v0
s_nop 0
v_readfirstlane_b32 s20, v2
s_waitcnt lgkmcnt(0)
s_mov_b32 s16, s42
s_and_b32 s17, s43, 0xffff
s_mov_b32 s18, 20971520
s_mov_b32 s19, 0x20000
s_cmp_ge_u32 s2, 256
s_cbranch_scc1 K1_KGEN
s_mov_b32 s8, s24
s_and_b32 s9, s25, 0xffff
s_mov_b32 s10, 4194304
s_mov_b32 s11, 0x20000
s_mov_b32 s12, s40
s_and_b32 s13, s41, 0xffff
s_mov_b32 s14, 6291456
s_mov_b32 s15, 0x20000
s_and_b32 s21, s2, 7
s_lshl_b32 s21, s21, 2
s_bfe_u32 s22, s2, 0x20003
s_add_u32 s21, s21, s22
s_lshr_b32 s22, s2, 5
s_lshl_b32 s23, s20, 8
s_add_u32 s23, s23, 0
v_add_u32 v3, s23, v1
v_lshrrev_b32 v8, 2, v3
v_lshrrev_b32 v9, 4, v3
v_xor_b32 v9, v9, v3
v_and_b32 v9, 3, v9
s_lshl_b32 s23, s22, 8
v_add_u32 v8, s23, v8
v_lshlrev_b32 v8, 11, v8
v_lshl_add_u32 v4, v9, 4, v8
s_lshl_b32 s23, s20, 8
s_add_u32 s23, s23, 64
v_add_u32 v3, s23, v1
v_lshrrev_b32 v8, 2, v3
v_lshrrev_b32 v9, 4, v3
v_xor_b32 v9, v9, v3
v_and_b32 v9, 3, v9
s_lshl_b32 s23, s22, 8
v_add_u32 v8, s23, v8
v_lshlrev_b32 v8, 11, v8
v_lshl_add_u32 v5, v9, 4, v8
s_lshl_b32 s23, s20, 8
s_add_u32 s23, s23, 128
v_add_u32 v3, s23, v1
v_lshrrev_b32 v8, 2, v3
v_lshrrev_b32 v9, 4, v3
v_xor_b32 v9, v9, v3
v_and_b32 v9, 3, v9
s_lshl_b32 s23, s22, 8
v_add_u32 v8, s23, v8
v_lshlrev_b32 v8, 11, v8
v_lshl_add_u32 v6, v9, 4, v8
s_lshl_b32 s23, s20, 8
s_add_u32 s23, s23, 192
v_add_u32 v3, s23, v1
v_lshrrev_b32 v8, 2, v3
v_lshrrev_b32 v9, 4, v3
v_xor_b32 v9, v9, v3
v_and_b32 v9, 3, v9
s_lshl_b32 s23, s22, 8
v_add_u32 v8, s23, v8
v_lshlrev_b32 v8, 11, v8
v_lshl_add_u32 v7, v9, 4, v8
s_cmp_eq_u32 s20, 3
s_cselect_b32 s23, 0, s20
s_lshl_b32 s44, s23, 11
s_lshl_b32 s45, s21, 6
s_add_u32 s44, s44, s45
v_add_u32 v3, 0, v1
v_lshrrev_b32 v8, 2, v3
v_and_b32 v9, 3, v3
v_mul_u32_u24 v8, 6144, v8
v_lshl_add_u32 v10, v9, 4, v8
v_add_u32 v10, s44, v10
v_add_u32 v3, 64, v1
v_lshrrev_b32 v8, 2, v3
v_and_b32 v9, 3, v3
v_mul_u32_u24 v8, 6144, v8
v_lshl_add_u32 v11, v9, 4, v8
v_add_u32 v11, s44, v11
s_lshl_b32 s46, s20, 12
s_lshl_b32 s47, s23, 11
s_add_u32 s47, s47, 16384
v_and_b32 v3, 31, v1
v_lshrrev_b32 v8, 5, v1
s_lshl_b32 s23, s20, 6
v_add_u32 v3, s23, v3
v_bfe_u32 v9, v3, 2, 2
v_xor_b32 v9, v9, v8
v_lshlrev_b32 v3, 6, v3
v_lshl_add_u32 v12, v9, 4, v3
v_xor_b32 v13, 32, v12
v_lshrrev_b32 v3, 5, v1
v_lshlrev_b32 v3, 3, v3
v_bfe_u32 v8, v1, 2, 2
v_add_u32 v3, v3, v8
v_bfe_u32 v8, v1, 4, 1
v_lshlrev_b32 v8, 5, v8
v_and_b32 v9, 3, v1
v_lshl_add_u32 v8, v9, 3, v8
v_lshl_add_u32 v14, v3, 6, v8
v_add_u32 v14, 16384, v14
v_mov_b32 v64, 0
v_mov_b32 v65, 0
v_mov_b32 v66, 0
v_mov_b32 v67, 0
v_mov_b32 v68, 0
v_mov_b32 v69, 0
v_mov_b32 v70, 0
v_mov_b32 v71, 0
v_mov_b32 v72, 0
v_mov_b32 v73, 0
v_mov_b32 v74, 0
v_mov_b32 v75, 0
v_mov_b32 v76, 0
v_mov_b32 v77, 0
v_mov_b32 v78, 0
v_mov_b32 v79, 0
v_mov_b32 v80, 0
v_mov_b32 v81, 0
v_mov_b32 v82, 0
v_mov_b32 v83, 0
v_mov_b32 v84, 0
v_mov_b32 v85, 0
v_mov_b32 v86, 0
v_mov_b32 v87, 0
v_mov_b32 v88, 0
v_mov_b32 v89, 0
v_mov_b32 v90, 0
v_mov_b32 v91, 0
v_mov_b32 v92, 0
v_mov_b32 v93, 0
v_mov_b32 v94, 0
v_mov_b32 v95, 0
v_mov_b32 v96, 0
v_mov_b32 v97, 0
v_mov_b32 v98, 0
v_mov_b32 v99, 0
v_mov_b32 v100, 0
v_mov_b32 v101, 0
v_mov_b32 v102, 0
v_mov_b32 v103, 0
v_mov_b32 v104, 0
v_mov_b32 v105, 0
v_mov_b32 v106, 0
v_mov_b32 v107, 0
v_mov_b32 v108, 0
v_mov_b32 v109, 0
v_mov_b32 v110, 0
v_mov_b32 v111, 0
v_mov_b32 v112, 0
v_mov_b32 v113, 0
v_mov_b32 v114, 0
v_mov_b32 v115, 0
v_mov_b32 v116, 0
v_mov_b32 v117, 0
v_mov_b32 v118, 0
v_mov_b32 v119, 0
v_mov_b32 v120, 0
v_mov_b32 v121, 0
v_mov_b32 v122, 0
v_mov_b32 v123, 0
v_mov_b32 v124, 0
v_mov_b32 v125, 0
v_mov_b32 v126, 0
v_mov_b32 v127, 0
v_mov_b32 v128, 0
v_mov_b32 v129, 0
v_mov_b32 v130, 0
v_mov_b32 v131, 0
v_mov_b32 v132, 0
v_mov_b32 v133, 0
v_mov_b32 v134, 0
v_mov_b32 v135, 0
v_mov_b32 v136, 0
v_mov_b32 v137, 0
v_mov_b32 v138, 0
v_mov_b32 v139, 0
v_mov_b32 v140, 0
v_mov_b32 v141, 0
v_mov_b32 v142, 0
v_mov_b32 v143, 0
v_mov_b32 v144, 0
v_mov_b32 v145, 0
v_mov_b32 v146, 0
v_mov_b32 v147, 0
v_mov_b32 v148, 0
v_mov_b32 v149, 0
v_mov_b32 v150, 0
v_mov_b32 v151, 0
v_mov_b32 v152, 0
v_mov_b32 v153, 0
v_mov_b32 v154, 0
v_mov_b32 v155, 0
v_mov_b32 v156, 0
v_mov_b32 v157, 0
v_mov_b32 v158, 0
v_mov_b32 v159, 0
s_mov_b32 s50, 0
s_mov_b32 s51, 0
s_add_u32 s48, s50, s46
s_add_u32 m0, s48, 0
s_nop 0
buffer_load_dwordx4 v4, s[8:11], s51 offen lds
s_add_u32 s48, s50, s46
s_add_u32 m0, s48, 1024
s_nop 0
buffer_load_dwordx4 v5, s[8:11], s51 offen lds
s_add_u32 s48, s50, s46
s_add_u32 m0, s48, 2048
s_nop 0
buffer_load_dwordx4 v6, s[8:11], s51 offen lds
s_add_u32 s48, s50, s46
s_add_u32 m0, s48, 3072
s_nop 0
buffer_load_dwordx4 v7, s[8:11], s51 offen lds
s_add_u32 s48, s50, s47
s_cmp_eq_u32 s20, 3
s_cselect_b32 s48, 67584, s48
s_mul_i32 s49, s51, 3072
s_add_u32 m0, s48, 0
s_nop 0
buffer_load_dwordx4 v10, s[12:15], s49 offen lds
s_add_u32 m0, s48, 1024
s_nop 0
buffer_load_dwordx4 v11, s[12:15], s49 offen lds
s_mov_b32 s50, 22528
s_mov_b32 s51, 64
s_add_u32 s48, s50, s46
s_add_u32 m0, s48, 0
s_nop 0
buffer_load_dwordx4 v4, s[8:11], s51 offen lds
s_add_u32 s48, s50, s46
s_add_u32 m0, s48, 1024
s_nop 0
buffer_load_dwordx4 v5, s[8:11], s51 offen lds
s_add_u32 s48, s50, s46
s_add_u32 m0, s48, 2048
s_nop 0
buffer_load_dwordx4 v6, s[8:11], s51 offen lds
s_add_u32 s48, s50, s46
s_add_u32 m0, s48, 3072
s_nop 0
buffer_load_dwordx4 v7, s[8:11], s51 offen lds
s_add_u32 s48, s50, s47
s_cmp_eq_u32 s20, 3
s_cselect_b32 s48, 67584, s48
s_mul_i32 s49, s51, 3072
s_add_u32 m0, s48, 0
s_nop 0
buffer_load_dwordx4 v10, s[12:15], s49 offen lds
s_add_u32 m0, s48, 1024
s_nop 0
buffer_load_dwordx4 v11, s[12:15], s49 offen lds
s_mov_b32 s52, 0
s_mov_b32 s53, 0
s_mov_b32 s50, 45056
K1_LOOP:
s_waitcnt vmcnt(6)
s_barrier
s_add_u32 s51, s52, 2
s_min_u32 s51, s51, 31
s_lshl_b32 s51, s51, 6
s_cmp_lg_u32 s52, s21
s_cbranch_scc1 K1_NOXT
v_lshlrev_b32 v15, 6, v0
v_add_u32 v15, s53, v15
v_bfe_u32 v16, v0, 2, 2
s_lshl_b32 s48, s21, 17
s_lshl_b32 s49, s22, 9
s_add_u32 s48, s48, s49
s_add_u32 s48, s48, 16777216
v_lshl_add_u32 v17, v0, 1, s48
v_xor_b32 v18, 0, v16
v_lshl_add_u32 v18, v18, 4, v15
ds_read_b128 v[20:23], v18
s_waitcnt lgkmcnt(0)
s_mov_b32 s49, 0
buffer_store_short v20, v17, s[16:19], s49 offen
s_mov_b32 s49, 4096
buffer_store_short_d16_hi v20, v17, s[16:19], s49 offen
s_mov_b32 s49, 8192
buffer_store_short v21, v17, s[16:19], s49 offen
s_mov_b32 s49, 12288
buffer_store_short_d16_hi v21, v17, s[16:19], s49 offen
s_mov_b32 s49, 16384
buffer_store_short v22, v17, s[16:19], s49 offen
s_mov_b32 s49, 20480
buffer_store_short_d16_hi v22, v17, s[16:19], s49 offen
s_mov_b32 s49, 24576
buffer_store_short v23, v17, s[16:19], s49 offen
s_mov_b32 s49, 28672
buffer_store_short_d16_hi v23, v17, s[16:19], s49 offen
v_xor_b32 v18, 1, v16
v_lshl_add_u32 v18, v18, 4, v15
ds_read_b128 v[20:23], v18
s_waitcnt lgkmcnt(0)
s_mov_b32 s49, 32768
buffer_store_short v20, v17, s[16:19], s49 offen
s_mov_b32 s49, 36864
buffer_store_short_d16_hi v20, v17, s[16:19], s49 offen
s_mov_b32 s49, 40960
buffer_store_short v21, v17, s[16:19], s49 offen
s_mov_b32 s49, 45056
buffer_store_short_d16_hi v21, v17, s[16:19], s49 offen
s_mov_b32 s49, 49152
buffer_store_short v22, v17, s[16:19], s49 offen
s_mov_b32 s49, 53248
buffer_store_short_d16_hi v22, v17, s[16:19], s49 offen
s_mov_b32 s49, 57344
buffer_store_short v23, v17, s[16:19], s49 offen
s_mov_b32 s49, 61440
buffer_store_short_d16_hi v23, v17, s[16:19], s49 offen
v_xor_b32 v18, 2, v16
v_lshl_add_u32 v18, v18, 4, v15
ds_read_b128 v[20:23], v18
s_waitcnt lgkmcnt(0)
s_mov_b32 s49, 65536
buffer_store_short v20, v17, s[16:19], s49 offen
s_mov_b32 s49, 69632
buffer_store_short_d16_hi v20, v17, s[16:19], s49 offen
s_mov_b32 s49, 73728
buffer_store_short v21, v17, s[16:19], s49 offen
s_mov_b32 s49, 77824
buffer_store_short_d16_hi v21, v17, s[16:19], s49 offen
s_mov_b32 s49, 81920
buffer_store_short v22, v17, s[16:19], s49 offen
s_mov_b32 s49, 86016
buffer_store_short_d16_hi v22, v17, s[16:19], s49 offen
s_mov_b32 s49, 90112
buffer_store_short v23, v17, s[16:19], s49 offen
s_mov_b32 s49, 94208
buffer_store_short_d16_hi v23, v17, s[16:19], s49 offen
v_xor_b32 v18, 3, v16
v_lshl_add_u32 v18, v18, 4, v15
ds_read_b128 v[20:23], v18
s_waitcnt lgkmcnt(0)
s_mov_b32 s49, 98304
buffer_store_short v20, v17, s[16:19], s49 offen
s_mov_b32 s49, 102400
buffer_store_short_d16_hi v20, v17, s[16:19], s49 offen
s_mov_b32 s49, 106496
buffer_store_short v21, v17, s[16:19], s49 offen
s_mov_b32 s49, 110592
buffer_store_short_d16_hi v21, v17, s[16:19], s49 offen
s_mov_b32 s49, 114688
buffer_store_short v22, v17, s[16:19], s49 offen
s_mov_b32 s49, 118784
buffer_store_short_d16_hi v22, v17, s[16:19], s49 offen
s_mov_b32 s49, 122880
buffer_store_short v23, v17, s[16:19], s49 offen
s_mov_b32 s49, 126976
buffer_store_short_d16_hi v23, v17, s[16:19], s49 offen
s_waitcnt vmcnt(0)
K1_NOXT:
v_add_u32 v15, s53, v12
v_add_u32 v16, s53, v13
v_add_u32 v17, s53, v14
ds_read_b128 v[20:23], v15
ds_read_b128 v[24:27], v15 offset:2048
ds_read_b64_tr_b16 v[28:29], v17 offset:0
ds_read_b64_tr_b16 v[30:31], v17 offset:256
ds_read_b64_tr_b16 v[32:33], v17 offset:2048
ds_read_b64_tr_b16 v[34:35], v17 offset:2304
ds_read_b64_tr_b16 v[36:37], v17 offset:4096
ds_read_b64_tr_b16 v[38:39], v17 offset:4352
ds_read_b128 v[40:43], v16
ds_read_b128 v[44:47], v16 offset:2048
ds_read_b64_tr_b16 v[48:49], v17 offset:1024
ds_read_b64_tr_b16 v[50:51], v17 offset:1280
ds_read_b64_tr_b16 v[52:53], v17 offset:3072
ds_read_b64_tr_b16 v[54:55], v17 offset:3328
ds_read_b64_tr_b16 v[56:57], v17 offset:5120
ds_read_b64_tr_b16 v[58:59], v17 offset:5376
s_waitcnt lgkmcnt(8)
v_mfma_f32_32x32x16_bf16 v[64:79], v[20:23], v[28:31], v[64:79]
s_add_u32 s48, s50, s46
s_add_u32 m0, s48, 0
s_nop 0
buffer_load_dwordx4 v4, s[8:11], s51 offen lds
v_mfma_f32_32x32x16_bf16 v[80:95], v[20:23], v[32:35], v[80:95]
v_mfma_f32_32x32x16_bf16 v[96:111], v[20:23], v[36:39], v[96:111]
s_add_u32 s48, s50, s46
s_add_u32 m0, s48, 1024
s_nop 0
buffer_load_dwordx4 v5, s[8:11], s51 offen lds
v_mfma_f32_32x32x16_bf16 v[112:127], v[24:27], v[28:31], v[112:127]
v_mfma_f32_32x32x16_bf16 v[128:143], v[24:27], v[32:35], v[128:143]
s_add_u32 s48, s50, s46
s_add_u32 m0, s48, 2048
s_nop 0
buffer_load_dwordx4 v6, s[8:11], s51 offen lds
v_mfma_f32_32x32x16_bf16 v[144:159], v[24:27], v[36:39], v[144:159]
s_waitcnt lgkmcnt(0)
v_mfma_f32_32x32x16_bf16 v[64:79], v[40:43], v[48:51], v[64:79]
s_add_u32 s48, s50, s46
s_add_u32 m0, s48, 3072
s_nop 0
buffer_load_dwordx4 v7, s[8:11], s51 offen lds
v_mfma_f32_32x32x16_bf16 v[80:95], v[40:43], v[52:55], v[80:95]
v_mfma_f32_32x32x16_bf16 v[96:111], v[40:43], v[56:59], v[96:111]
s_add_u32 s48, s50, s47
s_cmp_eq_u32 s20, 3
s_cselect_b32 s48, 67584, s48
s_mul_i32 s49, s51, 3072
s_add_u32 m0, s48, 0
s_nop 0
buffer_load_dwordx4 v10, s[12:15], s49 offen lds
v_mfma_f32_32x32x16_bf16 v[112:127], v[44:47], v[48:51], v[112:127]
v_mfma_f32_32x32x16_bf16 v[128:143], v[44:47], v[52:55], v[128:143]
s_add_u32 s48, s50, s47
s_cmp_eq_u32 s20, 3
s_cselect_b32 s48, 67584, s48
s_mul_i32 s49, s51, 3072
s_add_u32 m0, s48, 1024
s_nop 0
buffer_load_dwordx4 v11, s[12:15], s49 offen lds
v_mfma_f32_32x32x16_bf16 v[144:159], v[44:47], v[56:59], v[144:159]
s_add_u32 s53, s53, 22528
s_cmp_eq_u32 s53, 67584
s_cselect_b32 s53, 0, s53
s_add_u32 s50, s50, 22528
s_cmp_eq_u32 s50, 67584
s_cselect_b32 s50, 0, s50
s_add_u32 s52, s52, 1
s_cmp_lt_u32 s52, 32
s_cbranch_scc1 K1_LOOP
s_waitcnt vmcnt(0)
s_nop 7
s_nop 7
s_barrier
s_mov_b32 s61, 0x358637bd
v_bfe_u32 v2, v64, 16, 1
v_add3_u32 v64, v64, v2, s60
v_and_b32 v64, 0xffff0000, v64
v_mul_f32 v2, 0x3fb8aa3b, v64
v_exp_f32 v2, v2
v_add_f32 v3, 1.0, v64
v_cmp_lt_f32 vcc, 0, v64
s_nop 1
v_cndmask_b32 v64, v2, v3, vcc
v_bfe_u32 v2, v64, 16, 1
v_add3_u32 v64, v64, v2, s60
v_and_b32 v64, 0xffff0000, v64
v_add_f32 v64, s61, v64
v_bfe_u32 v2, v64, 16, 1
v_add3_u32 v64, v64, v2, s60
v_and_b32 v64, 0xffff0000, v64
v_bfe_u32 v2, v65, 16, 1
v_add3_u32 v65, v65, v2, s60
v_and_b32 v65, 0xffff0000, v65
v_mul_f32 v2, 0x3fb8aa3b, v65
v_exp_f32 v2, v2
v_add_f32 v3, 1.0, v65
v_cmp_lt_f32 vcc, 0, v65
s_nop 1
v_cndmask_b32 v65, v2, v3, vcc
v_bfe_u32 v2, v65, 16, 1
v_add3_u32 v65, v65, v2, s60
v_and_b32 v65, 0xffff0000, v65
v_add_f32 v65, s61, v65
v_bfe_u32 v2, v65, 16, 1
v_add3_u32 v65, v65, v2, s60
v_and_b32 v65, 0xffff0000, v65
v_bfe_u32 v2, v66, 16, 1
v_add3_u32 v66, v66, v2, s60
v_and_b32 v66, 0xffff0000, v66
v_mul_f32 v2, 0x3fb8aa3b, v66
v_exp_f32 v2, v2
v_add_f32 v3, 1.0, v66
v_cmp_lt_f32 vcc, 0, v66
s_nop 1
v_cndmask_b32 v66, v2, v3, vcc
v_bfe_u32 v2, v66, 16, 1
v_add3_u32 v66, v66, v2, s60
v_and_b32 v66, 0xffff0000, v66
v_add_f32 v66, s61, v66
v_bfe_u32 v2, v66, 16, 1
v_add3_u32 v66, v66, v2, s60
v_and_b32 v66, 0xffff0000, v66
v_bfe_u32 v2, v67, 16, 1
v_add3_u32 v67, v67, v2, s60
v_and_b32 v67, 0xffff0000, v67
v_mul_f32 v2, 0x3fb8aa3b, v67
v_exp_f32 v2, v2
v_add_f32 v3, 1.0, v67
v_cmp_lt_f32 vcc, 0, v67
s_nop 1
v_cndmask_b32 v67, v2, v3, vcc
v_bfe_u32 v2, v67, 16, 1
v_add3_u32 v67, v67, v2, s60
v_and_b32 v67, 0xffff0000, v67
v_add_f32 v67, s61, v67
v_bfe_u32 v2, v67, 16, 1
v_add3_u32 v67, v67, v2, s60
v_and_b32 v67, 0xffff0000, v67
v_bfe_u32 v2, v68, 16, 1
v_add3_u32 v68, v68, v2, s60
v_and_b32 v68, 0xffff0000, v68
v_mul_f32 v2, 0x3fb8aa3b, v68
v_exp_f32 v2, v2
v_add_f32 v3, 1.0, v68
v_cmp_lt_f32 vcc, 0, v68
s_nop 1
v_cndmask_b32 v68, v2, v3, vcc
v_bfe_u32 v2, v68, 16, 1
v_add3_u32 v68, v68, v2, s60
v_and_b32 v68, 0xffff0000, v68
v_add_f32 v68, s61, v68
v_bfe_u32 v2, v68, 16, 1
v_add3_u32 v68, v68, v2, s60
v_and_b32 v68, 0xffff0000, v68
v_bfe_u32 v2, v69, 16, 1
v_add3_u32 v69, v69, v2, s60
v_and_b32 v69, 0xffff0000, v69
v_mul_f32 v2, 0x3fb8aa3b, v69
v_exp_f32 v2, v2
v_add_f32 v3, 1.0, v69
v_cmp_lt_f32 vcc, 0, v69
s_nop 1
v_cndmask_b32 v69, v2, v3, vcc
v_bfe_u32 v2, v69, 16, 1
v_add3_u32 v69, v69, v2, s60
v_and_b32 v69, 0xffff0000, v69
v_add_f32 v69, s61, v69
v_bfe_u32 v2, v69, 16, 1
v_add3_u32 v69, v69, v2, s60
v_and_b32 v69, 0xffff0000, v69
v_bfe_u32 v2, v70, 16, 1
v_add3_u32 v70, v70, v2, s60
v_and_b32 v70, 0xffff0000, v70
v_mul_f32 v2, 0x3fb8aa3b, v70
v_exp_f32 v2, v2
v_add_f32 v3, 1.0, v70
v_cmp_lt_f32 vcc, 0, v70
s_nop 1
v_cndmask_b32 v70, v2, v3, vcc
v_bfe_u32 v2, v70, 16, 1
v_add3_u32 v70, v70, v2, s60
v_and_b32 v70, 0xffff0000, v70
v_add_f32 v70, s61, v70
v_bfe_u32 v2, v70, 16, 1
v_add3_u32 v70, v70, v2, s60
v_and_b32 v70, 0xffff0000, v70
v_bfe_u32 v2, v71, 16, 1
v_add3_u32 v71, v71, v2, s60
v_and_b32 v71, 0xffff0000, v71
v_mul_f32 v2, 0x3fb8aa3b, v71
v_exp_f32 v2, v2
v_add_f32 v3, 1.0, v71
v_cmp_lt_f32 vcc, 0, v71
s_nop 1
v_cndmask_b32 v71, v2, v3, vcc
v_bfe_u32 v2, v71, 16, 1
v_add3_u32 v71, v71, v2, s60
v_and_b32 v71, 0xffff0000, v71
v_add_f32 v71, s61, v71
v_bfe_u32 v2, v71, 16, 1
v_add3_u32 v71, v71, v2, s60
v_and_b32 v71, 0xffff0000, v71
v_bfe_u32 v2, v72, 16, 1
v_add3_u32 v72, v72, v2, s60
v_and_b32 v72, 0xffff0000, v72
v_mul_f32 v2, 0x3fb8aa3b, v72
v_exp_f32 v2, v2
v_add_f32 v3, 1.0, v72
v_cmp_lt_f32 vcc, 0, v72
s_nop 1
v_cndmask_b32 v72, v2, v3, vcc
v_bfe_u32 v2, v72, 16, 1
v_add3_u32 v72, v72, v2, s60
v_and_b32 v72, 0xffff0000, v72
v_add_f32 v72, s61, v72
v_bfe_u32 v2, v72, 16, 1
v_add3_u32 v72, v72, v2, s60
v_and_b32 v72, 0xffff0000, v72
v_bfe_u32 v2, v73, 16, 1
v_add3_u32 v73, v73, v2, s60
v_and_b32 v73, 0xffff0000, v73
v_mul_f32 v2, 0x3fb8aa3b, v73
v_exp_f32 v2, v2
v_add_f32 v3, 1.0, v73
v_cmp_lt_f32 vcc, 0, v73
s_nop 1
v_cndmask_b32 v73, v2, v3, vcc
v_bfe_u32 v2, v73, 16, 1
v_add3_u32 v73, v73, v2, s60
v_and_b32 v73, 0xffff0000, v73
v_add_f32 v73, s61, v73
v_bfe_u32 v2, v73, 16, 1
v_add3_u32 v73, v73, v2, s60
v_and_b32 v73, 0xffff0000, v73
v_bfe_u32 v2, v74, 16, 1
v_add3_u32 v74, v74, v2, s60
v_and_b32 v74, 0xffff0000, v74
v_mul_f32 v2, 0x3fb8aa3b, v74
v_exp_f32 v2, v2
v_add_f32 v3, 1.0, v74
v_cmp_lt_f32 vcc, 0, v74
s_nop 1
v_cndmask_b32 v74, v2, v3, vcc
v_bfe_u32 v2, v74, 16, 1
v_add3_u32 v74, v74, v2, s60
v_and_b32 v74, 0xffff0000, v74
v_add_f32 v74, s61, v74
v_bfe_u32 v2, v74, 16, 1
v_add3_u32 v74, v74, v2, s60
v_and_b32 v74, 0xffff0000, v74
v_bfe_u32 v2, v75, 16, 1
v_add3_u32 v75, v75, v2, s60
v_and_b32 v75, 0xffff0000, v75
v_mul_f32 v2, 0x3fb8aa3b, v75
v_exp_f32 v2, v2
v_add_f32 v3, 1.0, v75
v_cmp_lt_f32 vcc, 0, v75
s_nop 1
v_cndmask_b32 v75, v2, v3, vcc
v_bfe_u32 v2, v75, 16, 1
v_add3_u32 v75, v75, v2, s60
v_and_b32 v75, 0xffff0000, v75
v_add_f32 v75, s61, v75
v_bfe_u32 v2, v75, 16, 1
v_add3_u32 v75, v75, v2, s60
v_and_b32 v75, 0xffff0000, v75
v_bfe_u32 v2, v76, 16, 1
v_add3_u32 v76, v76, v2, s60
v_and_b32 v76, 0xffff0000, v76
v_mul_f32 v2, 0x3fb8aa3b, v76
v_exp_f32 v2, v2
v_add_f32 v3, 1.0, v76
v_cmp_lt_f32 vcc, 0, v76
s_nop 1
v_cndmask_b32 v76, v2, v3, vcc
v_bfe_u32 v2, v76, 16, 1
v_add3_u32 v76, v76, v2, s60
v_and_b32 v76, 0xffff0000, v76
v_add_f32 v76, s61, v76
v_bfe_u32 v2, v76, 16, 1
v_add3_u32 v76, v76, v2, s60
v_and_b32 v76, 0xffff0000, v76
v_bfe_u32 v2, v77, 16, 1
v_add3_u32 v77, v77, v2, s60
v_and_b32 v77, 0xffff0000, v77
v_mul_f32 v2, 0x3fb8aa3b, v77
v_exp_f32 v2, v2
v_add_f32 v3, 1.0, v77
v_cmp_lt_f32 vcc, 0, v77
s_nop 1
v_cndmask_b32 v77, v2, v3, vcc
v_bfe_u32 v2, v77, 16, 1
v_add3_u32 v77, v77, v2, s60
v_and_b32 v77, 0xffff0000, v77
v_add_f32 v77, s61, v77
v_bfe_u32 v2, v77, 16, 1
v_add3_u32 v77, v77, v2, s60
v_and_b32 v77, 0xffff0000, v77
v_bfe_u32 v2, v78, 16, 1
v_add3_u32 v78, v78, v2, s60
v_and_b32 v78, 0xffff0000, v78
v_mul_f32 v2, 0x3fb8aa3b, v78
v_exp_f32 v2, v2
v_add_f32 v3, 1.0, v78
v_cmp_lt_f32 vcc, 0, v78
s_nop 1
v_cndmask_b32 v78, v2, v3, vcc
v_bfe_u32 v2, v78, 16, 1
v_add3_u32 v78, v78, v2, s60
v_and_b32 v78, 0xffff0000, v78
v_add_f32 v78, s61, v78
v_bfe_u32 v2, v78, 16, 1
v_add3_u32 v78, v78, v2, s60
v_and_b32 v78, 0xffff0000, v78
v_bfe_u32 v2, v79, 16, 1
v_add3_u32 v79, v79, v2, s60
v_and_b32 v79, 0xffff0000, v79
v_mul_f32 v2, 0x3fb8aa3b, v79
v_exp_f32 v2, v2
v_add_f32 v3, 1.0, v79
v_cmp_lt_f32 vcc, 0, v79
s_nop 1
v_cndmask_b32 v79, v2, v3, vcc
v_bfe_u32 v2, v79, 16, 1
v_add3_u32 v79, v79, v2, s60
v_and_b32 v79, 0xffff0000, v79
v_add_f32 v79, s61, v79
v_bfe_u32 v2, v79, 16, 1
v_add3_u32 v79, v79, v2, s60
v_and_b32 v79, 0xffff0000, v79
v_bfe_u32 v2, v80, 16, 1
v_add3_u32 v80, v80, v2, s60
v_and_b32 v80, 0xffff0000, v80
v_mul_f32 v2, 0x3fb8aa3b, v80
v_exp_f32 v2, v2
v_add_f32 v3, 1.0, v80
v_cmp_lt_f32 vcc, 0, v80
s_nop 1
v_cndmask_b32 v80, v2, v3, vcc
v_bfe_u32 v2, v80, 16, 1
v_add3_u32 v80, v80, v2, s60
v_and_b32 v80, 0xffff0000, v80
v_add_f32 v80, s61, v80
v_bfe_u32 v2, v80, 16, 1
v_add3_u32 v80, v80, v2, s60
v_and_b32 v80, 0xffff0000, v80
v_bfe_u32 v2, v81, 16, 1
v_add3_u32 v81, v81, v2, s60
v_and_b32 v81, 0xffff0000, v81
v_mul_f32 v2, 0x3fb8aa3b, v81
v_exp_f32 v2, v2
v_add_f32 v3, 1.0, v81
v_cmp_lt_f32 vcc, 0, v81
s_nop 1
v_cndmask_b32 v81, v2, v3, vcc
v_bfe_u32 v2, v81, 16, 1
v_add3_u32 v81, v81, v2, s60
v_and_b32 v81, 0xffff0000, v81
v_add_f32 v81, s61, v81
v_bfe_u32 v2, v81, 16, 1
v_add3_u32 v81, v81, v2, s60
v_and_b32 v81, 0xffff0000, v81
v_bfe_u32 v2, v82, 16, 1
v_add3_u32 v82, v82, v2, s60
v_and_b32 v82, 0xffff0000, v82
v_mul_f32 v2, 0x3fb8aa3b, v82
v_exp_f32 v2, v2
v_add_f32 v3, 1.0, v82
v_cmp_lt_f32 vcc, 0, v82
s_nop 1
v_cndmask_b32 v82, v2, v3, vcc
v_bfe_u32 v2, v82, 16, 1
v_add3_u32 v82, v82, v2, s60
v_and_b32 v82, 0xffff0000, v82
v_add_f32 v82, s61, v82
v_bfe_u32 v2, v82, 16, 1
v_add3_u32 v82, v82, v2, s60
v_and_b32 v82, 0xffff0000, v82
v_bfe_u32 v2, v83, 16, 1
v_add3_u32 v83, v83, v2, s60
v_and_b32 v83, 0xffff0000, v83
v_mul_f32 v2, 0x3fb8aa3b, v83
v_exp_f32 v2, v2
v_add_f32 v3, 1.0, v83
v_cmp_lt_f32 vcc, 0, v83
s_nop 1
v_cndmask_b32 v83, v2, v3, vcc
v_bfe_u32 v2, v83, 16, 1
v_add3_u32 v83, v83, v2, s60
v_and_b32 v83, 0xffff0000, v83
v_add_f32 v83, s61, v83
v_bfe_u32 v2, v83, 16, 1
v_add3_u32 v83, v83, v2, s60
v_and_b32 v83, 0xffff0000, v83
v_bfe_u32 v2, v84, 16, 1
v_add3_u32 v84, v84, v2, s60
v_and_b32 v84, 0xffff0000, v84
v_mul_f32 v2, 0x3fb8aa3b, v84
v_exp_f32 v2, v2
v_add_f32 v3, 1.0, v84
v_cmp_lt_f32 vcc, 0, v84
s_nop 1
v_cndmask_b32 v84, v2, v3, vcc
v_bfe_u32 v2, v84, 16, 1
v_add3_u32 v84, v84, v2, s60
v_and_b32 v84, 0xffff0000, v84
v_add_f32 v84, s61, v84
v_bfe_u32 v2, v84, 16, 1
v_add3_u32 v84, v84, v2, s60
v_and_b32 v84, 0xffff0000, v84
v_bfe_u32 v2, v85, 16, 1
v_add3_u32 v85, v85, v2, s60
v_and_b32 v85, 0xffff0000, v85
v_mul_f32 v2, 0x3fb8aa3b, v85
v_exp_f32 v2, v2
v_add_f32 v3, 1.0, v85
v_cmp_lt_f32 vcc, 0, v85
s_nop 1
v_cndmask_b32 v85, v2, v3, vcc
v_bfe_u32 v2, v85, 16, 1
v_add3_u32 v85, v85, v2, s60
v_and_b32 v85, 0xffff0000, v85
v_add_f32 v85, s61, v85
v_bfe_u32 v2, v85, 16, 1
v_add3_u32 v85, v85, v2, s60
v_and_b32 v85, 0xffff0000, v85
v_bfe_u32 v2, v86, 16, 1
v_add3_u32 v86, v86, v2, s60
v_and_b32 v86, 0xffff0000, v86
v_mul_f32 v2, 0x3fb8aa3b, v86
v_exp_f32 v2, v2
v_add_f32 v3, 1.0, v86
v_cmp_lt_f32 vcc, 0, v86
s_nop 1
v_cndmask_b32 v86, v2, v3, vcc
v_bfe_u32 v2, v86, 16, 1
v_add3_u32 v86, v86, v2, s60
v_and_b32 v86, 0xffff0000, v86
v_add_f32 v86, s61, v86
v_bfe_u32 v2, v86, 16, 1
v_add3_u32 v86, v86, v2, s60
v_and_b32 v86, 0xffff0000, v86
v_bfe_u32 v2, v87, 16, 1
v_add3_u32 v87, v87, v2, s60
v_and_b32 v87, 0xffff0000, v87
v_mul_f32 v2, 0x3fb8aa3b, v87
v_exp_f32 v2, v2
v_add_f32 v3, 1.0, v87
v_cmp_lt_f32 vcc, 0, v87
s_nop 1
v_cndmask_b32 v87, v2, v3, vcc
v_bfe_u32 v2, v87, 16, 1
v_add3_u32 v87, v87, v2, s60
v_and_b32 v87, 0xffff0000, v87
v_add_f32 v87, s61, v87
v_bfe_u32 v2, v87, 16, 1
v_add3_u32 v87, v87, v2, s60
v_and_b32 v87, 0xffff0000, v87
v_bfe_u32 v2, v88, 16, 1
v_add3_u32 v88, v88, v2, s60
v_and_b32 v88, 0xffff0000, v88
v_mul_f32 v2, 0x3fb8aa3b, v88
v_exp_f32 v2, v2
v_add_f32 v3, 1.0, v88
v_cmp_lt_f32 vcc, 0, v88
s_nop 1
v_cndmask_b32 v88, v2, v3, vcc
v_bfe_u32 v2, v88, 16, 1
v_add3_u32 v88, v88, v2, s60
v_and_b32 v88, 0xffff0000, v88
v_add_f32 v88, s61, v88
v_bfe_u32 v2, v88, 16, 1
v_add3_u32 v88, v88, v2, s60
v_and_b32 v88, 0xffff0000, v88
v_bfe_u32 v2, v89, 16, 1
v_add3_u32 v89, v89, v2, s60
v_and_b32 v89, 0xffff0000, v89
v_mul_f32 v2, 0x3fb8aa3b, v89
v_exp_f32 v2, v2
v_add_f32 v3, 1.0, v89
v_cmp_lt_f32 vcc, 0, v89
s_nop 1
v_cndmask_b32 v89, v2, v3, vcc
v_bfe_u32 v2, v89, 16, 1
v_add3_u32 v89, v89, v2, s60
v_and_b32 v89, 0xffff0000, v89
v_add_f32 v89, s61, v89
v_bfe_u32 v2, v89, 16, 1
v_add3_u32 v89, v89, v2, s60
v_and_b32 v89, 0xffff0000, v89
v_bfe_u32 v2, v90, 16, 1
v_add3_u32 v90, v90, v2, s60
v_and_b32 v90, 0xffff0000, v90
v_mul_f32 v2, 0x3fb8aa3b, v90
v_exp_f32 v2, v2
v_add_f32 v3, 1.0, v90
v_cmp_lt_f32 vcc, 0, v90
s_nop 1
v_cndmask_b32 v90, v2, v3, vcc
v_bfe_u32 v2, v90, 16, 1
v_add3_u32 v90, v90, v2, s60
v_and_b32 v90, 0xffff0000, v90
v_add_f32 v90, s61, v90
v_bfe_u32 v2, v90, 16, 1
v_add3_u32 v90, v90, v2, s60
v_and_b32 v90, 0xffff0000, v90
v_bfe_u32 v2, v91, 16, 1
v_add3_u32 v91, v91, v2, s60
v_and_b32 v91, 0xffff0000, v91
v_mul_f32 v2, 0x3fb8aa3b, v91
v_exp_f32 v2, v2
v_add_f32 v3, 1.0, v91
v_cmp_lt_f32 vcc, 0, v91
s_nop 1
v_cndmask_b32 v91, v2, v3, vcc
v_bfe_u32 v2, v91, 16, 1
v_add3_u32 v91, v91, v2, s60
v_and_b32 v91, 0xffff0000, v91
v_add_f32 v91, s61, v91
v_bfe_u32 v2, v91, 16, 1
v_add3_u32 v91, v91, v2, s60
v_and_b32 v91, 0xffff0000, v91
v_bfe_u32 v2, v92, 16, 1
v_add3_u32 v92, v92, v2, s60
v_and_b32 v92, 0xffff0000, v92
v_mul_f32 v2, 0x3fb8aa3b, v92
v_exp_f32 v2, v2
v_add_f32 v3, 1.0, v92
v_cmp_lt_f32 vcc, 0, v92
s_nop 1
v_cndmask_b32 v92, v2, v3, vcc
v_bfe_u32 v2, v92, 16, 1
v_add3_u32 v92, v92, v2, s60
v_and_b32 v92, 0xffff0000, v92
v_add_f32 v92, s61, v92
v_bfe_u32 v2, v92, 16, 1
v_add3_u32 v92, v92, v2, s60
v_and_b32 v92, 0xffff0000, v92
v_bfe_u32 v2, v93, 16, 1
v_add3_u32 v93, v93, v2, s60
v_and_b32 v93, 0xffff0000, v93
v_mul_f32 v2, 0x3fb8aa3b, v93
v_exp_f32 v2, v2
v_add_f32 v3, 1.0, v93
v_cmp_lt_f32 vcc, 0, v93
s_nop 1
v_cndmask_b32 v93, v2, v3, vcc
v_bfe_u32 v2, v93, 16, 1
v_add3_u32 v93, v93, v2, s60
v_and_b32 v93, 0xffff0000, v93
v_add_f32 v93, s61, v93
v_bfe_u32 v2, v93, 16, 1
v_add3_u32 v93, v93, v2, s60
v_and_b32 v93, 0xffff0000, v93
v_bfe_u32 v2, v94, 16, 1
v_add3_u32 v94, v94, v2, s60
v_and_b32 v94, 0xffff0000, v94
v_mul_f32 v2, 0x3fb8aa3b, v94
v_exp_f32 v2, v2
v_add_f32 v3, 1.0, v94
v_cmp_lt_f32 vcc, 0, v94
s_nop 1
v_cndmask_b32 v94, v2, v3, vcc
v_bfe_u32 v2, v94, 16, 1
v_add3_u32 v94, v94, v2, s60
v_and_b32 v94, 0xffff0000, v94
v_add_f32 v94, s61, v94
v_bfe_u32 v2, v94, 16, 1
v_add3_u32 v94, v94, v2, s60
v_and_b32 v94, 0xffff0000, v94
v_bfe_u32 v2, v95, 16, 1
v_add3_u32 v95, v95, v2, s60
v_and_b32 v95, 0xffff0000, v95
v_mul_f32 v2, 0x3fb8aa3b, v95
v_exp_f32 v2, v2
v_add_f32 v3, 1.0, v95
v_cmp_lt_f32 vcc, 0, v95
s_nop 1
v_cndmask_b32 v95, v2, v3, vcc
v_bfe_u32 v2, v95, 16, 1
v_add3_u32 v95, v95, v2, s60
v_and_b32 v95, 0xffff0000, v95
v_add_f32 v95, s61, v95
v_bfe_u32 v2, v95, 16, 1
v_add3_u32 v95, v95, v2, s60
v_and_b32 v95, 0xffff0000, v95
v_bfe_u32 v2, v96, 16, 1
v_add3_u32 v96, v96, v2, s60
v_and_b32 v96, 0xffff0000, v96
v_bfe_u32 v2, v97, 16, 1
v_add3_u32 v97, v97, v2, s60
v_and_b32 v97, 0xffff0000, v97
v_bfe_u32 v2, v98, 16, 1
v_add3_u32 v98, v98, v2, s60
v_and_b32 v98, 0xffff0000, v98
v_bfe_u32 v2, v99, 16, 1
v_add3_u32 v99, v99, v2, s60
v_and_b32 v99, 0xffff0000, v99
v_bfe_u32 v2, v100, 16, 1
v_add3_u32 v100, v100, v2, s60
v_and_b32 v100, 0xffff0000, v100
v_bfe_u32 v2, v101, 16, 1
v_add3_u32 v101, v101, v2, s60
v_and_b32 v101, 0xffff0000, v101
v_bfe_u32 v2, v102, 16, 1
v_add3_u32 v102, v102, v2, s60
v_and_b32 v102, 0xffff0000, v102
v_bfe_u32 v2, v103, 16, 1
v_add3_u32 v103, v103, v2, s60
v_and_b32 v103, 0xffff0000, v103
v_bfe_u32 v2, v104, 16, 1
v_add3_u32 v104, v104, v2, s60
v_and_b32 v104, 0xffff0000, v104
v_bfe_u32 v2, v105, 16, 1
v_add3_u32 v105, v105, v2, s60
v_and_b32 v105, 0xffff0000, v105
v_bfe_u32 v2, v106, 16, 1
v_add3_u32 v106, v106, v2, s60
v_and_b32 v106, 0xffff0000, v106
v_bfe_u32 v2, v107, 16, 1
v_add3_u32 v107, v107, v2, s60
v_and_b32 v107, 0xffff0000, v107
v_bfe_u32 v2, v108, 16, 1
v_add3_u32 v108, v108, v2, s60
v_and_b32 v108, 0xffff0000, v108
v_bfe_u32 v2, v109, 16, 1
v_add3_u32 v109, v109, v2, s60
v_and_b32 v109, 0xffff0000, v109
v_bfe_u32 v2, v110, 16, 1
v_add3_u32 v110, v110, v2, s60
v_and_b32 v110, 0xffff0000, v110
v_bfe_u32 v2, v111, 16, 1
v_add3_u32 v111, v111, v2, s60
v_and_b32 v111, 0xffff0000, v111
v_bfe_u32 v2, v112, 16, 1
v_add3_u32 v112, v112, v2, s60
v_and_b32 v112, 0xffff0000, v112
v_mul_f32 v2, 0x3fb8aa3b, v112
v_exp_f32 v2, v2
v_add_f32 v3, 1.0, v112
v_cmp_lt_f32 vcc, 0, v112
s_nop 1
v_cndmask_b32 v112, v2, v3, vcc
v_bfe_u32 v2, v112, 16, 1
v_add3_u32 v112, v112, v2, s60
v_and_b32 v112, 0xffff0000, v112
v_add_f32 v112, s61, v112
v_bfe_u32 v2, v112, 16, 1
v_add3_u32 v112, v112, v2, s60
v_and_b32 v112, 0xffff0000, v112
v_bfe_u32 v2, v113, 16, 1
v_add3_u32 v113, v113, v2, s60
v_and_b32 v113, 0xffff0000, v113
v_mul_f32 v2, 0x3fb8aa3b, v113
v_exp_f32 v2, v2
v_add_f32 v3, 1.0, v113
v_cmp_lt_f32 vcc, 0, v113
s_nop 1
v_cndmask_b32 v113, v2, v3, vcc
v_bfe_u32 v2, v113, 16, 1
v_add3_u32 v113, v113, v2, s60
v_and_b32 v113, 0xffff0000, v113
v_add_f32 v113, s61, v113
v_bfe_u32 v2, v113, 16, 1
v_add3_u32 v113, v113, v2, s60
v_and_b32 v113, 0xffff0000, v113
v_bfe_u32 v2, v114, 16, 1
v_add3_u32 v114, v114, v2, s60
v_and_b32 v114, 0xffff0000, v114
v_mul_f32 v2, 0x3fb8aa3b, v114
v_exp_f32 v2, v2
v_add_f32 v3, 1.0, v114
v_cmp_lt_f32 vcc, 0, v114
s_nop 1
v_cndmask_b32 v114, v2, v3, vcc
v_bfe_u32 v2, v114, 16, 1
v_add3_u32 v114, v114, v2, s60
v_and_b32 v114, 0xffff0000, v114
v_add_f32 v114, s61, v114
v_bfe_u32 v2, v114, 16, 1
v_add3_u32 v114, v114, v2, s60
v_and_b32 v114, 0xffff0000, v114
v_bfe_u32 v2, v115, 16, 1
v_add3_u32 v115, v115, v2, s60
v_and_b32 v115, 0xffff0000, v115
v_mul_f32 v2, 0x3fb8aa3b, v115
v_exp_f32 v2, v2
v_add_f32 v3, 1.0, v115
v_cmp_lt_f32 vcc, 0, v115
s_nop 1
v_cndmask_b32 v115, v2, v3, vcc
v_bfe_u32 v2, v115, 16, 1
v_add3_u32 v115, v115, v2, s60
v_and_b32 v115, 0xffff0000, v115
v_add_f32 v115, s61, v115
v_bfe_u32 v2, v115, 16, 1
v_add3_u32 v115, v115, v2, s60
v_and_b32 v115, 0xffff0000, v115
v_bfe_u32 v2, v116, 16, 1
v_add3_u32 v116, v116, v2, s60
v_and_b32 v116, 0xffff0000, v116
v_mul_f32 v2, 0x3fb8aa3b, v116
v_exp_f32 v2, v2
v_add_f32 v3, 1.0, v116
v_cmp_lt_f32 vcc, 0, v116
s_nop 1
v_cndmask_b32 v116, v2, v3, vcc
v_bfe_u32 v2, v116, 16, 1
v_add3_u32 v116, v116, v2, s60
v_and_b32 v116, 0xffff0000, v116
v_add_f32 v116, s61, v116
v_bfe_u32 v2, v116, 16, 1
v_add3_u32 v116, v116, v2, s60
v_and_b32 v116, 0xffff0000, v116
v_bfe_u32 v2, v117, 16, 1
v_add3_u32 v117, v117, v2, s60
v_and_b32 v117, 0xffff0000, v117
v_mul_f32 v2, 0x3fb8aa3b, v117
v_exp_f32 v2, v2
v_add_f32 v3, 1.0, v117
v_cmp_lt_f32 vcc, 0, v117
s_nop 1
v_cndmask_b32 v117, v2, v3, vcc
v_bfe_u32 v2, v117, 16, 1
v_add3_u32 v117, v117, v2, s60
v_and_b32 v117, 0xffff0000, v117
v_add_f32 v117, s61, v117
v_bfe_u32 v2, v117, 16, 1
v_add3_u32 v117, v117, v2, s60
v_and_b32 v117, 0xffff0000, v117
v_bfe_u32 v2, v118, 16, 1
v_add3_u32 v118, v118, v2, s60
v_and_b32 v118, 0xffff0000, v118
v_mul_f32 v2, 0x3fb8aa3b, v118
v_exp_f32 v2, v2
v_add_f32 v3, 1.0, v118
v_cmp_lt_f32 vcc, 0, v118
s_nop 1
v_cndmask_b32 v118, v2, v3, vcc
v_bfe_u32 v2, v118, 16, 1
v_add3_u32 v118, v118, v2, s60
v_and_b32 v118, 0xffff0000, v118
v_add_f32 v118, s61, v118
v_bfe_u32 v2, v118, 16, 1
v_add3_u32 v118, v118, v2, s60
v_and_b32 v118, 0xffff0000, v118
v_bfe_u32 v2, v119, 16, 1
v_add3_u32 v119, v119, v2, s60
v_and_b32 v119, 0xffff0000, v119
v_mul_f32 v2, 0x3fb8aa3b, v119
v_exp_f32 v2, v2
v_add_f32 v3, 1.0, v119
v_cmp_lt_f32 vcc, 0, v119
s_nop 1
v_cndmask_b32 v119, v2, v3, vcc
v_bfe_u32 v2, v119, 16, 1
v_add3_u32 v119, v119, v2, s60
v_and_b32 v119, 0xffff0000, v119
v_add_f32 v119, s61, v119
v_bfe_u32 v2, v119, 16, 1
v_add3_u32 v119, v119, v2, s60
v_and_b32 v119, 0xffff0000, v119
v_bfe_u32 v2, v120, 16, 1
v_add3_u32 v120, v120, v2, s60
v_and_b32 v120, 0xffff0000, v120
v_mul_f32 v2, 0x3fb8aa3b, v120
v_exp_f32 v2, v2
v_add_f32 v3, 1.0, v120
v_cmp_lt_f32 vcc, 0, v120
s_nop 1
v_cndmask_b32 v120, v2, v3, vcc
v_bfe_u32 v2, v120, 16, 1
v_add3_u32 v120, v120, v2, s60
v_and_b32 v120, 0xffff0000, v120
v_add_f32 v120, s61, v120
v_bfe_u32 v2, v120, 16, 1
v_add3_u32 v120, v120, v2, s60
v_and_b32 v120, 0xffff0000, v120
v_bfe_u32 v2, v121, 16, 1
v_add3_u32 v121, v121, v2, s60
v_and_b32 v121, 0xffff0000, v121
v_mul_f32 v2, 0x3fb8aa3b, v121
v_exp_f32 v2, v2
v_add_f32 v3, 1.0, v121
v_cmp_lt_f32 vcc, 0, v121
s_nop 1
v_cndmask_b32 v121, v2, v3, vcc
v_bfe_u32 v2, v121, 16, 1
v_add3_u32 v121, v121, v2, s60
v_and_b32 v121, 0xffff0000, v121
v_add_f32 v121, s61, v121
v_bfe_u32 v2, v121, 16, 1
v_add3_u32 v121, v121, v2, s60
v_and_b32 v121, 0xffff0000, v121
v_bfe_u32 v2, v122, 16, 1
v_add3_u32 v122, v122, v2, s60
v_and_b32 v122, 0xffff0000, v122
v_mul_f32 v2, 0x3fb8aa3b, v122
v_exp_f32 v2, v2
v_add_f32 v3, 1.0, v122
v_cmp_lt_f32 vcc, 0, v122
s_nop 1
v_cndmask_b32 v122, v2, v3, vcc
v_bfe_u32 v2, v122, 16, 1
v_add3_u32 v122, v122, v2, s60
v_and_b32 v122, 0xffff0000, v122
v_add_f32 v122, s61, v122
v_bfe_u32 v2, v122, 16, 1
v_add3_u32 v122, v122, v2, s60
v_and_b32 v122, 0xffff0000, v122
v_bfe_u32 v2, v123, 16, 1
v_add3_u32 v123, v123, v2, s60
v_and_b32 v123, 0xffff0000, v123
v_mul_f32 v2, 0x3fb8aa3b, v123
v_exp_f32 v2, v2
v_add_f32 v3, 1.0, v123
v_cmp_lt_f32 vcc, 0, v123
s_nop 1
v_cndmask_b32 v123, v2, v3, vcc
v_bfe_u32 v2, v123, 16, 1
v_add3_u32 v123, v123, v2, s60
v_and_b32 v123, 0xffff0000, v123
v_add_f32 v123, s61, v123
v_bfe_u32 v2, v123, 16, 1
v_add3_u32 v123, v123, v2, s60
v_and_b32 v123, 0xffff0000, v123
v_bfe_u32 v2, v124, 16, 1
v_add3_u32 v124, v124, v2, s60
v_and_b32 v124, 0xffff0000, v124
v_mul_f32 v2, 0x3fb8aa3b, v124
v_exp_f32 v2, v2
v_add_f32 v3, 1.0, v124
v_cmp_lt_f32 vcc, 0, v124
s_nop 1
v_cndmask_b32 v124, v2, v3, vcc
v_bfe_u32 v2, v124, 16, 1
v_add3_u32 v124, v124, v2, s60
v_and_b32 v124, 0xffff0000, v124
v_add_f32 v124, s61, v124
v_bfe_u32 v2, v124, 16, 1
v_add3_u32 v124, v124, v2, s60
v_and_b32 v124, 0xffff0000, v124
v_bfe_u32 v2, v125, 16, 1
v_add3_u32 v125, v125, v2, s60
v_and_b32 v125, 0xffff0000, v125
v_mul_f32 v2, 0x3fb8aa3b, v125
v_exp_f32 v2, v2
v_add_f32 v3, 1.0, v125
v_cmp_lt_f32 vcc, 0, v125
s_nop 1
v_cndmask_b32 v125, v2, v3, vcc
v_bfe_u32 v2, v125, 16, 1
v_add3_u32 v125, v125, v2, s60
v_and_b32 v125, 0xffff0000, v125
v_add_f32 v125, s61, v125
v_bfe_u32 v2, v125, 16, 1
v_add3_u32 v125, v125, v2, s60
v_and_b32 v125, 0xffff0000, v125
v_bfe_u32 v2, v126, 16, 1
v_add3_u32 v126, v126, v2, s60
v_and_b32 v126, 0xffff0000, v126
v_mul_f32 v2, 0x3fb8aa3b, v126
v_exp_f32 v2, v2
v_add_f32 v3, 1.0, v126
v_cmp_lt_f32 vcc, 0, v126
s_nop 1
v_cndmask_b32 v126, v2, v3, vcc
v_bfe_u32 v2, v126, 16, 1
v_add3_u32 v126, v126, v2, s60
v_and_b32 v126, 0xffff0000, v126
v_add_f32 v126, s61, v126
v_bfe_u32 v2, v126, 16, 1
v_add3_u32 v126, v126, v2, s60
v_and_b32 v126, 0xffff0000, v126
v_bfe_u32 v2, v127, 16, 1
v_add3_u32 v127, v127, v2, s60
v_and_b32 v127, 0xffff0000, v127
v_mul_f32 v2, 0x3fb8aa3b, v127
v_exp_f32 v2, v2
v_add_f32 v3, 1.0, v127
v_cmp_lt_f32 vcc, 0, v127
s_nop 1
v_cndmask_b32 v127, v2, v3, vcc
v_bfe_u32 v2, v127, 16, 1
v_add3_u32 v127, v127, v2, s60
v_and_b32 v127, 0xffff0000, v127
v_add_f32 v127, s61, v127
v_bfe_u32 v2, v127, 16, 1
v_add3_u32 v127, v127, v2, s60
v_and_b32 v127, 0xffff0000, v127
v_bfe_u32 v2, v128, 16, 1
v_add3_u32 v128, v128, v2, s60
v_and_b32 v128, 0xffff0000, v128
v_mul_f32 v2, 0x3fb8aa3b, v128
v_exp_f32 v2, v2
v_add_f32 v3, 1.0, v128
v_cmp_lt_f32 vcc, 0, v128
s_nop 1
v_cndmask_b32 v128, v2, v3, vcc
v_bfe_u32 v2, v128, 16, 1
v_add3_u32 v128, v128, v2, s60
v_and_b32 v128, 0xffff0000, v128
v_add_f32 v128, s61, v128
v_bfe_u32 v2, v128, 16, 1
v_add3_u32 v128, v128, v2, s60
v_and_b32 v128, 0xffff0000, v128
v_bfe_u32 v2, v129, 16, 1
v_add3_u32 v129, v129, v2, s60
v_and_b32 v129, 0xffff0000, v129
v_mul_f32 v2, 0x3fb8aa3b, v129
v_exp_f32 v2, v2
v_add_f32 v3, 1.0, v129
v_cmp_lt_f32 vcc, 0, v129
s_nop 1
v_cndmask_b32 v129, v2, v3, vcc
v_bfe_u32 v2, v129, 16, 1
v_add3_u32 v129, v129, v2, s60
v_and_b32 v129, 0xffff0000, v129
v_add_f32 v129, s61, v129
v_bfe_u32 v2, v129, 16, 1
v_add3_u32 v129, v129, v2, s60
v_and_b32 v129, 0xffff0000, v129
v_bfe_u32 v2, v130, 16, 1
v_add3_u32 v130, v130, v2, s60
v_and_b32 v130, 0xffff0000, v130
v_mul_f32 v2, 0x3fb8aa3b, v130
v_exp_f32 v2, v2
v_add_f32 v3, 1.0, v130
v_cmp_lt_f32 vcc, 0, v130
s_nop 1
v_cndmask_b32 v130, v2, v3, vcc
v_bfe_u32 v2, v130, 16, 1
v_add3_u32 v130, v130, v2, s60
v_and_b32 v130, 0xffff0000, v130
v_add_f32 v130, s61, v130
v_bfe_u32 v2, v130, 16, 1
v_add3_u32 v130, v130, v2, s60
v_and_b32 v130, 0xffff0000, v130
v_bfe_u32 v2, v131, 16, 1
v_add3_u32 v131, v131, v2, s60
v_and_b32 v131, 0xffff0000, v131
v_mul_f32 v2, 0x3fb8aa3b, v131
v_exp_f32 v2, v2
v_add_f32 v3, 1.0, v131
v_cmp_lt_f32 vcc, 0, v131
s_nop 1
v_cndmask_b32 v131, v2, v3, vcc
v_bfe_u32 v2, v131, 16, 1
v_add3_u32 v131, v131, v2, s60
v_and_b32 v131, 0xffff0000, v131
v_add_f32 v131, s61, v131
v_bfe_u32 v2, v131, 16, 1
v_add3_u32 v131, v131, v2, s60
v_and_b32 v131, 0xffff0000, v131
v_bfe_u32 v2, v132, 16, 1
v_add3_u32 v132, v132, v2, s60
v_and_b32 v132, 0xffff0000, v132
v_mul_f32 v2, 0x3fb8aa3b, v132
v_exp_f32 v2, v2
v_add_f32 v3, 1.0, v132
v_cmp_lt_f32 vcc, 0, v132
s_nop 1
v_cndmask_b32 v132, v2, v3, vcc
v_bfe_u32 v2, v132, 16, 1
v_add3_u32 v132, v132, v2, s60
v_and_b32 v132, 0xffff0000, v132
v_add_f32 v132, s61, v132
v_bfe_u32 v2, v132, 16, 1
v_add3_u32 v132, v132, v2, s60
v_and_b32 v132, 0xffff0000, v132
v_bfe_u32 v2, v133, 16, 1
v_add3_u32 v133, v133, v2, s60
v_and_b32 v133, 0xffff0000, v133
v_mul_f32 v2, 0x3fb8aa3b, v133
v_exp_f32 v2, v2
v_add_f32 v3, 1.0, v133
v_cmp_lt_f32 vcc, 0, v133
s_nop 1
v_cndmask_b32 v133, v2, v3, vcc
v_bfe_u32 v2, v133, 16, 1
v_add3_u32 v133, v133, v2, s60
v_and_b32 v133, 0xffff0000, v133
v_add_f32 v133, s61, v133
v_bfe_u32 v2, v133, 16, 1
v_add3_u32 v133, v133, v2, s60
v_and_b32 v133, 0xffff0000, v133
v_bfe_u32 v2, v134, 16, 1
v_add3_u32 v134, v134, v2, s60
v_and_b32 v134, 0xffff0000, v134
v_mul_f32 v2, 0x3fb8aa3b, v134
v_exp_f32 v2, v2
v_add_f32 v3, 1.0, v134
v_cmp_lt_f32 vcc, 0, v134
s_nop 1
v_cndmask_b32 v134, v2, v3, vcc
v_bfe_u32 v2, v134, 16, 1
v_add3_u32 v134, v134, v2, s60
v_and_b32 v134, 0xffff0000, v134
v_add_f32 v134, s61, v134
v_bfe_u32 v2, v134, 16, 1
v_add3_u32 v134, v134, v2, s60
v_and_b32 v134, 0xffff0000, v134
v_bfe_u32 v2, v135, 16, 1
v_add3_u32 v135, v135, v2, s60
v_and_b32 v135, 0xffff0000, v135
v_mul_f32 v2, 0x3fb8aa3b, v135
v_exp_f32 v2, v2
v_add_f32 v3, 1.0, v135
v_cmp_lt_f32 vcc, 0, v135
s_nop 1
v_cndmask_b32 v135, v2, v3, vcc
v_bfe_u32 v2, v135, 16, 1
v_add3_u32 v135, v135, v2, s60
v_and_b32 v135, 0xffff0000, v135
v_add_f32 v135, s61, v135
v_bfe_u32 v2, v135, 16, 1
v_add3_u32 v135, v135, v2, s60
v_and_b32 v135, 0xffff0000, v135
v_bfe_u32 v2, v136, 16, 1
v_add3_u32 v136, v136, v2, s60
v_and_b32 v136, 0xffff0000, v136
v_mul_f32 v2, 0x3fb8aa3b, v136
v_exp_f32 v2, v2
v_add_f32 v3, 1.0, v136
v_cmp_lt_f32 vcc, 0, v136
s_nop 1
v_cndmask_b32 v136, v2, v3, vcc
v_bfe_u32 v2, v136, 16, 1
v_add3_u32 v136, v136, v2, s60
v_and_b32 v136, 0xffff0000, v136
v_add_f32 v136, s61, v136
v_bfe_u32 v2, v136, 16, 1
v_add3_u32 v136, v136, v2, s60
v_and_b32 v136, 0xffff0000, v136
v_bfe_u32 v2, v137, 16, 1
v_add3_u32 v137, v137, v2, s60
v_and_b32 v137, 0xffff0000, v137
v_mul_f32 v2, 0x3fb8aa3b, v137
v_exp_f32 v2, v2
v_add_f32 v3, 1.0, v137
v_cmp_lt_f32 vcc, 0, v137
s_nop 1
v_cndmask_b32 v137, v2, v3, vcc
v_bfe_u32 v2, v137, 16, 1
v_add3_u32 v137, v137, v2, s60
v_and_b32 v137, 0xffff0000, v137
v_add_f32 v137, s61, v137
v_bfe_u32 v2, v137, 16, 1
v_add3_u32 v137, v137, v2, s60
v_and_b32 v137, 0xffff0000, v137
v_bfe_u32 v2, v138, 16, 1
v_add3_u32 v138, v138, v2, s60
v_and_b32 v138, 0xffff0000, v138
v_mul_f32 v2, 0x3fb8aa3b, v138
v_exp_f32 v2, v2
v_add_f32 v3, 1.0, v138
v_cmp_lt_f32 vcc, 0, v138
s_nop 1
v_cndmask_b32 v138, v2, v3, vcc
v_bfe_u32 v2, v138, 16, 1
v_add3_u32 v138, v138, v2, s60
v_and_b32 v138, 0xffff0000, v138
v_add_f32 v138, s61, v138
v_bfe_u32 v2, v138, 16, 1
v_add3_u32 v138, v138, v2, s60
v_and_b32 v138, 0xffff0000, v138
v_bfe_u32 v2, v139, 16, 1
v_add3_u32 v139, v139, v2, s60
v_and_b32 v139, 0xffff0000, v139
v_mul_f32 v2, 0x3fb8aa3b, v139
v_exp_f32 v2, v2
v_add_f32 v3, 1.0, v139
v_cmp_lt_f32 vcc, 0, v139
s_nop 1
v_cndmask_b32 v139, v2, v3, vcc
v_bfe_u32 v2, v139, 16, 1
v_add3_u32 v139, v139, v2, s60
v_and_b32 v139, 0xffff0000, v139
v_add_f32 v139, s61, v139
v_bfe_u32 v2, v139, 16, 1
v_add3_u32 v139, v139, v2, s60
v_and_b32 v139, 0xffff0000, v139
v_bfe_u32 v2, v140, 16, 1
v_add3_u32 v140, v140, v2, s60
v_and_b32 v140, 0xffff0000, v140
v_mul_f32 v2, 0x3fb8aa3b, v140
v_exp_f32 v2, v2
v_add_f32 v3, 1.0, v140
v_cmp_lt_f32 vcc, 0, v140
s_nop 1
v_cndmask_b32 v140, v2, v3, vcc
v_bfe_u32 v2, v140, 16, 1
v_add3_u32 v140, v140, v2, s60
v_and_b32 v140, 0xffff0000, v140
v_add_f32 v140, s61, v140
v_bfe_u32 v2, v140, 16, 1
v_add3_u32 v140, v140, v2, s60
v_and_b32 v140, 0xffff0000, v140
v_bfe_u32 v2, v141, 16, 1
v_add3_u32 v141, v141, v2, s60
v_and_b32 v141, 0xffff0000, v141
v_mul_f32 v2, 0x3fb8aa3b, v141
v_exp_f32 v2, v2
v_add_f32 v3, 1.0, v141
v_cmp_lt_f32 vcc, 0, v141
s_nop 1
v_cndmask_b32 v141, v2, v3, vcc
v_bfe_u32 v2, v141, 16, 1
v_add3_u32 v141, v141, v2, s60
v_and_b32 v141, 0xffff0000, v141
v_add_f32 v141, s61, v141
v_bfe_u32 v2, v141, 16, 1
v_add3_u32 v141, v141, v2, s60
v_and_b32 v141, 0xffff0000, v141
v_bfe_u32 v2, v142, 16, 1
v_add3_u32 v142, v142, v2, s60
v_and_b32 v142, 0xffff0000, v142
v_mul_f32 v2, 0x3fb8aa3b, v142
v_exp_f32 v2, v2
v_add_f32 v3, 1.0, v142
v_cmp_lt_f32 vcc, 0, v142
s_nop 1
v_cndmask_b32 v142, v2, v3, vcc
v_bfe_u32 v2, v142, 16, 1
v_add3_u32 v142, v142, v2, s60
v_and_b32 v142, 0xffff0000, v142
v_add_f32 v142, s61, v142
v_bfe_u32 v2, v142, 16, 1
v_add3_u32 v142, v142, v2, s60
v_and_b32 v142, 0xffff0000, v142
v_bfe_u32 v2, v143, 16, 1
v_add3_u32 v143, v143, v2, s60
v_and_b32 v143, 0xffff0000, v143
v_mul_f32 v2, 0x3fb8aa3b, v143
v_exp_f32 v2, v2
v_add_f32 v3, 1.0, v143
v_cmp_lt_f32 vcc, 0, v143
s_nop 1
v_cndmask_b32 v143, v2, v3, vcc
v_bfe_u32 v2, v143, 16, 1
v_add3_u32 v143, v143, v2, s60
v_and_b32 v143, 0xffff0000, v143
v_add_f32 v143, s61, v143
v_bfe_u32 v2, v143, 16, 1
v_add3_u32 v143, v143, v2, s60
v_and_b32 v143, 0xffff0000, v143
v_bfe_u32 v2, v144, 16, 1
v_add3_u32 v144, v144, v2, s60
v_and_b32 v144, 0xffff0000, v144
v_bfe_u32 v2, v145, 16, 1
v_add3_u32 v145, v145, v2, s60
v_and_b32 v145, 0xffff0000, v145
v_bfe_u32 v2, v146, 16, 1
v_add3_u32 v146, v146, v2, s60
v_and_b32 v146, 0xffff0000, v146
v_bfe_u32 v2, v147, 16, 1
v_add3_u32 v147, v147, v2, s60
v_and_b32 v147, 0xffff0000, v147
v_bfe_u32 v2, v148, 16, 1
v_add3_u32 v148, v148, v2, s60
v_and_b32 v148, 0xffff0000, v148
v_bfe_u32 v2, v149, 16, 1
v_add3_u32 v149, v149, v2, s60
v_and_b32 v149, 0xffff0000, v149
v_bfe_u32 v2, v150, 16, 1
v_add3_u32 v150, v150, v2, s60
v_and_b32 v150, 0xffff0000, v150
v_bfe_u32 v2, v151, 16, 1
v_add3_u32 v151, v151, v2, s60
v_and_b32 v151, 0xffff0000, v151
v_bfe_u32 v2, v152, 16, 1
v_add3_u32 v152, v152, v2, s60
v_and_b32 v152, 0xffff0000, v152
v_bfe_u32 v2, v153, 16, 1
v_add3_u32 v153, v153, v2, s60
v_and_b32 v153, 0xffff0000, v153
v_bfe_u32 v2, v154, 16, 1
v_add3_u32 v154, v154, v2, s60
v_and_b32 v154, 0xffff0000, v154
v_bfe_u32 v2, v155, 16, 1
v_add3_u32 v155, v155, v2, s60
v_and_b32 v155, 0xffff0000, v155
v_bfe_u32 v2, v156, 16, 1
v_add3_u32 v156, v156, v2, s60
v_and_b32 v156, 0xffff0000, v156
v_bfe_u32 v2, v157, 16, 1
v_add3_u32 v157, v157, v2, s60
v_and_b32 v157, 0xffff0000, v157
v_bfe_u32 v2, v158, 16, 1
v_add3_u32 v158, v158, v2, s60
v_and_b32 v158, 0xffff0000, v158
v_bfe_u32 v2, v159, 16, 1
v_add3_u32 v159, v159, v2, s60
v_and_b32 v159, 0xffff0000, v159
v_and_b32 v3, 31, v1
v_lshrrev_b32 v8, 5, v1
v_lshlrev_b32 v8, 8, v8
v_lshl_add_u32 v3, v3, 1, v8
v_add_u32 v3, s46, v3
ds_write_b16_d16_hi v3, v64 offset:0
ds_write_b16_d16_hi v3, v65 offset:64
ds_write_b16_d16_hi v3, v66 offset:128
ds_write_b16_d16_hi v3, v67 offset:192
ds_write_b16_d16_hi v3, v68 offset:512
ds_write_b16_d16_hi v3, v69 offset:576
ds_write_b16_d16_hi v3, v70 offset:640
ds_write_b16_d16_hi v3, v71 offset:704
ds_write_b16_d16_hi v3, v72 offset:1024
ds_write_b16_d16_hi v3, v73 offset:1088
ds_write_b16_d16_hi v3, v74 offset:1152
ds_write_b16_d16_hi v3, v75 offset:1216
ds_write_b16_d16_hi v3, v76 offset:1536
ds_write_b16_d16_hi v3, v77 offset:1600
ds_write_b16_d16_hi v3, v78 offset:1664
ds_write_b16_d16_hi v3, v79 offset:1728
ds_write_b16_d16_hi v3, v112 offset:2048
ds_write_b16_d16_hi v3, v113 offset:2112
ds_write_b16_d16_hi v3, v114 offset:2176
ds_write_b16_d16_hi v3, v115 offset:2240
ds_write_b16_d16_hi v3, v116 offset:2560
ds_write_b16_d16_hi v3, v117 offset:2624
ds_write_b16_d16_hi v3, v118 offset:2688
ds_write_b16_d16_hi v3, v119 offset:2752
ds_write_b16_d16_hi v3, v120 offset:3072
ds_write_b16_d16_hi v3, v121 offset:3136
ds_write_b16_d16_hi v3, v122 offset:3200
ds_write_b16_d16_hi v3, v123 offset:3264
ds_write_b16_d16_hi v3, v124 offset:3584
ds_write_b16_d16_hi v3, v125 offset:3648
ds_write_b16_d16_hi v3, v126 offset:3712
ds_write_b16_d16_hi v3, v127 offset:3776
s_waitcnt lgkmcnt(0)
v_lshlrev_b32 v3, 4, v1
v_add_u32 v3, s46, v3
ds_read_b128 v[20:23], v3 offset:0
v_add_u32 v8, 0, v1
v_lshrrev_b32 v9, 2, v8
v_and_b32 v8, 3, v8
s_lshl_b32 s23, s22, 8
s_lshl_b32 s48, s20, 6
s_add_u32 s23, s23, s48
v_add_u32 v9, s23, v9
v_lshlrev_b32 v9, 6, v9
v_lshl_add_u32 v9, v8, 4, v9
s_lshl_b32 s23, s21, 17
v_add_u32 v9, s23, v9
s_waitcnt lgkmcnt(0)
buffer_store_dwordx4 v[20:23], v9, s[16:19], 0 offen
s_nop 1
v_lshlrev_b32 v3, 4, v1
v_add_u32 v3, s46, v3
ds_read_b128 v[20:23], v3 offset:1024
v_add_u32 v8, 64, v1
v_lshrrev_b32 v9, 2, v8
v_and_b32 v8, 3, v8
s_lshl_b32 s23, s22, 8
s_lshl_b32 s48, s20, 6
s_add_u32 s23, s23, s48
v_add_u32 v9, s23, v9
v_lshlrev_b32 v9, 6, v9
v_lshl_add_u32 v9, v8, 4, v9
s_lshl_b32 s23, s21, 17
v_add_u32 v9, s23, v9
s_waitcnt lgkmcnt(0)
buffer_store_dwordx4 v[20:23], v9, s[16:19], 0 offen
s_nop 1
v_lshlrev_b32 v3, 4, v1
v_add_u32 v3, s46, v3
ds_read_b128 v[20:23], v3 offset:2048
v_add_u32 v8, 128, v1
v_lshrrev_b32 v9, 2, v8
v_and_b32 v8, 3, v8
s_lshl_b32 s23, s22, 8
s_lshl_b32 s48, s20, 6
s_add_u32 s23, s23, s48
v_add_u32 v9, s23, v9
v_lshlrev_b32 v9, 6, v9
v_lshl_add_u32 v9, v8, 4, v9
s_lshl_b32 s23, s21, 17
v_add_u32 v9, s23, v9
s_waitcnt lgkmcnt(0)
buffer_store_dwordx4 v[20:23], v9, s[16:19], 0 offen
s_nop 1
v_lshlrev_b32 v3, 4, v1
v_add_u32 v3, s46, v3
ds_read_b128 v[20:23], v3 offset:3072
v_add_u32 v8, 192, v1
v_lshrrev_b32 v9, 2, v8
v_and_b32 v8, 3, v8
s_lshl_b32 s23, s22, 8
s_lshl_b32 s48, s20, 6
s_add_u32 s23, s23, s48
v_add_u32 v9, s23, v9
v_lshlrev_b32 v9, 6, v9
v_lshl_add_u32 v9, v8, 4, v9
s_lshl_b32 s23, s21, 17
v_add_u32 v9, s23, v9
s_waitcnt lgkmcnt(0)
buffer_store_dwordx4 v[20:23], v9, s[16:19], 0 offen
s_nop 1
v_mov_b32 v20, 0
v_mov_b32 v21, 0
v_mov_b32 v22, 0
v_mov_b32 v23, 0
v_mov_b32 v24, 0
v_mov_b32 v25, 0
v_mov_b32 v26, 0
v_mov_b32 v27, 0
v_mov_b32 v28, 0
v_mov_b32 v29, 0
v_mov_b32 v30, 0
v_mov_b32 v31, 0
v_mov_b32 v32, 0
v_mov_b32 v33, 0
v_mov_b32 v34, 0
v_mov_b32 v35, 0
v_mov_b32 v36, 0
v_mov_b32 v37, 0
v_mov_b32 v38, 0
v_mov_b32 v39, 0
v_mov_b32 v40, 0
v_mov_b32 v41, 0
v_mov_b32 v42, 0
v_mov_b32 v43, 0
v_mov_b32 v44, 0
v_mov_b32 v45, 0
v_mov_b32 v46, 0
v_mov_b32 v47, 0
v_mov_b32 v48, 0
v_mov_b32 v49, 0
v_mov_b32 v50, 0
v_mov_b32 v51, 0
v_mov_b32 v52, 0x3f803f80
v_mov_b32 v53, 0x3f803f80
v_mov_b32 v54, 0x3f803f80
v_mov_b32 v55, 0x3f803f80
v_lshrrev_b32 v56, 16, v80
v_or_b32 v56, v81, v56
v_lshrrev_b32 v60, 16, v96
v_or_b32 v60, v97, v60
v_lshrrev_b32 v57, 16, v82
v_or_b32 v57, v83, v57
v_lshrrev_b32 v61, 16, v98
v_or_b32 v61, v99, v61
v_lshrrev_b32 v58, 16, v84
v_or_b32 v58, v85, v58
v_lshrrev_b32 v62, 16, v100
v_or_b32 v62, v101, v62
v_lshrrev_b32 v59, 16, v86
v_or_b32 v59, v87, v59
v_lshrrev_b32 v63, 16, v102
v_or_b32 v63, v103, v63
s_nop 1
v_mfma_f32_32x32x16_bf16 v[20:35], v[56:59], v[60:63], v[20:35]
v_mfma_f32_32x32x16_bf16 v[36:51], v[56:59], v[52:55], v[36:51]
s_nop 7
v_lshrrev_b32 v56, 16, v88
v_or_b32 v56, v89, v56
v_lshrrev_b32 v60, 16, v104
v_or_b32 v60, v105, v60
v_lshrrev_b32 v57, 16, v90
v_or_b32 v57, v91, v57
v_lshrrev_b32 v61, 16, v106
v_or_b32 v61, v107, v61
v_lshrrev_b32 v58, 16, v92
v_or_b32 v58, v93, v58
v_lshrrev_b32 v62, 16, v108
v_or_b32 v62, v109, v62
v_lshrrev_b32 v59, 16, v94
v_or_b32 v59, v95, v59
v_lshrrev_b32 v63, 16, v110
v_or_b32 v63, v111, v63
s_nop 1
v_mfma_f32_32x32x16_bf16 v[20:35], v[56:59], v[60:63], v[20:35]
v_mfma_f32_32x32x16_bf16 v[36:51], v[56:59], v[52:55], v[36:51]
s_nop 7
v_lshrrev_b32 v56, 16, v128
v_or_b32 v56, v129, v56
v_lshrrev_b32 v60, 16, v144
v_or_b32 v60, v145, v60
v_lshrrev_b32 v57, 16, v130
v_or_b32 v57, v131, v57
v_lshrrev_b32 v61, 16, v146
v_or_b32 v61, v147, v61
v_lshrrev_b32 v58, 16, v132
v_or_b32 v58, v133, v58
v_lshrrev_b32 v62, 16, v148
v_or_b32 v62, v149, v62
v_lshrrev_b32 v59, 16, v134
v_or_b32 v59, v135, v59
v_lshrrev_b32 v63, 16, v150
v_or_b32 v63, v151, v63
s_nop 1
v_mfma_f32_32x32x16_bf16 v[20:35], v[56:59], v[60:63], v[20:35]
v_mfma_f32_32x32x16_bf16 v[36:51], v[56:59], v[52:55], v[36:51]
s_nop 7
v_lshrrev_b32 v56, 16, v136
v_or_b32 v56, v137, v56
v_lshrrev_b32 v60, 16, v152
v_or_b32 v60, v153, v60
v_lshrrev_b32 v57, 16, v138
v_or_b32 v57, v139, v57
v_lshrrev_b32 v61, 16, v154
v_or_b32 v61, v155, v61
v_lshrrev_b32 v58, 16, v140
v_or_b32 v58, v141, v58
v_lshrrev_b32 v62, 16, v156
v_or_b32 v62, v157, v62
v_lshrrev_b32 v59, 16, v142
v_or_b32 v59, v143, v59
v_lshrrev_b32 v63, 16, v158
v_or_b32 v63, v159, v63
s_nop 1
v_mfma_f32_32x32x16_bf16 v[20:35], v[56:59], v[60:63], v[20:35]
v_mfma_f32_32x32x16_bf16 v[36:51], v[56:59], v[52:55], v[36:51]
s_nop 7
s_nop 7
s_nop 7
s_barrier
s_mul_i32 s48, s20, 4352
s_add_u32 s48, s48, 16384
v_and_b32 v3, 31, v1
v_lshrrev_b32 v8, 5, v1
v_lshlrev_b32 v8, 9, v8
v_lshl_add_u32 v3, v3, 2, v8
v_add_u32 v3, s48, v3
ds_write_b32 v3, v20 offset:0
ds_write_b32 v3, v21 offset:128
ds_write_b32 v3, v22 offset:256
ds_write_b32 v3, v23 offset:384
ds_write_b32 v3, v24 offset:1024
ds_write_b32 v3, v25 offset:1152
ds_write_b32 v3, v26 offset:1280
ds_write_b32 v3, v27 offset:1408
ds_write_b32 v3, v28 offset:2048
ds_write_b32 v3, v29 offset:2176
ds_write_b32 v3, v30 offset:2304
ds_write_b32 v3, v31 offset:2432
ds_write_b32 v3, v32 offset:3072
ds_write_b32 v3, v33 offset:3200
ds_write_b32 v3, v34 offset:3328
ds_write_b32 v3, v35 offset:3456
v_and_b32 v9, 31, v1
v_cmp_eq_u32 vcc, 0, v9
s_and_saveexec_b64 s[54:55], vcc
v_lshrrev_b32 v8, 5, v1
v_lshlrev_b32 v8, 4, v8
v_add_u32 v8, s48, v8
ds_write_b32 v8, v36 offset:4096
ds_write_b32 v8, v37 offset:4100
ds_write_b32 v8, v38 offset:4104
ds_write_b32 v8, v39 offset:4108
ds_write_b32 v8, v40 offset:4128
ds_write_b32 v8, v41 offset:4132
ds_write_b32 v8, v42 offset:4136
ds_write_b32 v8, v43 offset:4140
ds_write_b32 v8, v44 offset:4160
ds_write_b32 v8, v45 offset:4164
ds_write_b32 v8, v46 offset:4168
ds_write_b32 v8, v47 offset:4172
ds_write_b32 v8, v48 offset:4192
ds_write_b32 v8, v49 offset:4196
ds_write_b32 v8, v50 offset:4200
ds_write_b32 v8, v51 offset:4204
s_mov_b64 exec, s[54:55]
s_waitcnt lgkmcnt(0)
s_barrier
s_mul_i32 s48, s22, 32
s_add_u32 s48, s48, s21
s_mul_i32 s48, s48, 4224
s_add_u32 s48, s48, 4194304
v_add_u32 v3, 0, v0
v_cmp_gt_u32 vcc, 1056, v3
s_and_saveexec_b64 s[54:55], vcc
v_lshlrev_b32 v3, 2, v3
ds_read_b32 v20, v3 offset:16384
ds_read_b32 v21, v3 offset:20736
ds_read_b32 v22, v3 offset:25088
ds_read_b32 v23, v3 offset:29440
s_waitcnt lgkmcnt(0)
v_add_f32 v20, v20, v21
v_add_f32 v22, v22, v23
v_add_f32 v20, v20, v22
v_add_u32 v3, s48, v3
buffer_store_dword v20, v3, s[16:19], 0 offen
s_mov_b64 exec, s[54:55]
v_add_u32 v3, 256, v0
v_cmp_gt_u32 vcc, 1056, v3
s_and_saveexec_b64 s[54:55], vcc
v_lshlrev_b32 v3, 2, v3
ds_read_b32 v20, v3 offset:16384
ds_read_b32 v21, v3 offset:20736
ds_read_b32 v22, v3 offset:25088
ds_read_b32 v23, v3 offset:29440
s_waitcnt lgkmcnt(0)
v_add_f32 v20, v20, v21
v_add_f32 v22, v22, v23
v_add_f32 v20, v20, v22
v_add_u32 v3, s48, v3
buffer_store_dword v20, v3, s[16:19], 0 offen
s_mov_b64 exec, s[54:55]
v_add_u32 v3, 512, v0
v_cmp_gt_u32 vcc, 1056, v3
s_and_saveexec_b64 s[54:55], vcc
v_lshlrev_b32 v3, 2, v3
ds_read_b32 v20, v3 offset:16384
ds_read_b32 v21, v3 offset:20736
ds_read_b32 v22, v3 offset:25088
ds_read_b32 v23, v3 offset:29440
s_waitcnt lgkmcnt(0)
v_add_f32 v20, v20, v21
v_add_f32 v22, v22, v23
v_add_f32 v20, v20, v22
v_add_u32 v3, s48, v3
buffer_store_dword v20, v3, s[16:19], 0 offen
s_mov_b64 exec, s[54:55]
v_add_u32 v3, 768, v0
v_cmp_gt_u32 vcc, 1056, v3
s_and_saveexec_b64 s[54:55], vcc
v_lshlrev_b32 v3, 2, v3
ds_read_b32 v20, v3 offset:16384
ds_read_b32 v21, v3 offset:20736
ds_read_b32 v22, v3 offset:25088
ds_read_b32 v23, v3 offset:29440
s_waitcnt lgkmcnt(0)
v_add_f32 v20, v20, v21
v_add_f32 v22, v22, v23
v_add_f32 v20, v20, v22
v_add_u32 v3, s48, v3
buffer_store_dword v20, v3, s[16:19], 0 offen
s_mov_b64 exec, s[54:55]
v_add_u32 v3, 1024, v0
v_cmp_gt_u32 vcc, 1056, v3
s_and_saveexec_b64 s[54:55], vcc
v_lshlrev_b32 v3, 2, v3
ds_read_b32 v20, v3 offset:16384
ds_read_b32 v21, v3 offset:20736
ds_read_b32 v22, v3 offset:25088
ds_read_b32 v23, v3 offset:29440
s_waitcnt lgkmcnt(0)
v_add_f32 v20, v20, v21
v_add_f32 v22, v22, v23
v_add_f32 v20, v20, v22
v_add_u32 v3, s48, v3
buffer_store_dword v20, v3, s[16:19], 0 offen
s_mov_b64 exec, s[54:55]
s_branch K1_END
K1_KGEN:
s_sub_u32 s21, s2, 256
s_lshl_b32 s21, s21, 2
s_add_u32 s21, s21, s20
s_lshl_b32 s22, s21, 8
s_mul_i32 s46, s20, 16896
s_mov_b32 s8, s38
s_and_b32 s9, s39, 0xffff
s_mov_b32 s10, 2048
s_mov_b32 s11, 0x20000
s_lshl_b32 s23, s21, 1
v_mov_b32 v2, s23
buffer_load_ushort v2, v2, s[8:11], 0 offen
s_mov_b32 s8, s26
s_and_b32 s9, s27, 0xffff
s_mov_b32 s10, 262144
s_mov_b32 s11, 0x20000
v_lshl_add_u32 v3, v1, 1, s22
buffer_load_ushort v64, v3, s[8:11], 0 offen offset:0
v_lshl_add_u32 v3, v1, 1, s22
buffer_load_ushort v72, v3, s[8:11], 0 offen offset:128
s_mov_b32 s8, s28
s_and_b32 s9, s29, 0xffff
s_mov_b32 s10, 262144
s_mov_b32 s11, 0x20000
v_lshl_add_u32 v3, v1, 1, s22
buffer_load_ushort v65, v3, s[8:11], 0 offen offset:0
v_lshl_add_u32 v3, v1, 1, s22
buffer_load_ushort v73, v3, s[8:11], 0 offen offset:128
s_mov_b32 s8, s30
s_and_b32 s9, s31, 0xffff
s_mov_b32 s10, 262144
s_mov_b32 s11, 0x20000
v_lshl_add_u32 v3, v1, 1, s22
buffer_load_ushort v66, v3, s[8:11], 0 offen offset:0
v_lshl_add_u32 v3, v1, 1, s22
buffer_load_ushort v74, v3, s[8:11], 0 offen offset:128
s_mov_b32 s8, s32
s_and_b32 s9, s33, 0xffff
s_mov_b32 s10, 262144
s_mov_b32 s11, 0x20000
v_lshl_add_u32 v3, v1, 1, s22
buffer_load_ushort v67, v3, s[8:11], 0 offen offset:0
v_lshl_add_u32 v3, v1, 1, s22
buffer_load_ushort v75, v3, s[8:11], 0 offen offset:128
s_mov_b32 s8, s34
s_and_b32 s9, s35, 0xffff
s_mov_b32 s10, 262144
s_mov_b32 s11, 0x20000
v_lshl_add_u32 v3, v1, 1, s22
buffer_load_ushort v68, v3, s[8:11], 0 offen offset:0
v_lshl_add_u32 v3, v1, 1, s22
buffer_load_ushort v76, v3, s[8:11], 0 offen offset:128
s_mov_b32 s8, s36
s_and_b32 s9, s37, 0xffff
s_mov_b32 s10, 262144
s_mov_b32 s11, 0x20000
v_lshl_add_u32 v3, v1, 1, s22
buffer_load_ushort v69, v3, s[8:11], 0 offen offset:0
v_lshl_add_u32 v3, v1, 1, s22
buffer_load_ushort v77, v3, s[8:11], 0 offen offset:128
s_waitcnt vmcnt(0)
v_lshlrev_b32 v2, 16, v2
v_mul_f32 v2, 0x3fb8aa3b, v2
v_exp_f32 v2, v2
s_nop 0
v_bfe_u32 v3, v2, 16, 1
v_add3_u32 v2, v2, v3, s60
v_and_b32 v2, 0xffff0000, v2
v_lshlrev_b32 v64, 16, v64
v_lshlrev_b32 v65, 16, v65
v_lshlrev_b32 v66, 16, v66
v_lshlrev_b32 v67, 16, v67
v_lshlrev_b32 v68, 16, v68
v_lshlrev_b32 v69, 16, v69
v_mul_f32 v64, v2, v64
v_mul_f32 v65, v2, v65
v_mul_f32 v66, v2, v66
v_mul_f32 v67, v2, v67
v_mul_f32 v70, v68, v66
v_fma_f32 v70, -v69, v67, v70
v_mul_f32 v71, v68, v67
v_fma_f32 v71, v69, v66, v71
v_lshlrev_b32 v72, 16, v72
v_lshlrev_b32 v73, 16, v73
v_lshlrev_b32 v74, 16, v74
v_lshlrev_b32 v75, 16, v75
v_lshlrev_b32 v76, 16, v76
v_lshlrev_b32 v77, 16, v77
v_mul_f32 v72, v2, v72
v_mul_f32 v73, v2, v73
v_mul_f32 v74, v2, v74
v_mul_f32 v75, v2, v75
v_mul_f32 v78, v76, v74
v_fma_f32 v78, -v77, v75, v78
v_mul_f32 v79, v76, v75
v_fma_f32 v79, v77, v74, v79
v_lshl_add_u32 v8, v1, 2, s46
v_and_b32 v9, 15, v1
v_mul_u32_u24 v9, 528, v9
v_lshrrev_b32 v3, 4, v1
v_lshl_add_u32 v9, v3, 4, v9
v_add_u32 v9, s46, v9
v_mul_f32 v4, 1.0, v64
v_mul_f32 v5, 1.0, v65
v_mul_f32 v4, 0x3fb8aa3b, v4
v_mul_f32 v5, 0x3e22f983, v5
v_exp_f32 v4, v4
v_fract_f32 v5, v5
v_cos_f32 v10, v5
v_sin_f32 v11, v5
s_nop 0
v_mul_f32 v10, v4, v10
v_mul_f32 v11, v4, v11
s_mov_b32 s23, 0x41800000
v_mul_f32 v4, s23, v64
v_mul_f32 v5, s23, v65
v_mul_f32 v4, 0x3fb8aa3b, v4
v_mul_f32 v5, 0x3e22f983, v5
v_exp_f32 v4, v4
v_fract_f32 v5, v5
v_cos_f32 v12, v5
v_sin_f32 v13, v5
s_nop 0
v_mul_f32 v12, v4, v12
v_mul_f32 v13, v4, v13
v_mov_b32 v14, v70
v_mov_b32 v15, v71
v_mov_b32 v16, 1.0
v_mov_b32 v17, 0
v_cvt_pk_bf16_f32 v18, v16, v17
ds_write_b32 v8, v18 offset:8448
v_mul_f32 v6, v16, v10
v_fma_f32 v6, -v17, v11, v6
v_mul_f32 v7, v16, v11
v_fma_f32 v17, v17, v10, v7
v_mov_b32 v16, v6
v_cvt_pk_bf16_f32 v18, v16, v17
ds_write_b32 v8, v18 offset:8976
v_mul_f32 v6, v16, v10
v_fma_f32 v6, -v17, v11, v6
v_mul_f32 v7, v16, v11
v_fma_f32 v17, v17, v10, v7
v_mov_b32 v16, v6
v_cvt_pk_bf16_f32 v18, v16, v17
ds_write_b32 v8, v18 offset:9504
v_mul_f32 v6, v16, v10
v_fma_f32 v6, -v17, v11, v6
v_mul_f32 v7, v16, v11
v_fma_f32 v17, v17, v10, v7
v_mov_b32 v16, v6
v_cvt_pk_bf16_f32 v18, v16, v17
ds_write_b32 v8, v18 offset:10032
v_mul_f32 v6, v16, v10
v_fma_f32 v6, -v17, v11, v6
v_mul_f32 v7, v16, v11
v_fma_f32 v17, v17, v10, v7
v_mov_b32 v16, v6
v_cvt_pk_bf16_f32 v18, v16, v17
ds_write_b32 v8, v18 offset:10560
v_mul_f32 v6, v16, v10
v_fma_f32 v6, -v17, v11, v6
v_mul_f32 v7, v16, v11
v_fma_f32 v17, v17, v10, v7
v_mov_b32 v16, v6
v_cvt_pk_bf16_f32 v18, v16, v17
ds_write_b32 v8, v18 offset:11088
v_mul_f32 v6, v16, v10
v_fma_f32 v6, -v17, v11, v6
v_mul_f32 v7, v16, v11
v_fma_f32 v17, v17, v10, v7
v_mov_b32 v16, v6
v_cvt_pk_bf16_f32 v18, v16, v17
ds_write_b32 v8, v18 offset:11616
v_mul_f32 v6, v16, v10
v_fma_f32 v6, -v17, v11, v6
v_mul_f32 v7, v16, v11
v_fma_f32 v17, v17, v10, v7
v_mov_b32 v16, v6
v_cvt_pk_bf16_f32 v18, v16, v17
ds_write_b32 v8, v18 offset:12144
v_mul_f32 v6, v16, v10
v_fma_f32 v6, -v17, v11, v6
v_mul_f32 v7, v16, v11
v_fma_f32 v17, v17, v10, v7
v_mov_b32 v16, v6
v_cvt_pk_bf16_f32 v18, v16, v17
ds_write_b32 v8, v18 offset:12672
v_mul_f32 v6, v16, v10
v_fma_f32 v6, -v17, v11, v6
v_mul_f32 v7, v16, v11
v_fma_f32 v17, v17, v10, v7
v_mov_b32 v16, v6
v_cvt_pk_bf16_f32 v18, v16, v17
ds_write_b32 v8, v18 offset:13200
v_mul_f32 v6, v16, v10
v_fma_f32 v6, -v17, v11, v6
v_mul_f32 v7, v16, v11
v_fma_f32 v17, v17, v10, v7
v_mov_b32 v16, v6
v_cvt_pk_bf16_f32 v18, v16, v17
ds_write_b32 v8, v18 offset:13728
v_mul_f32 v6, v16, v10
v_fma_f32 v6, -v17, v11, v6
v_mul_f32 v7, v16, v11
v_fma_f32 v17, v17, v10, v7
v_mov_b32 v16, v6
v_cvt_pk_bf16_f32 v18, v16, v17
ds_write_b32 v8, v18 offset:14256
v_mul_f32 v6, v16, v10
v_fma_f32 v6, -v17, v11, v6
v_mul_f32 v7, v16, v11
v_fma_f32 v17, v17, v10, v7
v_mov_b32 v16, v6
v_cvt_pk_bf16_f32 v18, v16, v17
ds_write_b32 v8, v18 offset:14784
v_mul_f32 v6, v16, v10
v_fma_f32 v6, -v17, v11, v6
v_mul_f32 v7, v16, v11
v_fma_f32 v17, v17, v10, v7
v_mov_b32 v16, v6
v_cvt_pk_bf16_f32 v18, v16, v17
ds_write_b32 v8, v18 offset:15312
v_mul_f32 v6, v16, v10
v_fma_f32 v6, -v17, v11, v6
v_mul_f32 v7, v16, v11
v_fma_f32 v17, v17, v10, v7
v_mov_b32 v16, v6
v_cvt_pk_bf16_f32 v18, v16, v17
ds_write_b32 v8, v18 offset:15840
v_mul_f32 v6, v16, v10
v_fma_f32 v6, -v17, v11, v6
v_mul_f32 v7, v16, v11
v_fma_f32 v17, v17, v10, v7
v_mov_b32 v16, v6
v_cvt_pk_bf16_f32 v18, v16, v17
ds_write_b32 v8, v18 offset:16368
v_sub_f32 v19, 0, v15
v_cvt_pk_bf16_f32 v18, v14, v19
ds_write_b32 v8, v18 offset:0
v_mul_f32 v6, v14, v12
v_fma_f32 v6, -v15, v13, v6
v_mul_f32 v7, v14, v13
v_fma_f32 v15, v15, v12, v7
v_mov_b32 v14, v6
v_sub_f32 v19, 0, v15
v_cvt_pk_bf16_f32 v18, v14, v19
ds_write_b32 v8, v18 offset:528
v_mul_f32 v6, v14, v12
v_fma_f32 v6, -v15, v13, v6
v_mul_f32 v7, v14, v13
v_fma_f32 v15, v15, v12, v7
v_mov_b32 v14, v6
v_sub_f32 v19, 0, v15
v_cvt_pk_bf16_f32 v18, v14, v19
ds_write_b32 v8, v18 offset:1056
v_mul_f32 v6, v14, v12
v_fma_f32 v6, -v15, v13, v6
v_mul_f32 v7, v14, v13
v_fma_f32 v15, v15, v12, v7
v_mov_b32 v14, v6
v_sub_f32 v19, 0, v15
v_cvt_pk_bf16_f32 v18, v14, v19
ds_write_b32 v8, v18 offset:1584
v_mul_f32 v6, v14, v12
v_fma_f32 v6, -v15, v13, v6
v_mul_f32 v7, v14, v13
v_fma_f32 v15, v15, v12, v7
v_mov_b32 v14, v6
v_sub_f32 v19, 0, v15
v_cvt_pk_bf16_f32 v18, v14, v19
ds_write_b32 v8, v18 offset:2112
v_mul_f32 v6, v14, v12
v_fma_f32 v6, -v15, v13, v6
v_mul_f32 v7, v14, v13
v_fma_f32 v15, v15, v12, v7
v_mov_b32 v14, v6
v_sub_f32 v19, 0, v15
v_cvt_pk_bf16_f32 v18, v14, v19
ds_write_b32 v8, v18 offset:2640
v_mul_f32 v6, v14, v12
v_fma_f32 v6, -v15, v13, v6
v_mul_f32 v7, v14, v13
v_fma_f32 v15, v15, v12, v7
v_mov_b32 v14, v6
v_sub_f32 v19, 0, v15
v_cvt_pk_bf16_f32 v18, v14, v19
ds_write_b32 v8, v18 offset:3168
v_mul_f32 v6, v14, v12
v_fma_f32 v6, -v15, v13, v6
v_mul_f32 v7, v14, v13
v_fma_f32 v15, v15, v12, v7
v_mov_b32 v14, v6
v_sub_f32 v19, 0, v15
v_cvt_pk_bf16_f32 v18, v14, v19
ds_write_b32 v8, v18 offset:3696
v_mul_f32 v6, v14, v12
v_fma_f32 v6, -v15, v13, v6
v_mul_f32 v7, v14, v13
v_fma_f32 v15, v15, v12, v7
v_mov_b32 v14, v6
v_sub_f32 v19, 0, v15
v_cvt_pk_bf16_f32 v18, v14, v19
ds_write_b32 v8, v18 offset:4224
v_mul_f32 v6, v14, v12
v_fma_f32 v6, -v15, v13, v6
v_mul_f32 v7, v14, v13
v_fma_f32 v15, v15, v12, v7
v_mov_b32 v14, v6
v_sub_f32 v19, 0, v15
v_cvt_pk_bf16_f32 v18, v14, v19
ds_write_b32 v8, v18 offset:4752
v_mul_f32 v6, v14, v12
v_fma_f32 v6, -v15, v13, v6
v_mul_f32 v7, v14, v13
v_fma_f32 v15, v15, v12, v7
v_mov_b32 v14, v6
v_sub_f32 v19, 0, v15
v_cvt_pk_bf16_f32 v18, v14, v19
ds_write_b32 v8, v18 offset:5280
v_mul_f32 v6, v14, v12
v_fma_f32 v6, -v15, v13, v6
v_mul_f32 v7, v14, v13
v_fma_f32 v15, v15, v12, v7
v_mov_b32 v14, v6
v_sub_f32 v19, 0, v15
v_cvt_pk_bf16_f32 v18, v14, v19
ds_write_b32 v8, v18 offset:5808
v_mul_f32 v6, v14, v12
v_fma_f32 v6, -v15, v13, v6
v_mul_f32 v7, v14, v13
v_fma_f32 v15, v15, v12, v7
v_mov_b32 v14, v6
v_sub_f32 v19, 0, v15
v_cvt_pk_bf16_f32 v18, v14, v19
ds_write_b32 v8, v18 offset:6336
v_mul_f32 v6, v14, v12
v_fma_f32 v6, -v15, v13, v6
v_mul_f32 v7, v14, v13
v_fma_f32 v15, v15, v12, v7
v_mov_b32 v14, v6
v_sub_f32 v19, 0, v15
v_cvt_pk_bf16_f32 v18, v14, v19
ds_write_b32 v8, v18 offset:6864
v_mul_f32 v6, v14, v12
v_fma_f32 v6, -v15, v13, v6
v_mul_f32 v7, v14, v13
v_fma_f32 v15, v15, v12, v7
v_mov_b32 v14, v6
v_sub_f32 v19, 0, v15
v_cvt_pk_bf16_f32 v18, v14, v19
ds_write_b32 v8, v18 offset:7392
v_mul_f32 v6, v14, v12
v_fma_f32 v6, -v15, v13, v6
v_mul_f32 v7, v14, v13
v_fma_f32 v15, v15, v12, v7
v_mov_b32 v14, v6
v_sub_f32 v19, 0, v15
v_cvt_pk_bf16_f32 v18, v14, v19
ds_write_b32 v8, v18 offset:7920
v_mul_f32 v4, 1.0, v72
v_mul_f32 v5, 1.0, v73
v_mul_f32 v4, 0x3fb8aa3b, v4
v_mul_f32 v5, 0x3e22f983, v5
v_exp_f32 v4, v4
v_fract_f32 v5, v5
v_cos_f32 v10, v5
v_sin_f32 v11, v5
s_nop 0
v_mul_f32 v10, v4, v10
v_mul_f32 v11, v4, v11
s_mov_b32 s23, 0x41800000
v_mul_f32 v4, s23, v72
v_mul_f32 v5, s23, v73
v_mul_f32 v4, 0x3fb8aa3b, v4
v_mul_f32 v5, 0x3e22f983, v5
v_exp_f32 v4, v4
v_fract_f32 v5, v5
v_cos_f32 v12, v5
v_sin_f32 v13, v5
s_nop 0
v_mul_f32 v12, v4, v12
v_mul_f32 v13, v4, v13
v_mov_b32 v14, v78
v_mov_b32 v15, v79
v_mov_b32 v16, 1.0
v_mov_b32 v17, 0
v_cvt_pk_bf16_f32 v18, v16, v17
ds_write_b32 v8, v18 offset:8704
v_mul_f32 v6, v16, v10
v_fma_f32 v6, -v17, v11, v6
v_mul_f32 v7, v16, v11
v_fma_f32 v17, v17, v10, v7
v_mov_b32 v16, v6
v_cvt_pk_bf16_f32 v18, v16, v17
ds_write_b32 v8, v18 offset:9232
v_mul_f32 v6, v16, v10
v_fma_f32 v6, -v17, v11, v6
v_mul_f32 v7, v16, v11
v_fma_f32 v17, v17, v10, v7
v_mov_b32 v16, v6
v_cvt_pk_bf16_f32 v18, v16, v17
ds_write_b32 v8, v18 offset:9760
v_mul_f32 v6, v16, v10
v_fma_f32 v6, -v17, v11, v6
v_mul_f32 v7, v16, v11
v_fma_f32 v17, v17, v10, v7
v_mov_b32 v16, v6
v_cvt_pk_bf16_f32 v18, v16, v17
ds_write_b32 v8, v18 offset:10288
v_mul_f32 v6, v16, v10
v_fma_f32 v6, -v17, v11, v6
v_mul_f32 v7, v16, v11
v_fma_f32 v17, v17, v10, v7
v_mov_b32 v16, v6
v_cvt_pk_bf16_f32 v18, v16, v17
ds_write_b32 v8, v18 offset:10816
v_mul_f32 v6, v16, v10
v_fma_f32 v6, -v17, v11, v6
v_mul_f32 v7, v16, v11
v_fma_f32 v17, v17, v10, v7
v_mov_b32 v16, v6
v_cvt_pk_bf16_f32 v18, v16, v17
ds_write_b32 v8, v18 offset:11344
v_mul_f32 v6, v16, v10
v_fma_f32 v6, -v17, v11, v6
v_mul_f32 v7, v16, v11
v_fma_f32 v17, v17, v10, v7
v_mov_b32 v16, v6
v_cvt_pk_bf16_f32 v18, v16, v17
ds_write_b32 v8, v18 offset:11872
v_mul_f32 v6, v16, v10
v_fma_f32 v6, -v17, v11, v6
v_mul_f32 v7, v16, v11
v_fma_f32 v17, v17, v10, v7
v_mov_b32 v16, v6
v_cvt_pk_bf16_f32 v18, v16, v17
ds_write_b32 v8, v18 offset:12400
v_mul_f32 v6, v16, v10
v_fma_f32 v6, -v17, v11, v6
v_mul_f32 v7, v16, v11
v_fma_f32 v17, v17, v10, v7
v_mov_b32 v16, v6
v_cvt_pk_bf16_f32 v18, v16, v17
ds_write_b32 v8, v18 offset:12928
v_mul_f32 v6, v16, v10
v_fma_f32 v6, -v17, v11, v6
v_mul_f32 v7, v16, v11
v_fma_f32 v17, v17, v10, v7
v_mov_b32 v16, v6
v_cvt_pk_bf16_f32 v18, v16, v17
ds_write_b32 v8, v18 offset:13456
v_mul_f32 v6, v16, v10
v_fma_f32 v6, -v17, v11, v6
v_mul_f32 v7, v16, v11
v_fma_f32 v17, v17, v10, v7
v_mov_b32 v16, v6
v_cvt_pk_bf16_f32 v18, v16, v17
ds_write_b32 v8, v18 offset:13984
v_mul_f32 v6, v16, v10
v_fma_f32 v6, -v17, v11, v6
v_mul_f32 v7, v16, v11
v_fma_f32 v17, v17, v10, v7
v_mov_b32 v16, v6
v_cvt_pk_bf16_f32 v18, v16, v17
ds_write_b32 v8, v18 offset:14512
v_mul_f32 v6, v16, v10
v_fma_f32 v6, -v17, v11, v6
v_mul_f32 v7, v16, v11
v_fma_f32 v17, v17, v10, v7
v_mov_b32 v16, v6
v_cvt_pk_bf16_f32 v18, v16, v17
ds_write_b32 v8, v18 offset:15040
v_mul_f32 v6, v16, v10
v_fma_f32 v6, -v17, v11, v6
v_mul_f32 v7, v16, v11
v_fma_f32 v17, v17, v10, v7
v_mov_b32 v16, v6
v_cvt_pk_bf16_f32 v18, v16, v17
ds_write_b32 v8, v18 offset:15568
v_mul_f32 v6, v16, v10
v_fma_f32 v6, -v17, v11, v6
v_mul_f32 v7, v16, v11
v_fma_f32 v17, v17, v10, v7
v_mov_b32 v16, v6
v_cvt_pk_bf16_f32 v18, v16, v17
ds_write_b32 v8, v18 offset:16096
v_mul_f32 v6, v16, v10
v_fma_f32 v6, -v17, v11, v6
v_mul_f32 v7, v16, v11
v_fma_f32 v17, v17, v10, v7
v_mov_b32 v16, v6
v_cvt_pk_bf16_f32 v18, v16, v17
ds_write_b32 v8, v18 offset:16624
v_sub_f32 v19, 0, v15
v_cvt_pk_bf16_f32 v18, v14, v19
ds_write_b32 v8, v18 offset:256
v_mul_f32 v6, v14, v12
v_fma_f32 v6, -v15, v13, v6
v_mul_f32 v7, v14, v13
v_fma_f32 v15, v15, v12, v7
v_mov_b32 v14, v6
v_sub_f32 v19, 0, v15
v_cvt_pk_bf16_f32 v18, v14, v19
ds_write_b32 v8, v18 offset:784
v_mul_f32 v6, v14, v12
v_fma_f32 v6, -v15, v13, v6
v_mul_f32 v7, v14, v13
v_fma_f32 v15, v15, v12, v7
v_mov_b32 v14, v6
v_sub_f32 v19, 0, v15
v_cvt_pk_bf16_f32 v18, v14, v19
ds_write_b32 v8, v18 offset:1312
v_mul_f32 v6, v14, v12
v_fma_f32 v6, -v15, v13, v6
v_mul_f32 v7, v14, v13
v_fma_f32 v15, v15, v12, v7
v_mov_b32 v14, v6
v_sub_f32 v19, 0, v15
v_cvt_pk_bf16_f32 v18, v14, v19
ds_write_b32 v8, v18 offset:1840
v_mul_f32 v6, v14, v12
v_fma_f32 v6, -v15, v13, v6
v_mul_f32 v7, v14, v13
v_fma_f32 v15, v15, v12, v7
v_mov_b32 v14, v6
v_sub_f32 v19, 0, v15
v_cvt_pk_bf16_f32 v18, v14, v19
ds_write_b32 v8, v18 offset:2368
v_mul_f32 v6, v14, v12
v_fma_f32 v6, -v15, v13, v6
v_mul_f32 v7, v14, v13
v_fma_f32 v15, v15, v12, v7
v_mov_b32 v14, v6
v_sub_f32 v19, 0, v15
v_cvt_pk_bf16_f32 v18, v14, v19
ds_write_b32 v8, v18 offset:2896
v_mul_f32 v6, v14, v12
v_fma_f32 v6, -v15, v13, v6
v_mul_f32 v7, v14, v13
v_fma_f32 v15, v15, v12, v7
v_mov_b32 v14, v6
v_sub_f32 v19, 0, v15
v_cvt_pk_bf16_f32 v18, v14, v19
ds_write_b32 v8, v18 offset:3424
v_mul_f32 v6, v14, v12
v_fma_f32 v6, -v15, v13, v6
v_mul_f32 v7, v14, v13
v_fma_f32 v15, v15, v12, v7
v_mov_b32 v14, v6
v_sub_f32 v19, 0, v15
v_cvt_pk_bf16_f32 v18, v14, v19
ds_write_b32 v8, v18 offset:3952
v_mul_f32 v6, v14, v12
v_fma_f32 v6, -v15, v13, v6
v_mul_f32 v7, v14, v13
v_fma_f32 v15, v15, v12, v7
v_mov_b32 v14, v6
v_sub_f32 v19, 0, v15
v_cvt_pk_bf16_f32 v18, v14, v19
ds_write_b32 v8, v18 offset:4480
v_mul_f32 v6, v14, v12
v_fma_f32 v6, -v15, v13, v6
v_mul_f32 v7, v14, v13
v_fma_f32 v15, v15, v12, v7
v_mov_b32 v14, v6
v_sub_f32 v19, 0, v15
v_cvt_pk_bf16_f32 v18, v14, v19
ds_write_b32 v8, v18 offset:5008
v_mul_f32 v6, v14, v12
v_fma_f32 v6, -v15, v13, v6
v_mul_f32 v7, v14, v13
v_fma_f32 v15, v15, v12, v7
v_mov_b32 v14, v6
v_sub_f32 v19, 0, v15
v_cvt_pk_bf16_f32 v18, v14, v19
ds_write_b32 v8, v18 offset:5536
v_mul_f32 v6, v14, v12
v_fma_f32 v6, -v15, v13, v6
v_mul_f32 v7, v14, v13
v_fma_f32 v15, v15, v12, v7
v_mov_b32 v14, v6
v_sub_f32 v19, 0, v15
v_cvt_pk_bf16_f32 v18, v14, v19
ds_write_b32 v8, v18 offset:6064
v_mul_f32 v6, v14, v12
v_fma_f32 v6, -v15, v13, v6
v_mul_f32 v7, v14, v13
v_fma_f32 v15, v15, v12, v7
v_mov_b32 v14, v6
v_sub_f32 v19, 0, v15
v_cvt_pk_bf16_f32 v18, v14, v19
ds_write_b32 v8, v18 offset:6592
v_mul_f32 v6, v14, v12
v_fma_f32 v6, -v15, v13, v6
v_mul_f32 v7, v14, v13
v_fma_f32 v15, v15, v12, v7
v_mov_b32 v14, v6
v_sub_f32 v19, 0, v15
v_cvt_pk_bf16_f32 v18, v14, v19
ds_write_b32 v8, v18 offset:7120
v_mul_f32 v6, v14, v12
v_fma_f32 v6, -v15, v13, v6
v_mul_f32 v7, v14, v13
v_fma_f32 v15, v15, v12, v7
v_mov_b32 v14, v6
v_sub_f32 v19, 0, v15
v_cvt_pk_bf16_f32 v18, v14, v19
ds_write_b32 v8, v18 offset:7648
v_mul_f32 v6, v14, v12
v_fma_f32 v6, -v15, v13, v6
v_mul_f32 v7, v14, v13
v_fma_f32 v15, v15, v12, v7
v_mov_b32 v14, v6
v_sub_f32 v19, 0, v15
v_cvt_pk_bf16_f32 v18, v14, v19
ds_write_b32 v8, v18 offset:8176
s_waitcnt lgkmcnt(0)
v_mov_b32 v20, 0
v_mov_b32 v21, 0
v_mov_b32 v22, 0
v_mov_b32 v23, 0
ds_read_b128 v[24:27], v9 offset:0
ds_read_b128 v[28:31], v9 offset:8448
s_waitcnt lgkmcnt(0)
v_mfma_f32_16x16x32_bf16 v[20:23], v[24:27], v[28:31], v[20:23]
ds_read_b128 v[24:27], v9 offset:64
ds_read_b128 v[28:31], v9 offset:8512
s_waitcnt lgkmcnt(0)
v_mfma_f32_16x16x32_bf16 v[20:23], v[24:27], v[28:31], v[20:23]
ds_read_b128 v[24:27], v9 offset:128
ds_read_b128 v[28:31], v9 offset:8576
s_waitcnt lgkmcnt(0)
v_mfma_f32_16x16x32_bf16 v[20:23], v[24:27], v[28:31], v[20:23]
ds_read_b128 v[24:27], v9 offset:192
ds_read_b128 v[28:31], v9 offset:8640
s_waitcnt lgkmcnt(0)
v_mfma_f32_16x16x32_bf16 v[20:23], v[24:27], v[28:31], v[20:23]
ds_read_b128 v[24:27], v9 offset:256
ds_read_b128 v[28:31], v9 offset:8704
s_waitcnt lgkmcnt(0)
v_mfma_f32_16x16x32_bf16 v[20:23], v[24:27], v[28:31], v[20:23]
ds_read_b128 v[24:27], v9 offset:320
ds_read_b128 v[28:31], v9 offset:8768
s_waitcnt lgkmcnt(0)
v_mfma_f32_16x16x32_bf16 v[20:23], v[24:27], v[28:31], v[20:23]
ds_read_b128 v[24:27], v9 offset:384
ds_read_b128 v[28:31], v9 offset:8832
s_waitcnt lgkmcnt(0)
v_mfma_f32_16x16x32_bf16 v[20:23], v[24:27], v[28:31], v[20:23]
ds_read_b128 v[24:27], v9 offset:448
ds_read_b128 v[28:31], v9 offset:8896
s_waitcnt lgkmcnt(0)
v_mfma_f32_16x16x32_bf16 v[20:23], v[24:27], v[28:31], v[20:23]
s_nop 7
s_nop 3
v_mov_b32 v80, v20
v_mov_b32 v81, v21
v_mov_b32 v82, v22
v_mov_b32 v83, v23
v_mul_f32 v4, 2.0, v64
v_mul_f32 v5, 2.0, v65
v_mul_f32 v4, 0x3fb8aa3b, v4
v_mul_f32 v5, 0x3e22f983, v5
v_exp_f32 v4, v4
v_fract_f32 v5, v5
v_cos_f32 v10, v5
v_sin_f32 v11, v5
s_nop 0
v_mul_f32 v10, v4, v10
v_mul_f32 v11, v4, v11
s_mov_b32 s23, 0x42000000
v_mul_f32 v4, s23, v64
v_mul_f32 v5, s23, v65
v_mul_f32 v4, 0x3fb8aa3b, v4
v_mul_f32 v5, 0x3e22f983, v5
v_exp_f32 v4, v4
v_fract_f32 v5, v5
v_cos_f32 v12, v5
v_sin_f32 v13, v5
s_nop 0
v_mul_f32 v12, v4, v12
v_mul_f32 v13, v4, v13
s_mov_b32 s23, 0x43800000
v_mul_f32 v4, s23, v64
v_mul_f32 v5, s23, v65
v_mul_f32 v4, 0x3fb8aa3b, v4
v_mul_f32 v5, 0x3e22f983, v5
v_exp_f32 v4, v4
v_fract_f32 v5, v5
v_cos_f32 v14, v5
v_sin_f32 v15, v5
s_nop 0
v_mul_f32 v14, v4, v14
v_mul_f32 v15, v4, v15
v_mul_f32 v6, v14, v70
v_fma_f32 v6, -v15, v71, v6
v_mul_f32 v7, v14, v71
v_fma_f32 v15, v15, v70, v7
v_mov_b32 v14, v6
v_mov_b32 v16, 1.0
v_mov_b32 v17, 0
v_cvt_pk_bf16_f32 v18, v16, v17
ds_write_b32 v8, v18 offset:8448
v_mul_f32 v6, v16, v10
v_fma_f32 v6, -v17, v11, v6
v_mul_f32 v7, v16, v11
v_fma_f32 v17, v17, v10, v7
v_mov_b32 v16, v6
v_cvt_pk_bf16_f32 v18, v16, v17
ds_write_b32 v8, v18 offset:8976
v_mul_f32 v6, v16, v10
v_fma_f32 v6, -v17, v11, v6
v_mul_f32 v7, v16, v11
v_fma_f32 v17, v17, v10, v7
v_mov_b32 v16, v6
v_cvt_pk_bf16_f32 v18, v16, v17
ds_write_b32 v8, v18 offset:9504
v_mul_f32 v6, v16, v10
v_fma_f32 v6, -v17, v11, v6
v_mul_f32 v7, v16, v11
v_fma_f32 v17, v17, v10, v7
v_mov_b32 v16, v6
v_cvt_pk_bf16_f32 v18, v16, v17
ds_write_b32 v8, v18 offset:10032
v_mul_f32 v6, v16, v10
v_fma_f32 v6, -v17, v11, v6
v_mul_f32 v7, v16, v11
v_fma_f32 v17, v17, v10, v7
v_mov_b32 v16, v6
v_cvt_pk_bf16_f32 v18, v16, v17
ds_write_b32 v8, v18 offset:10560
v_mul_f32 v6, v16, v10
v_fma_f32 v6, -v17, v11, v6
v_mul_f32 v7, v16, v11
v_fma_f32 v17, v17, v10, v7
v_mov_b32 v16, v6
v_cvt_pk_bf16_f32 v18, v16, v17
ds_write_b32 v8, v18 offset:11088
v_mul_f32 v6, v16, v10
v_fma_f32 v6, -v17, v11, v6
v_mul_f32 v7, v16, v11
v_fma_f32 v17, v17, v10, v7
v_mov_b32 v16, v6
v_cvt_pk_bf16_f32 v18, v16, v17
ds_write_b32 v8, v18 offset:11616
v_mul_f32 v6, v16, v10
v_fma_f32 v6, -v17, v11, v6
v_mul_f32 v7, v16, v11
v_fma_f32 v17, v17, v10, v7
v_mov_b32 v16, v6
v_cvt_pk_bf16_f32 v18, v16, v17
ds_write_b32 v8, v18 offset:12144
v_mul_f32 v6, v16, v10
v_fma_f32 v6, -v17, v11, v6
v_mul_f32 v7, v16, v11
v_fma_f32 v17, v17, v10, v7
v_mov_b32 v16, v6
v_cvt_pk_bf16_f32 v18, v16, v17
ds_write_b32 v8, v18 offset:12672
v_mul_f32 v6, v16, v10
v_fma_f32 v6, -v17, v11, v6
v_mul_f32 v7, v16, v11
v_fma_f32 v17, v17, v10, v7
v_mov_b32 v16, v6
v_cvt_pk_bf16_f32 v18, v16, v17
ds_write_b32 v8, v18 offset:13200
v_mul_f32 v6, v16, v10
v_fma_f32 v6, -v17, v11, v6
v_mul_f32 v7, v16, v11
v_fma_f32 v17, v17, v10, v7
v_mov_b32 v16, v6
v_cvt_pk_bf16_f32 v18, v16, v17
ds_write_b32 v8, v18 offset:13728
v_mul_f32 v6, v16, v10
v_fma_f32 v6, -v17, v11, v6
v_mul_f32 v7, v16, v11
v_fma_f32 v17, v17, v10, v7
v_mov_b32 v16, v6
v_cvt_pk_bf16_f32 v18, v16, v17
ds_write_b32 v8, v18 offset:14256
v_mul_f32 v6, v16, v10
v_fma_f32 v6, -v17, v11, v6
v_mul_f32 v7, v16, v11
v_fma_f32 v17, v17, v10, v7
v_mov_b32 v16, v6
v_cvt_pk_bf16_f32 v18, v16, v17
ds_write_b32 v8, v18 offset:14784
v_mul_f32 v6, v16, v10
v_fma_f32 v6, -v17, v11, v6
v_mul_f32 v7, v16, v11
v_fma_f32 v17, v17, v10, v7
v_mov_b32 v16, v6
v_cvt_pk_bf16_f32 v18, v16, v17
ds_write_b32 v8, v18 offset:15312
v_mul_f32 v6, v16, v10
v_fma_f32 v6, -v17, v11, v6
v_mul_f32 v7, v16, v11
v_fma_f32 v17, v17, v10, v7
v_mov_b32 v16, v6
v_cvt_pk_bf16_f32 v18, v16, v17
ds_write_b32 v8, v18 offset:15840
v_mul_f32 v6, v16, v10
v_fma_f32 v6, -v17, v11, v6
v_mul_f32 v7, v16, v11
v_fma_f32 v17, v17, v10, v7
v_mov_b32 v16, v6
v_cvt_pk_bf16_f32 v18, v16, v17
ds_write_b32 v8, v18 offset:16368
v_sub_f32 v19, 0, v15
v_cvt_pk_bf16_f32 v18, v14, v19
ds_write_b32 v8, v18 offset:0
v_mul_f32 v6, v14, v12
v_fma_f32 v6, -v15, v13, v6
v_mul_f32 v7, v14, v13
v_fma_f32 v15, v15, v12, v7
v_mov_b32 v14, v6
v_sub_f32 v19, 0, v15
v_cvt_pk_bf16_f32 v18, v14, v19
ds_write_b32 v8, v18 offset:528
v_mul_f32 v6, v14, v12
v_fma_f32 v6, -v15, v13, v6
v_mul_f32 v7, v14, v13
v_fma_f32 v15, v15, v12, v7
v_mov_b32 v14, v6
v_sub_f32 v19, 0, v15
v_cvt_pk_bf16_f32 v18, v14, v19
ds_write_b32 v8, v18 offset:1056
v_mul_f32 v6, v14, v12
v_fma_f32 v6, -v15, v13, v6
v_mul_f32 v7, v14, v13
v_fma_f32 v15, v15, v12, v7
v_mov_b32 v14, v6
v_sub_f32 v19, 0, v15
v_cvt_pk_bf16_f32 v18, v14, v19
ds_write_b32 v8, v18 offset:1584
v_mul_f32 v6, v14, v12
v_fma_f32 v6, -v15, v13, v6
v_mul_f32 v7, v14, v13
v_fma_f32 v15, v15, v12, v7
v_mov_b32 v14, v6
v_sub_f32 v19, 0, v15
v_cvt_pk_bf16_f32 v18, v14, v19
ds_write_b32 v8, v18 offset:2112
v_mul_f32 v6, v14, v12
v_fma_f32 v6, -v15, v13, v6
v_mul_f32 v7, v14, v13
v_fma_f32 v15, v15, v12, v7
v_mov_b32 v14, v6
v_sub_f32 v19, 0, v15
v_cvt_pk_bf16_f32 v18, v14, v19
ds_write_b32 v8, v18 offset:2640
v_mul_f32 v6, v14, v12
v_fma_f32 v6, -v15, v13, v6
v_mul_f32 v7, v14, v13
v_fma_f32 v15, v15, v12, v7
v_mov_b32 v14, v6
v_sub_f32 v19, 0, v15
v_cvt_pk_bf16_f32 v18, v14, v19
ds_write_b32 v8, v18 offset:3168
v_mul_f32 v6, v14, v12
v_fma_f32 v6, -v15, v13, v6
v_mul_f32 v7, v14, v13
v_fma_f32 v15, v15, v12, v7
v_mov_b32 v14, v6
v_sub_f32 v19, 0, v15
v_cvt_pk_bf16_f32 v18, v14, v19
ds_write_b32 v8, v18 offset:3696
v_mul_f32 v4, 2.0, v72
v_mul_f32 v5, 2.0, v73
v_mul_f32 v4, 0x3fb8aa3b, v4
v_mul_f32 v5, 0x3e22f983, v5
v_exp_f32 v4, v4
v_fract_f32 v5, v5
v_cos_f32 v10, v5
v_sin_f32 v11, v5
s_nop 0
v_mul_f32 v10, v4, v10
v_mul_f32 v11, v4, v11
s_mov_b32 s23, 0x42000000
v_mul_f32 v4, s23, v72
v_mul_f32 v5, s23, v73
v_mul_f32 v4, 0x3fb8aa3b, v4
v_mul_f32 v5, 0x3e22f983, v5
v_exp_f32 v4, v4
v_fract_f32 v5, v5
v_cos_f32 v12, v5
v_sin_f32 v13, v5
s_nop 0
v_mul_f32 v12, v4, v12
v_mul_f32 v13, v4, v13
s_mov_b32 s23, 0x43800000
v_mul_f32 v4, s23, v72
v_mul_f32 v5, s23, v73
v_mul_f32 v4, 0x3fb8aa3b, v4
v_mul_f32 v5, 0x3e22f983, v5
v_exp_f32 v4, v4
v_fract_f32 v5, v5
v_cos_f32 v14, v5
v_sin_f32 v15, v5
s_nop 0
v_mul_f32 v14, v4, v14
v_mul_f32 v15, v4, v15
v_mul_f32 v6, v14, v78
v_fma_f32 v6, -v15, v79, v6
v_mul_f32 v7, v14, v79
v_fma_f32 v15, v15, v78, v7
v_mov_b32 v14, v6
v_mov_b32 v16, 1.0
v_mov_b32 v17, 0
v_cvt_pk_bf16_f32 v18, v16, v17
ds_write_b32 v8, v18 offset:8704
v_mul_f32 v6, v16, v10
v_fma_f32 v6, -v17, v11, v6
v_mul_f32 v7, v16, v11
v_fma_f32 v17, v17, v10, v7
v_mov_b32 v16, v6
v_cvt_pk_bf16_f32 v18, v16, v17
ds_write_b32 v8, v18 offset:9232
v_mul_f32 v6, v16, v10
v_fma_f32 v6, -v17, v11, v6
v_mul_f32 v7, v16, v11
v_fma_f32 v17, v17, v10, v7
v_mov_b32 v16, v6
v_cvt_pk_bf16_f32 v18, v16, v17
ds_write_b32 v8, v18 offset:9760
v_mul_f32 v6, v16, v10
v_fma_f32 v6, -v17, v11, v6
v_mul_f32 v7, v16, v11
v_fma_f32 v17, v17, v10, v7
v_mov_b32 v16, v6
v_cvt_pk_bf16_f32 v18, v16, v17
ds_write_b32 v8, v18 offset:10288
v_mul_f32 v6, v16, v10
v_fma_f32 v6, -v17, v11, v6
v_mul_f32 v7, v16, v11
v_fma_f32 v17, v17, v10, v7
v_mov_b32 v16, v6
v_cvt_pk_bf16_f32 v18, v16, v17
ds_write_b32 v8, v18 offset:10816
v_mul_f32 v6, v16, v10
v_fma_f32 v6, -v17, v11, v6
v_mul_f32 v7, v16, v11
v_fma_f32 v17, v17, v10, v7
v_mov_b32 v16, v6
v_cvt_pk_bf16_f32 v18, v16, v17
ds_write_b32 v8, v18 offset:11344
v_mul_f32 v6, v16, v10
v_fma_f32 v6, -v17, v11, v6
v_mul_f32 v7, v16, v11
v_fma_f32 v17, v17, v10, v7
v_mov_b32 v16, v6
v_cvt_pk_bf16_f32 v18, v16, v17
ds_write_b32 v8, v18 offset:11872
v_mul_f32 v6, v16, v10
v_fma_f32 v6, -v17, v11, v6
v_mul_f32 v7, v16, v11
v_fma_f32 v17, v17, v10, v7
v_mov_b32 v16, v6
v_cvt_pk_bf16_f32 v18, v16, v17
ds_write_b32 v8, v18 offset:12400
v_mul_f32 v6, v16, v10
v_fma_f32 v6, -v17, v11, v6
v_mul_f32 v7, v16, v11
v_fma_f32 v17, v17, v10, v7
v_mov_b32 v16, v6
v_cvt_pk_bf16_f32 v18, v16, v17
ds_write_b32 v8, v18 offset:12928
v_mul_f32 v6, v16, v10
v_fma_f32 v6, -v17, v11, v6
v_mul_f32 v7, v16, v11
v_fma_f32 v17, v17, v10, v7
v_mov_b32 v16, v6
v_cvt_pk_bf16_f32 v18, v16, v17
ds_write_b32 v8, v18 offset:13456
v_mul_f32 v6, v16, v10
v_fma_f32 v6, -v17, v11, v6
v_mul_f32 v7, v16, v11
v_fma_f32 v17, v17, v10, v7
v_mov_b32 v16, v6
v_cvt_pk_bf16_f32 v18, v16, v17
ds_write_b32 v8, v18 offset:13984
v_mul_f32 v6, v16, v10
v_fma_f32 v6, -v17, v11, v6
v_mul_f32 v7, v16, v11
v_fma_f32 v17, v17, v10, v7
v_mov_b32 v16, v6
v_cvt_pk_bf16_f32 v18, v16, v17
ds_write_b32 v8, v18 offset:14512
v_mul_f32 v6, v16, v10
v_fma_f32 v6, -v17, v11, v6
v_mul_f32 v7, v16, v11
v_fma_f32 v17, v17, v10, v7
v_mov_b32 v16, v6
v_cvt_pk_bf16_f32 v18, v16, v17
ds_write_b32 v8, v18 offset:15040
v_mul_f32 v6, v16, v10
v_fma_f32 v6, -v17, v11, v6
v_mul_f32 v7, v16, v11
v_fma_f32 v17, v17, v10, v7
v_mov_b32 v16, v6
v_cvt_pk_bf16_f32 v18, v16, v17
ds_write_b32 v8, v18 offset:15568
v_mul_f32 v6, v16, v10
v_fma_f32 v6, -v17, v11, v6
v_mul_f32 v7, v16, v11
v_fma_f32 v17, v17, v10, v7
v_mov_b32 v16, v6
v_cvt_pk_bf16_f32 v18, v16, v17
ds_write_b32 v8, v18 offset:16096
v_mul_f32 v6, v16, v10
v_fma_f32 v6, -v17, v11, v6
v_mul_f32 v7, v16, v11
v_fma_f32 v17, v17, v10, v7
v_mov_b32 v16, v6
v_cvt_pk_bf16_f32 v18, v16, v17
ds_write_b32 v8, v18 offset:16624
v_sub_f32 v19, 0, v15
v_cvt_pk_bf16_f32 v18, v14, v19
ds_write_b32 v8, v18 offset:256
v_mul_f32 v6, v14, v12
v_fma_f32 v6, -v15, v13, v6
v_mul_f32 v7, v14, v13
v_fma_f32 v15, v15, v12, v7
v_mov_b32 v14, v6
v_sub_f32 v19, 0, v15
v_cvt_pk_bf16_f32 v18, v14, v19
ds_write_b32 v8, v18 offset:784
v_mul_f32 v6, v14, v12
v_fma_f32 v6, -v15, v13, v6
v_mul_f32 v7, v14, v13
v_fma_f32 v15, v15, v12, v7
v_mov_b32 v14, v6
v_sub_f32 v19, 0, v15
v_cvt_pk_bf16_f32 v18, v14, v19
ds_write_b32 v8, v18 offset:1312
v_mul_f32 v6, v14, v12
v_fma_f32 v6, -v15, v13, v6
v_mul_f32 v7, v14, v13
v_fma_f32 v15, v15, v12, v7
v_mov_b32 v14, v6
v_sub_f32 v19, 0, v15
v_cvt_pk_bf16_f32 v18, v14, v19
ds_write_b32 v8, v18 offset:1840
v_mul_f32 v6, v14, v12
v_fma_f32 v6, -v15, v13, v6
v_mul_f32 v7, v14, v13
v_fma_f32 v15, v15, v12, v7
v_mov_b32 v14, v6
v_sub_f32 v19, 0, v15
v_cvt_pk_bf16_f32 v18, v14, v19
ds_write_b32 v8, v18 offset:2368
v_mul_f32 v6, v14, v12
v_fma_f32 v6, -v15, v13, v6
v_mul_f32 v7, v14, v13
v_fma_f32 v15, v15, v12, v7
v_mov_b32 v14, v6
v_sub_f32 v19, 0, v15
v_cvt_pk_bf16_f32 v18, v14, v19
ds_write_b32 v8, v18 offset:2896
v_mul_f32 v6, v14, v12
v_fma_f32 v6, -v15, v13, v6
v_mul_f32 v7, v14, v13
v_fma_f32 v15, v15, v12, v7
v_mov_b32 v14, v6
v_sub_f32 v19, 0, v15
v_cvt_pk_bf16_f32 v18, v14, v19
ds_write_b32 v8, v18 offset:3424
v_mul_f32 v6, v14, v12
v_fma_f32 v6, -v15, v13, v6
v_mul_f32 v7, v14, v13
v_fma_f32 v15, v15, v12, v7
v_mov_b32 v14, v6
v_sub_f32 v19, 0, v15
v_cvt_pk_bf16_f32 v18, v14, v19
ds_write_b32 v8, v18 offset:3952
s_waitcnt lgkmcnt(0)
v_mov_b32 v20, 0
v_mov_b32 v21, 0
v_mov_b32 v22, 0
v_mov_b32 v23, 0
ds_read_b128 v[24:27], v9 offset:0
ds_read_b128 v[28:31], v9 offset:8448
s_waitcnt lgkmcnt(0)
v_mfma_f32_16x16x32_bf16 v[20:23], v[24:27], v[28:31], v[20:23]
ds_read_b128 v[24:27], v9 offset:64
ds_read_b128 v[28:31], v9 offset:8512
s_waitcnt lgkmcnt(0)
v_mfma_f32_16x16x32_bf16 v[20:23], v[24:27], v[28:31], v[20:23]
ds_read_b128 v[24:27], v9 offset:128
ds_read_b128 v[28:31], v9 offset:8576
s_waitcnt lgkmcnt(0)
v_mfma_f32_16x16x32_bf16 v[20:23], v[24:27], v[28:31], v[20:23]
ds_read_b128 v[24:27], v9 offset:192
ds_read_b128 v[28:31], v9 offset:8640
s_waitcnt lgkmcnt(0)
v_mfma_f32_16x16x32_bf16 v[20:23], v[24:27], v[28:31], v[20:23]
ds_read_b128 v[24:27], v9 offset:256
ds_read_b128 v[28:31], v9 offset:8704
s_waitcnt lgkmcnt(0)
v_mfma_f32_16x16x32_bf16 v[20:23], v[24:27], v[28:31], v[20:23]
ds_read_b128 v[24:27], v9 offset:320
ds_read_b128 v[28:31], v9 offset:8768
s_waitcnt lgkmcnt(0)
v_mfma_f32_16x16x32_bf16 v[20:23], v[24:27], v[28:31], v[20:23]
ds_read_b128 v[24:27], v9 offset:384
ds_read_b128 v[28:31], v9 offset:8832
s_waitcnt lgkmcnt(0)
v_mfma_f32_16x16x32_bf16 v[20:23], v[24:27], v[28:31], v[20:23]
ds_read_b128 v[24:27], v9 offset:448
ds_read_b128 v[28:31], v9 offset:8896
s_waitcnt lgkmcnt(0)
v_mfma_f32_16x16x32_bf16 v[20:23], v[24:27], v[28:31], v[20:23]
s_nop 7
s_nop 3
v_mov_b32 v84, v20
v_mov_b32 v85, v21
v_mov_b32 v86, v22
v_mov_b32 v87, v23
v_mul_f32 v4, 4.0, v64
v_mul_f32 v5, 4.0, v65
v_mul_f32 v4, 0x3fb8aa3b, v4
v_mul_f32 v5, 0x3e22f983, v5
v_exp_f32 v4, v4
v_fract_f32 v5, v5
v_cos_f32 v10, v5
v_sin_f32 v11, v5
s_nop 0
v_mul_f32 v10, v4, v10
v_mul_f32 v11, v4, v11
s_mov_b32 s23, 0x42800000
v_mul_f32 v4, s23, v64
v_mul_f32 v5, s23, v65
v_mul_f32 v4, 0x3fb8aa3b, v4
v_mul_f32 v5, 0x3e22f983, v5
v_exp_f32 v4, v4
v_fract_f32 v5, v5
v_cos_f32 v12, v5
v_sin_f32 v13, v5
s_nop 0
v_mul_f32 v12, v4, v12
v_mul_f32 v13, v4, v13
s_mov_b32 s23, 0x44000000
v_mul_f32 v4, s23, v64
v_mul_f32 v5, s23, v65
v_mul_f32 v4, 0x3fb8aa3b, v4
v_mul_f32 v5, 0x3e22f983, v5
v_exp_f32 v4, v4
v_fract_f32 v5, v5
v_cos_f32 v14, v5
v_sin_f32 v15, v5
s_nop 0
v_mul_f32 v14, v4, v14
v_mul_f32 v15, v4, v15
v_mul_f32 v6, v14, v70
v_fma_f32 v6, -v15, v71, v6
v_mul_f32 v7, v14, v71
v_fma_f32 v15, v15, v70, v7
v_mov_b32 v14, v6
v_mov_b32 v16, 1.0
v_mov_b32 v17, 0
v_cvt_pk_bf16_f32 v18, v16, v17
ds_write_b32 v8, v18 offset:8448
v_mul_f32 v6, v16, v10
v_fma_f32 v6, -v17, v11, v6
v_mul_f32 v7, v16, v11
v_fma_f32 v17, v17, v10, v7
v_mov_b32 v16, v6
v_cvt_pk_bf16_f32 v18, v16, v17
ds_write_b32 v8, v18 offset:8976
v_mul_f32 v6, v16, v10
v_fma_f32 v6, -v17, v11, v6
v_mul_f32 v7, v16, v11
v_fma_f32 v17, v17, v10, v7
v_mov_b32 v16, v6
v_cvt_pk_bf16_f32 v18, v16, v17
ds_write_b32 v8, v18 offset:9504
v_mul_f32 v6, v16, v10
v_fma_f32 v6, -v17, v11, v6
v_mul_f32 v7, v16, v11
v_fma_f32 v17, v17, v10, v7
v_mov_b32 v16, v6
v_cvt_pk_bf16_f32 v18, v16, v17
ds_write_b32 v8, v18 offset:10032
v_mul_f32 v6, v16, v10
v_fma_f32 v6, -v17, v11, v6
v_mul_f32 v7, v16, v11
v_fma_f32 v17, v17, v10, v7
v_mov_b32 v16, v6
v_cvt_pk_bf16_f32 v18, v16, v17
ds_write_b32 v8, v18 offset:10560
v_mul_f32 v6, v16, v10
v_fma_f32 v6, -v17, v11, v6
v_mul_f32 v7, v16, v11
v_fma_f32 v17, v17, v10, v7
v_mov_b32 v16, v6
v_cvt_pk_bf16_f32 v18, v16, v17
ds_write_b32 v8, v18 offset:11088
v_mul_f32 v6, v16, v10
v_fma_f32 v6, -v17, v11, v6
v_mul_f32 v7, v16, v11
v_fma_f32 v17, v17, v10, v7
v_mov_b32 v16, v6
v_cvt_pk_bf16_f32 v18, v16, v17
ds_write_b32 v8, v18 offset:11616
v_mul_f32 v6, v16, v10
v_fma_f32 v6, -v17, v11, v6
v_mul_f32 v7, v16, v11
v_fma_f32 v17, v17, v10, v7
v_mov_b32 v16, v6
v_cvt_pk_bf16_f32 v18, v16, v17
ds_write_b32 v8, v18 offset:12144
v_mul_f32 v6, v16, v10
v_fma_f32 v6, -v17, v11, v6
v_mul_f32 v7, v16, v11
v_fma_f32 v17, v17, v10, v7
v_mov_b32 v16, v6
v_cvt_pk_bf16_f32 v18, v16, v17
ds_write_b32 v8, v18 offset:12672
v_mul_f32 v6, v16, v10
v_fma_f32 v6, -v17, v11, v6
v_mul_f32 v7, v16, v11
v_fma_f32 v17, v17, v10, v7
v_mov_b32 v16, v6
v_cvt_pk_bf16_f32 v18, v16, v17
ds_write_b32 v8, v18 offset:13200
v_mul_f32 v6, v16, v10
v_fma_f32 v6, -v17, v11, v6
v_mul_f32 v7, v16, v11
v_fma_f32 v17, v17, v10, v7
v_mov_b32 v16, v6
v_cvt_pk_bf16_f32 v18, v16, v17
ds_write_b32 v8, v18 offset:13728
v_mul_f32 v6, v16, v10
v_fma_f32 v6, -v17, v11, v6
v_mul_f32 v7, v16, v11
v_fma_f32 v17, v17, v10, v7
v_mov_b32 v16, v6
v_cvt_pk_bf16_f32 v18, v16, v17
ds_write_b32 v8, v18 offset:14256
v_mul_f32 v6, v16, v10
v_fma_f32 v6, -v17, v11, v6
v_mul_f32 v7, v16, v11
v_fma_f32 v17, v17, v10, v7
v_mov_b32 v16, v6
v_cvt_pk_bf16_f32 v18, v16, v17
ds_write_b32 v8, v18 offset:14784
v_mul_f32 v6, v16, v10
v_fma_f32 v6, -v17, v11, v6
v_mul_f32 v7, v16, v11
v_fma_f32 v17, v17, v10, v7
v_mov_b32 v16, v6
v_cvt_pk_bf16_f32 v18, v16, v17
ds_write_b32 v8, v18 offset:15312
v_mul_f32 v6, v16, v10
v_fma_f32 v6, -v17, v11, v6
v_mul_f32 v7, v16, v11
v_fma_f32 v17, v17, v10, v7
v_mov_b32 v16, v6
v_cvt_pk_bf16_f32 v18, v16, v17
ds_write_b32 v8, v18 offset:15840
v_mul_f32 v6, v16, v10
v_fma_f32 v6, -v17, v11, v6
v_mul_f32 v7, v16, v11
v_fma_f32 v17, v17, v10, v7
v_mov_b32 v16, v6
v_cvt_pk_bf16_f32 v18, v16, v17
ds_write_b32 v8, v18 offset:16368
v_sub_f32 v19, 0, v15
v_cvt_pk_bf16_f32 v18, v14, v19
ds_write_b32 v8, v18 offset:0
v_mul_f32 v6, v14, v12
v_fma_f32 v6, -v15, v13, v6
v_mul_f32 v7, v14, v13
v_fma_f32 v15, v15, v12, v7
v_mov_b32 v14, v6
v_sub_f32 v19, 0, v15
v_cvt_pk_bf16_f32 v18, v14, v19
ds_write_b32 v8, v18 offset:528
v_mul_f32 v6, v14, v12
v_fma_f32 v6, -v15, v13, v6
v_mul_f32 v7, v14, v13
v_fma_f32 v15, v15, v12, v7
v_mov_b32 v14, v6
v_sub_f32 v19, 0, v15
v_cvt_pk_bf16_f32 v18, v14, v19
ds_write_b32 v8, v18 offset:1056
v_mul_f32 v6, v14, v12
v_fma_f32 v6, -v15, v13, v6
v_mul_f32 v7, v14, v13
v_fma_f32 v15, v15, v12, v7
v_mov_b32 v14, v6
v_sub_f32 v19, 0, v15
v_cvt_pk_bf16_f32 v18, v14, v19
ds_write_b32 v8, v18 offset:1584
v_mul_f32 v6, v14, v12
v_fma_f32 v6, -v15, v13, v6
v_mul_f32 v7, v14, v13
v_fma_f32 v15, v15, v12, v7
v_mov_b32 v14, v6
v_sub_f32 v19, 0, v15
v_cvt_pk_bf16_f32 v18, v14, v19
ds_write_b32 v8, v18 offset:2112
v_mul_f32 v6, v14, v12
v_fma_f32 v6, -v15, v13, v6
v_mul_f32 v7, v14, v13
v_fma_f32 v15, v15, v12, v7
v_mov_b32 v14, v6
v_sub_f32 v19, 0, v15
v_cvt_pk_bf16_f32 v18, v14, v19
ds_write_b32 v8, v18 offset:2640
v_mul_f32 v6, v14, v12
v_fma_f32 v6, -v15, v13, v6
v_mul_f32 v7, v14, v13
v_fma_f32 v15, v15, v12, v7
v_mov_b32 v14, v6
v_sub_f32 v19, 0, v15
v_cvt_pk_bf16_f32 v18, v14, v19
ds_write_b32 v8, v18 offset:3168
v_mul_f32 v6, v14, v12
v_fma_f32 v6, -v15, v13, v6
v_mul_f32 v7, v14, v13
v_fma_f32 v15, v15, v12, v7
v_mov_b32 v14, v6
v_sub_f32 v19, 0, v15
v_cvt_pk_bf16_f32 v18, v14, v19
ds_write_b32 v8, v18 offset:3696
v_mul_f32 v4, 4.0, v72
v_mul_f32 v5, 4.0, v73
v_mul_f32 v4, 0x3fb8aa3b, v4
v_mul_f32 v5, 0x3e22f983, v5
v_exp_f32 v4, v4
v_fract_f32 v5, v5
v_cos_f32 v10, v5
v_sin_f32 v11, v5
s_nop 0
v_mul_f32 v10, v4, v10
v_mul_f32 v11, v4, v11
s_mov_b32 s23, 0x42800000
v_mul_f32 v4, s23, v72
v_mul_f32 v5, s23, v73
v_mul_f32 v4, 0x3fb8aa3b, v4
v_mul_f32 v5, 0x3e22f983, v5
v_exp_f32 v4, v4
v_fract_f32 v5, v5
v_cos_f32 v12, v5
v_sin_f32 v13, v5
s_nop 0
v_mul_f32 v12, v4, v12
v_mul_f32 v13, v4, v13
s_mov_b32 s23, 0x44000000
v_mul_f32 v4, s23, v72
v_mul_f32 v5, s23, v73
v_mul_f32 v4, 0x3fb8aa3b, v4
v_mul_f32 v5, 0x3e22f983, v5
v_exp_f32 v4, v4
v_fract_f32 v5, v5
v_cos_f32 v14, v5
v_sin_f32 v15, v5
s_nop 0
v_mul_f32 v14, v4, v14
v_mul_f32 v15, v4, v15
v_mul_f32 v6, v14, v78
v_fma_f32 v6, -v15, v79, v6
v_mul_f32 v7, v14, v79
v_fma_f32 v15, v15, v78, v7
v_mov_b32 v14, v6
v_mov_b32 v16, 1.0
v_mov_b32 v17, 0
v_cvt_pk_bf16_f32 v18, v16, v17
ds_write_b32 v8, v18 offset:8704
v_mul_f32 v6, v16, v10
v_fma_f32 v6, -v17, v11, v6
v_mul_f32 v7, v16, v11
v_fma_f32 v17, v17, v10, v7
v_mov_b32 v16, v6
v_cvt_pk_bf16_f32 v18, v16, v17
ds_write_b32 v8, v18 offset:9232
v_mul_f32 v6, v16, v10
v_fma_f32 v6, -v17, v11, v6
v_mul_f32 v7, v16, v11
v_fma_f32 v17, v17, v10, v7
v_mov_b32 v16, v6
v_cvt_pk_bf16_f32 v18, v16, v17
ds_write_b32 v8, v18 offset:9760
v_mul_f32 v6, v16, v10
v_fma_f32 v6, -v17, v11, v6
v_mul_f32 v7, v16, v11
v_fma_f32 v17, v17, v10, v7
v_mov_b32 v16, v6
v_cvt_pk_bf16_f32 v18, v16, v17
ds_write_b32 v8, v18 offset:10288
v_mul_f32 v6, v16, v10
v_fma_f32 v6, -v17, v11, v6
v_mul_f32 v7, v16, v11
v_fma_f32 v17, v17, v10, v7
v_mov_b32 v16, v6
v_cvt_pk_bf16_f32 v18, v16, v17
ds_write_b32 v8, v18 offset:10816
v_mul_f32 v6, v16, v10
v_fma_f32 v6, -v17, v11, v6
v_mul_f32 v7, v16, v11
v_fma_f32 v17, v17, v10, v7
v_mov_b32 v16, v6
v_cvt_pk_bf16_f32 v18, v16, v17
ds_write_b32 v8, v18 offset:11344
v_mul_f32 v6, v16, v10
v_fma_f32 v6, -v17, v11, v6
v_mul_f32 v7, v16, v11
v_fma_f32 v17, v17, v10, v7
v_mov_b32 v16, v6
v_cvt_pk_bf16_f32 v18, v16, v17
ds_write_b32 v8, v18 offset:11872
v_mul_f32 v6, v16, v10
v_fma_f32 v6, -v17, v11, v6
v_mul_f32 v7, v16, v11
v_fma_f32 v17, v17, v10, v7
v_mov_b32 v16, v6
v_cvt_pk_bf16_f32 v18, v16, v17
ds_write_b32 v8, v18 offset:12400
v_mul_f32 v6, v16, v10
v_fma_f32 v6, -v17, v11, v6
v_mul_f32 v7, v16, v11
v_fma_f32 v17, v17, v10, v7
v_mov_b32 v16, v6
v_cvt_pk_bf16_f32 v18, v16, v17
ds_write_b32 v8, v18 offset:12928
v_mul_f32 v6, v16, v10
v_fma_f32 v6, -v17, v11, v6
v_mul_f32 v7, v16, v11
v_fma_f32 v17, v17, v10, v7
v_mov_b32 v16, v6
v_cvt_pk_bf16_f32 v18, v16, v17
ds_write_b32 v8, v18 offset:13456
v_mul_f32 v6, v16, v10
v_fma_f32 v6, -v17, v11, v6
v_mul_f32 v7, v16, v11
v_fma_f32 v17, v17, v10, v7
v_mov_b32 v16, v6
v_cvt_pk_bf16_f32 v18, v16, v17
ds_write_b32 v8, v18 offset:13984
v_mul_f32 v6, v16, v10
v_fma_f32 v6, -v17, v11, v6
v_mul_f32 v7, v16, v11
v_fma_f32 v17, v17, v10, v7
v_mov_b32 v16, v6
v_cvt_pk_bf16_f32 v18, v16, v17
ds_write_b32 v8, v18 offset:14512
v_mul_f32 v6, v16, v10
v_fma_f32 v6, -v17, v11, v6
v_mul_f32 v7, v16, v11
v_fma_f32 v17, v17, v10, v7
v_mov_b32 v16, v6
v_cvt_pk_bf16_f32 v18, v16, v17
ds_write_b32 v8, v18 offset:15040
v_mul_f32 v6, v16, v10
v_fma_f32 v6, -v17, v11, v6
v_mul_f32 v7, v16, v11
v_fma_f32 v17, v17, v10, v7
v_mov_b32 v16, v6
v_cvt_pk_bf16_f32 v18, v16, v17
ds_write_b32 v8, v18 offset:15568
v_mul_f32 v6, v16, v10
v_fma_f32 v6, -v17, v11, v6
v_mul_f32 v7, v16, v11
v_fma_f32 v17, v17, v10, v7
v_mov_b32 v16, v6
v_cvt_pk_bf16_f32 v18, v16, v17
ds_write_b32 v8, v18 offset:16096
v_mul_f32 v6, v16, v10
v_fma_f32 v6, -v17, v11, v6
v_mul_f32 v7, v16, v11
v_fma_f32 v17, v17, v10, v7
v_mov_b32 v16, v6
v_cvt_pk_bf16_f32 v18, v16, v17
ds_write_b32 v8, v18 offset:16624
v_sub_f32 v19, 0, v15
v_cvt_pk_bf16_f32 v18, v14, v19
ds_write_b32 v8, v18 offset:256
v_mul_f32 v6, v14, v12
v_fma_f32 v6, -v15, v13, v6
v_mul_f32 v7, v14, v13
v_fma_f32 v15, v15, v12, v7
v_mov_b32 v14, v6
v_sub_f32 v19, 0, v15
v_cvt_pk_bf16_f32 v18, v14, v19
ds_write_b32 v8, v18 offset:784
v_mul_f32 v6, v14, v12
v_fma_f32 v6, -v15, v13, v6
v_mul_f32 v7, v14, v13
v_fma_f32 v15, v15, v12, v7
v_mov_b32 v14, v6
v_sub_f32 v19, 0, v15
v_cvt_pk_bf16_f32 v18, v14, v19
ds_write_b32 v8, v18 offset:1312
v_mul_f32 v6, v14, v12
v_fma_f32 v6, -v15, v13, v6
v_mul_f32 v7, v14, v13
v_fma_f32 v15, v15, v12, v7
v_mov_b32 v14, v6
v_sub_f32 v19, 0, v15
v_cvt_pk_bf16_f32 v18, v14, v19
ds_write_b32 v8, v18 offset:1840
v_mul_f32 v6, v14, v12
v_fma_f32 v6, -v15, v13, v6
v_mul_f32 v7, v14, v13
v_fma_f32 v15, v15, v12, v7
v_mov_b32 v14, v6
v_sub_f32 v19, 0, v15
v_cvt_pk_bf16_f32 v18, v14, v19
ds_write_b32 v8, v18 offset:2368
v_mul_f32 v6, v14, v12
v_fma_f32 v6, -v15, v13, v6
v_mul_f32 v7, v14, v13
v_fma_f32 v15, v15, v12, v7
v_mov_b32 v14, v6
v_sub_f32 v19, 0, v15
v_cvt_pk_bf16_f32 v18, v14, v19
ds_write_b32 v8, v18 offset:2896
v_mul_f32 v6, v14, v12
v_fma_f32 v6, -v15, v13, v6
v_mul_f32 v7, v14, v13
v_fma_f32 v15, v15, v12, v7
v_mov_b32 v14, v6
v_sub_f32 v19, 0, v15
v_cvt_pk_bf16_f32 v18, v14, v19
ds_write_b32 v8, v18 offset:3424
v_mul_f32 v6, v14, v12
v_fma_f32 v6, -v15, v13, v6
v_mul_f32 v7, v14, v13
v_fma_f32 v15, v15, v12, v7
v_mov_b32 v14, v6
v_sub_f32 v19, 0, v15
v_cvt_pk_bf16_f32 v18, v14, v19
ds_write_b32 v8, v18 offset:3952
s_waitcnt lgkmcnt(0)
v_mov_b32 v20, 0
v_mov_b32 v21, 0
v_mov_b32 v22, 0
v_mov_b32 v23, 0
ds_read_b128 v[24:27], v9 offset:0
ds_read_b128 v[28:31], v9 offset:8448
s_waitcnt lgkmcnt(0)
v_mfma_f32_16x16x32_bf16 v[20:23], v[24:27], v[28:31], v[20:23]
ds_read_b128 v[24:27], v9 offset:64
ds_read_b128 v[28:31], v9 offset:8512
s_waitcnt lgkmcnt(0)
v_mfma_f32_16x16x32_bf16 v[20:23], v[24:27], v[28:31], v[20:23]
ds_read_b128 v[24:27], v9 offset:128
ds_read_b128 v[28:31], v9 offset:8576
s_waitcnt lgkmcnt(0)
v_mfma_f32_16x16x32_bf16 v[20:23], v[24:27], v[28:31], v[20:23]
ds_read_b128 v[24:27], v9 offset:192
ds_read_b128 v[28:31], v9 offset:8640
s_waitcnt lgkmcnt(0)
v_mfma_f32_16x16x32_bf16 v[20:23], v[24:27], v[28:31], v[20:23]
ds_read_b128 v[24:27], v9 offset:256
ds_read_b128 v[28:31], v9 offset:8704
s_waitcnt lgkmcnt(0)
v_mfma_f32_16x16x32_bf16 v[20:23], v[24:27], v[28:31], v[20:23]
ds_read_b128 v[24:27], v9 offset:320
ds_read_b128 v[28:31], v9 offset:8768
s_waitcnt lgkmcnt(0)
v_mfma_f32_16x16x32_bf16 v[20:23], v[24:27], v[28:31], v[20:23]
ds_read_b128 v[24:27], v9 offset:384
ds_read_b128 v[28:31], v9 offset:8832
s_waitcnt lgkmcnt(0)
v_mfma_f32_16x16x32_bf16 v[20:23], v[24:27], v[28:31], v[20:23]
ds_read_b128 v[24:27], v9 offset:448
ds_read_b128 v[28:31], v9 offset:8896
s_waitcnt lgkmcnt(0)
v_mfma_f32_16x16x32_bf16 v[20:23], v[24:27], v[28:31], v[20:23]
s_nop 7
s_nop 3
v_mov_b32 v88, v20
v_mov_b32 v89, v21
v_mov_b32 v90, v22
v_mov_b32 v91, v23
s_mov_b32 s23, 0x41000000
v_mul_f32 v4, s23, v64
v_mul_f32 v5, s23, v65
v_mul_f32 v4, 0x3fb8aa3b, v4
v_mul_f32 v5, 0x3e22f983, v5
v_exp_f32 v4, v4
v_fract_f32 v5, v5
v_cos_f32 v10, v5
v_sin_f32 v11, v5
s_nop 0
v_mul_f32 v10, v4, v10
v_mul_f32 v11, v4, v11
s_mov_b32 s23, 0x43000000
v_mul_f32 v4, s23, v64
v_mul_f32 v5, s23, v65
v_mul_f32 v4, 0x3fb8aa3b, v4
v_mul_f32 v5, 0x3e22f983, v5
v_exp_f32 v4, v4
v_fract_f32 v5, v5
v_cos_f32 v12, v5
v_sin_f32 v13, v5
s_nop 0
v_mul_f32 v12, v4, v12
v_mul_f32 v13, v4, v13
s_mov_b32 s23, 0x44800000
v_mul_f32 v4, s23, v64
v_mul_f32 v5, s23, v65
v_mul_f32 v4, 0x3fb8aa3b, v4
v_mul_f32 v5, 0x3e22f983, v5
v_exp_f32 v4, v4
v_fract_f32 v5, v5
v_cos_f32 v14, v5
v_sin_f32 v15, v5
s_nop 0
v_mul_f32 v14, v4, v14
v_mul_f32 v15, v4, v15
v_mul_f32 v6, v14, v70
v_fma_f32 v6, -v15, v71, v6
v_mul_f32 v7, v14, v71
v_fma_f32 v15, v15, v70, v7
v_mov_b32 v14, v6
v_mov_b32 v16, 1.0
v_mov_b32 v17, 0
v_cvt_pk_bf16_f32 v18, v16, v17
ds_write_b32 v8, v18 offset:8448
v_mul_f32 v6, v16, v10
v_fma_f32 v6, -v17, v11, v6
v_mul_f32 v7, v16, v11
v_fma_f32 v17, v17, v10, v7
v_mov_b32 v16, v6
v_cvt_pk_bf16_f32 v18, v16, v17
ds_write_b32 v8, v18 offset:8976
v_mul_f32 v6, v16, v10
v_fma_f32 v6, -v17, v11, v6
v_mul_f32 v7, v16, v11
v_fma_f32 v17, v17, v10, v7
v_mov_b32 v16, v6
v_cvt_pk_bf16_f32 v18, v16, v17
ds_write_b32 v8, v18 offset:9504
v_mul_f32 v6, v16, v10
v_fma_f32 v6, -v17, v11, v6
v_mul_f32 v7, v16, v11
v_fma_f32 v17, v17, v10, v7
v_mov_b32 v16, v6
v_cvt_pk_bf16_f32 v18, v16, v17
ds_write_b32 v8, v18 offset:10032
v_mul_f32 v6, v16, v10
v_fma_f32 v6, -v17, v11, v6
v_mul_f32 v7, v16, v11
v_fma_f32 v17, v17, v10, v7
v_mov_b32 v16, v6
v_cvt_pk_bf16_f32 v18, v16, v17
ds_write_b32 v8, v18 offset:10560
v_mul_f32 v6, v16, v10
v_fma_f32 v6, -v17, v11, v6
v_mul_f32 v7, v16, v11
v_fma_f32 v17, v17, v10, v7
v_mov_b32 v16, v6
v_cvt_pk_bf16_f32 v18, v16, v17
ds_write_b32 v8, v18 offset:11088
v_mul_f32 v6, v16, v10
v_fma_f32 v6, -v17, v11, v6
v_mul_f32 v7, v16, v11
v_fma_f32 v17, v17, v10, v7
v_mov_b32 v16, v6
v_cvt_pk_bf16_f32 v18, v16, v17
ds_write_b32 v8, v18 offset:11616
v_mul_f32 v6, v16, v10
v_fma_f32 v6, -v17, v11, v6
v_mul_f32 v7, v16, v11
v_fma_f32 v17, v17, v10, v7
v_mov_b32 v16, v6
v_cvt_pk_bf16_f32 v18, v16, v17
ds_write_b32 v8, v18 offset:12144
v_mul_f32 v6, v16, v10
v_fma_f32 v6, -v17, v11, v6
v_mul_f32 v7, v16, v11
v_fma_f32 v17, v17, v10, v7
v_mov_b32 v16, v6
v_cvt_pk_bf16_f32 v18, v16, v17
ds_write_b32 v8, v18 offset:12672
v_mul_f32 v6, v16, v10
v_fma_f32 v6, -v17, v11, v6
v_mul_f32 v7, v16, v11
v_fma_f32 v17, v17, v10, v7
v_mov_b32 v16, v6
v_cvt_pk_bf16_f32 v18, v16, v17
ds_write_b32 v8, v18 offset:13200
v_mul_f32 v6, v16, v10
v_fma_f32 v6, -v17, v11, v6
v_mul_f32 v7, v16, v11
v_fma_f32 v17, v17, v10, v7
v_mov_b32 v16, v6
v_cvt_pk_bf16_f32 v18, v16, v17
ds_write_b32 v8, v18 offset:13728
v_mul_f32 v6, v16, v10
v_fma_f32 v6, -v17, v11, v6
v_mul_f32 v7, v16, v11
v_fma_f32 v17, v17, v10, v7
v_mov_b32 v16, v6
v_cvt_pk_bf16_f32 v18, v16, v17
ds_write_b32 v8, v18 offset:14256
v_mul_f32 v6, v16, v10
v_fma_f32 v6, -v17, v11, v6
v_mul_f32 v7, v16, v11
v_fma_f32 v17, v17, v10, v7
v_mov_b32 v16, v6
v_cvt_pk_bf16_f32 v18, v16, v17
ds_write_b32 v8, v18 offset:14784
v_mul_f32 v6, v16, v10
v_fma_f32 v6, -v17, v11, v6
v_mul_f32 v7, v16, v11
v_fma_f32 v17, v17, v10, v7
v_mov_b32 v16, v6
v_cvt_pk_bf16_f32 v18, v16, v17
ds_write_b32 v8, v18 offset:15312
v_mul_f32 v6, v16, v10
v_fma_f32 v6, -v17, v11, v6
v_mul_f32 v7, v16, v11
v_fma_f32 v17, v17, v10, v7
v_mov_b32 v16, v6
v_cvt_pk_bf16_f32 v18, v16, v17
ds_write_b32 v8, v18 offset:15840
v_mul_f32 v6, v16, v10
v_fma_f32 v6, -v17, v11, v6
v_mul_f32 v7, v16, v11
v_fma_f32 v17, v17, v10, v7
v_mov_b32 v16, v6
v_cvt_pk_bf16_f32 v18, v16, v17
ds_write_b32 v8, v18 offset:16368
v_sub_f32 v19, 0, v15
v_cvt_pk_bf16_f32 v18, v14, v19
ds_write_b32 v8, v18 offset:0
v_mul_f32 v6, v14, v12
v_fma_f32 v6, -v15, v13, v6
v_mul_f32 v7, v14, v13
v_fma_f32 v15, v15, v12, v7
v_mov_b32 v14, v6
v_sub_f32 v19, 0, v15
v_cvt_pk_bf16_f32 v18, v14, v19
ds_write_b32 v8, v18 offset:528
v_mul_f32 v6, v14, v12
v_fma_f32 v6, -v15, v13, v6
v_mul_f32 v7, v14, v13
v_fma_f32 v15, v15, v12, v7
v_mov_b32 v14, v6
v_sub_f32 v19, 0, v15
v_cvt_pk_bf16_f32 v18, v14, v19
ds_write_b32 v8, v18 offset:1056
v_mul_f32 v6, v14, v12
v_fma_f32 v6, -v15, v13, v6
v_mul_f32 v7, v14, v13
v_fma_f32 v15, v15, v12, v7
v_mov_b32 v14, v6
v_sub_f32 v19, 0, v15
v_cvt_pk_bf16_f32 v18, v14, v19
ds_write_b32 v8, v18 offset:1584
v_mul_f32 v6, v14, v12
v_fma_f32 v6, -v15, v13, v6
v_mul_f32 v7, v14, v13
v_fma_f32 v15, v15, v12, v7
v_mov_b32 v14, v6
v_sub_f32 v19, 0, v15
v_cvt_pk_bf16_f32 v18, v14, v19
ds_write_b32 v8, v18 offset:2112
v_mul_f32 v6, v14, v12
v_fma_f32 v6, -v15, v13, v6
v_mul_f32 v7, v14, v13
v_fma_f32 v15, v15, v12, v7
v_mov_b32 v14, v6
v_sub_f32 v19, 0, v15
v_cvt_pk_bf16_f32 v18, v14, v19
ds_write_b32 v8, v18 offset:2640
v_mul_f32 v6, v14, v12
v_fma_f32 v6, -v15, v13, v6
v_mul_f32 v7, v14, v13
v_fma_f32 v15, v15, v12, v7
v_mov_b32 v14, v6
v_sub_f32 v19, 0, v15
v_cvt_pk_bf16_f32 v18, v14, v19
ds_write_b32 v8, v18 offset:3168
v_mul_f32 v6, v14, v12
v_fma_f32 v6, -v15, v13, v6
v_mul_f32 v7, v14, v13
v_fma_f32 v15, v15, v12, v7
v_mov_b32 v14, v6
v_sub_f32 v19, 0, v15
v_cvt_pk_bf16_f32 v18, v14, v19
ds_write_b32 v8, v18 offset:3696
v_mul_f32 v6, v14, v12
v_fma_f32 v6, -v15, v13, v6
v_mul_f32 v7, v14, v13
v_fma_f32 v15, v15, v12, v7
v_mov_b32 v14, v6
v_sub_f32 v19, 0, v15
v_cvt_pk_bf16_f32 v18, v14, v19
ds_write_b32 v8, v18 offset:4224
s_mov_b32 s23, 0x41000000
v_mul_f32 v4, s23, v72
v_mul_f32 v5, s23, v73
v_mul_f32 v4, 0x3fb8aa3b, v4
v_mul_f32 v5, 0x3e22f983, v5
v_exp_f32 v4, v4
v_fract_f32 v5, v5
v_cos_f32 v10, v5
v_sin_f32 v11, v5
s_nop 0
v_mul_f32 v10, v4, v10
v_mul_f32 v11, v4, v11
s_mov_b32 s23, 0x43000000
v_mul_f32 v4, s23, v72
v_mul_f32 v5, s23, v73
v_mul_f32 v4, 0x3fb8aa3b, v4
v_mul_f32 v5, 0x3e22f983, v5
v_exp_f32 v4, v4
v_fract_f32 v5, v5
v_cos_f32 v12, v5
v_sin_f32 v13, v5
s_nop 0
v_mul_f32 v12, v4, v12
v_mul_f32 v13, v4, v13
s_mov_b32 s23, 0x44800000
v_mul_f32 v4, s23, v72
v_mul_f32 v5, s23, v73
v_mul_f32 v4, 0x3fb8aa3b, v4
v_mul_f32 v5, 0x3e22f983, v5
v_exp_f32 v4, v4
v_fract_f32 v5, v5
v_cos_f32 v14, v5
v_sin_f32 v15, v5
s_nop 0
v_mul_f32 v14, v4, v14
v_mul_f32 v15, v4, v15
v_mul_f32 v6, v14, v78
v_fma_f32 v6, -v15, v79, v6
v_mul_f32 v7, v14, v79
v_fma_f32 v15, v15, v78, v7
v_mov_b32 v14, v6
v_mov_b32 v16, 1.0
v_mov_b32 v17, 0
v_cvt_pk_bf16_f32 v18, v16, v17
ds_write_b32 v8, v18 offset:8704
v_mul_f32 v6, v16, v10
v_fma_f32 v6, -v17, v11, v6
v_mul_f32 v7, v16, v11
v_fma_f32 v17, v17, v10, v7
v_mov_b32 v16, v6
v_cvt_pk_bf16_f32 v18, v16, v17
ds_write_b32 v8, v18 offset:9232
v_mul_f32 v6, v16, v10
v_fma_f32 v6, -v17, v11, v6
v_mul_f32 v7, v16, v11
v_fma_f32 v17, v17, v10, v7
v_mov_b32 v16, v6
v_cvt_pk_bf16_f32 v18, v16, v17
ds_write_b32 v8, v18 offset:9760
v_mul_f32 v6, v16, v10
v_fma_f32 v6, -v17, v11, v6
v_mul_f32 v7, v16, v11
v_fma_f32 v17, v17, v10, v7
v_mov_b32 v16, v6
v_cvt_pk_bf16_f32 v18, v16, v17
ds_write_b32 v8, v18 offset:10288
v_mul_f32 v6, v16, v10
v_fma_f32 v6, -v17, v11, v6
v_mul_f32 v7, v16, v11
v_fma_f32 v17, v17, v10, v7
v_mov_b32 v16, v6
v_cvt_pk_bf16_f32 v18, v16, v17
ds_write_b32 v8, v18 offset:10816
v_mul_f32 v6, v16, v10
v_fma_f32 v6, -v17, v11, v6
v_mul_f32 v7, v16, v11
v_fma_f32 v17, v17, v10, v7
v_mov_b32 v16, v6
v_cvt_pk_bf16_f32 v18, v16, v17
ds_write_b32 v8, v18 offset:11344
v_mul_f32 v6, v16, v10
v_fma_f32 v6, -v17, v11, v6
v_mul_f32 v7, v16, v11
v_fma_f32 v17, v17, v10, v7
v_mov_b32 v16, v6
v_cvt_pk_bf16_f32 v18, v16, v17
ds_write_b32 v8, v18 offset:11872
v_mul_f32 v6, v16, v10
v_fma_f32 v6, -v17, v11, v6
v_mul_f32 v7, v16, v11
v_fma_f32 v17, v17, v10, v7
v_mov_b32 v16, v6
v_cvt_pk_bf16_f32 v18, v16, v17
ds_write_b32 v8, v18 offset:12400
v_mul_f32 v6, v16, v10
v_fma_f32 v6, -v17, v11, v6
v_mul_f32 v7, v16, v11
v_fma_f32 v17, v17, v10, v7
v_mov_b32 v16, v6
v_cvt_pk_bf16_f32 v18, v16, v17
ds_write_b32 v8, v18 offset:12928
v_mul_f32 v6, v16, v10
v_fma_f32 v6, -v17, v11, v6
v_mul_f32 v7, v16, v11
v_fma_f32 v17, v17, v10, v7
v_mov_b32 v16, v6
v_cvt_pk_bf16_f32 v18, v16, v17
ds_write_b32 v8, v18 offset:13456
v_mul_f32 v6, v16, v10
v_fma_f32 v6, -v17, v11, v6
v_mul_f32 v7, v16, v11
v_fma_f32 v17, v17, v10, v7
v_mov_b32 v16, v6
v_cvt_pk_bf16_f32 v18, v16, v17
ds_write_b32 v8, v18 offset:13984
v_mul_f32 v6, v16, v10
v_fma_f32 v6, -v17, v11, v6
v_mul_f32 v7, v16, v11
v_fma_f32 v17, v17, v10, v7
v_mov_b32 v16, v6
v_cvt_pk_bf16_f32 v18, v16, v17
ds_write_b32 v8, v18 offset:14512
v_mul_f32 v6, v16, v10
v_fma_f32 v6, -v17, v11, v6
v_mul_f32 v7, v16, v11
v_fma_f32 v17, v17, v10, v7
v_mov_b32 v16, v6
v_cvt_pk_bf16_f32 v18, v16, v17
ds_write_b32 v8, v18 offset:15040
v_mul_f32 v6, v16, v10
v_fma_f32 v6, -v17, v11, v6
v_mul_f32 v7, v16, v11
v_fma_f32 v17, v17, v10, v7
v_mov_b32 v16, v6
v_cvt_pk_bf16_f32 v18, v16, v17
ds_write_b32 v8, v18 offset:15568
v_mul_f32 v6, v16, v10
v_fma_f32 v6, -v17, v11, v6
v_mul_f32 v7, v16, v11
v_fma_f32 v17, v17, v10, v7
v_mov_b32 v16, v6
v_cvt_pk_bf16_f32 v18, v16, v17
ds_write_b32 v8, v18 offset:16096
v_mul_f32 v6, v16, v10
v_fma_f32 v6, -v17, v11, v6
v_mul_f32 v7, v16, v11
v_fma_f32 v17, v17, v10, v7
v_mov_b32 v16, v6
v_cvt_pk_bf16_f32 v18, v16, v17
ds_write_b32 v8, v18 offset:16624
v_sub_f32 v19, 0, v15
v_cvt_pk_bf16_f32 v18, v14, v19
ds_write_b32 v8, v18 offset:256
v_mul_f32 v6, v14, v12
v_fma_f32 v6, -v15, v13, v6
v_mul_f32 v7, v14, v13
v_fma_f32 v15, v15, v12, v7
v_mov_b32 v14, v6
v_sub_f32 v19, 0, v15
v_cvt_pk_bf16_f32 v18, v14, v19
ds_write_b32 v8, v18 offset:784
v_mul_f32 v6, v14, v12
v_fma_f32 v6, -v15, v13, v6
v_mul_f32 v7, v14, v13
v_fma_f32 v15, v15, v12, v7
v_mov_b32 v14, v6
v_sub_f32 v19, 0, v15
v_cvt_pk_bf16_f32 v18, v14, v19
ds_write_b32 v8, v18 offset:1312
v_mul_f32 v6, v14, v12
v_fma_f32 v6, -v15, v13, v6
v_mul_f32 v7, v14, v13
v_fma_f32 v15, v15, v12, v7
v_mov_b32 v14, v6
v_sub_f32 v19, 0, v15
v_cvt_pk_bf16_f32 v18, v14, v19
ds_write_b32 v8, v18 offset:1840
v_mul_f32 v6, v14, v12
v_fma_f32 v6, -v15, v13, v6
v_mul_f32 v7, v14, v13
v_fma_f32 v15, v15, v12, v7
v_mov_b32 v14, v6
v_sub_f32 v19, 0, v15
v_cvt_pk_bf16_f32 v18, v14, v19
ds_write_b32 v8, v18 offset:2368
v_mul_f32 v6, v14, v12
v_fma_f32 v6, -v15, v13, v6
v_mul_f32 v7, v14, v13
v_fma_f32 v15, v15, v12, v7
v_mov_b32 v14, v6
v_sub_f32 v19, 0, v15
v_cvt_pk_bf16_f32 v18, v14, v19
ds_write_b32 v8, v18 offset:2896
v_mul_f32 v6, v14, v12
v_fma_f32 v6, -v15, v13, v6
v_mul_f32 v7, v14, v13
v_fma_f32 v15, v15, v12, v7
v_mov_b32 v14, v6
v_sub_f32 v19, 0, v15
v_cvt_pk_bf16_f32 v18, v14, v19
ds_write_b32 v8, v18 offset:3424
v_mul_f32 v6, v14, v12
v_fma_f32 v6, -v15, v13, v6
v_mul_f32 v7, v14, v13
v_fma_f32 v15, v15, v12, v7
v_mov_b32 v14, v6
v_sub_f32 v19, 0, v15
v_cvt_pk_bf16_f32 v18, v14, v19
ds_write_b32 v8, v18 offset:3952
v_mul_f32 v6, v14, v12
v_fma_f32 v6, -v15, v13, v6
v_mul_f32 v7, v14, v13
v_fma_f32 v15, v15, v12, v7
v_mov_b32 v14, v6
v_sub_f32 v19, 0, v15
v_cvt_pk_bf16_f32 v18, v14, v19
ds_write_b32 v8, v18 offset:4480
s_waitcnt lgkmcnt(0)
v_mov_b32 v20, 0
v_mov_b32 v21, 0
v_mov_b32 v22, 0
v_mov_b32 v23, 0
ds_read_b128 v[24:27], v9 offset:0
ds_read_b128 v[28:31], v9 offset:8448
s_waitcnt lgkmcnt(0)
v_mfma_f32_16x16x32_bf16 v[20:23], v[24:27], v[28:31], v[20:23]
ds_read_b128 v[24:27], v9 offset:64
ds_read_b128 v[28:31], v9 offset:8512
s_waitcnt lgkmcnt(0)
v_mfma_f32_16x16x32_bf16 v[20:23], v[24:27], v[28:31], v[20:23]
ds_read_b128 v[24:27], v9 offset:128
ds_read_b128 v[28:31], v9 offset:8576
s_waitcnt lgkmcnt(0)
v_mfma_f32_16x16x32_bf16 v[20:23], v[24:27], v[28:31], v[20:23]
ds_read_b128 v[24:27], v9 offset:192
ds_read_b128 v[28:31], v9 offset:8640
s_waitcnt lgkmcnt(0)
v_mfma_f32_16x16x32_bf16 v[20:23], v[24:27], v[28:31], v[20:23]
ds_read_b128 v[24:27], v9 offset:256
ds_read_b128 v[28:31], v9 offset:8704
s_waitcnt lgkmcnt(0)
v_mfma_f32_16x16x32_bf16 v[20:23], v[24:27], v[28:31], v[20:23]
ds_read_b128 v[24:27], v9 offset:320
ds_read_b128 v[28:31], v9 offset:8768
s_waitcnt lgkmcnt(0)
v_mfma_f32_16x16x32_bf16 v[20:23], v[24:27], v[28:31], v[20:23]
ds_read_b128 v[24:27], v9 offset:384
ds_read_b128 v[28:31], v9 offset:8832
s_waitcnt lgkmcnt(0)
v_mfma_f32_16x16x32_bf16 v[20:23], v[24:27], v[28:31], v[20:23]
ds_read_b128 v[24:27], v9 offset:448
ds_read_b128 v[28:31], v9 offset:8896
s_waitcnt lgkmcnt(0)
v_mfma_f32_16x16x32_bf16 v[20:23], v[24:27], v[28:31], v[20:23]
s_nop 7
s_nop 3
v_mov_b32 v92, v20
v_mov_b32 v93, v21
v_mov_b32 v94, v22
v_mov_b32 v95, v23
v_and_b32 v3, 15, v1
v_lshrrev_b32 v4, 4, v1
v_lshl_add_u32 v3, v4, 6, v3
v_lshl_add_u32 v3, v3, 2, s46
v_cmp_gt_u32 vcc, 64, v1
s_and_saveexec_b64 s[54:55], vcc
ds_write_b32 v3, v80 offset:0
ds_write_b32 v3, v81 offset:64
ds_write_b32 v3, v82 offset:128
ds_write_b32 v3, v83 offset:192
s_mov_b64 exec, s[54:55]
v_cmp_gt_u32 vcc, 32, v1
s_and_saveexec_b64 s[54:55], vcc
ds_write_b32 v3, v84 offset:1024
ds_write_b32 v3, v85 offset:1088
ds_write_b32 v3, v86 offset:1152
ds_write_b32 v3, v87 offset:1216
s_mov_b64 exec, s[54:55]
v_cmp_gt_u32 vcc, 32, v1
s_and_saveexec_b64 s[54:55], vcc
ds_write_b32 v3, v88 offset:1536
ds_write_b32 v3, v89 offset:1600
ds_write_b32 v3, v90 offset:1664
ds_write_b32 v3, v91 offset:1728
s_mov_b64 exec, s[54:55]
v_cmp_gt_u32 vcc, 48, v1
s_and_saveexec_b64 s[54:55], vcc
ds_write_b32 v3, v92 offset:2048
ds_write_b32 v3, v93 offset:2112
ds_write_b32 v3, v94 offset:2176
ds_write_b32 v3, v95 offset:2240
s_mov_b64 exec, s[54:55]
s_waitcnt lgkmcnt(0)
s_lshl_b32 s23, s21, 12
s_add_u32 s23, s23, 6291456
v_lshlrev_b32 v10, 1, v1
v_sub_u32 v10, 2047, v10
v_add_u32 v11, -1, v10
v_cvt_f32_u32 v4, v10
v_bfe_u32 v5, v4, 16, 1
v_add3_u32 v4, v4, v5, s60
v_and_b32 v4, 0xffff0000, v4
v_cvt_u32_f32 v4, v4
v_mov_b32 v12, v4
v_subrev_u32 v5, 256, v4
v_lshrrev_b32 v5, 1, v5
v_add_u32 v5, 256, v5
v_cmp_lt_u32 vcc, 256, v4
s_nop 1
v_cndmask_b32 v12, v12, v5, vcc
v_subrev_u32 v5, 512, v4
v_lshrrev_b32 v5, 2, v5
v_add_u32 v5, 384, v5
v_cmp_lt_u32 vcc, 512, v4
s_nop 1
v_cndmask_b32 v12, v12, v5, vcc
v_subrev_u32 v5, 1024, v4
v_lshrrev_b32 v5, 3, v5
v_add_u32 v5, 512, v5
v_cmp_lt_u32 vcc, 1024, v4
s_nop 1
v_cndmask_b32 v12, v12, v5, vcc
v_lshl_add_u32 v12, v12, 2, s46
v_cvt_f32_u32 v4, v11
v_bfe_u32 v5, v4, 16, 1
v_add3_u32 v4, v4, v5, s60
v_and_b32 v4, 0xffff0000, v4
v_cvt_u32_f32 v4, v4
v_mov_b32 v13, v4
v_subrev_u32 v5, 256, v4
v_lshrrev_b32 v5, 1, v5
v_add_u32 v5, 256, v5
v_cmp_lt_u32 vcc, 256, v4
s_nop 1
v_cndmask_b32 v13, v13, v5, vcc
v_subrev_u32 v5, 512, v4
v_lshrrev_b32 v5, 2, v5
v_add_u32 v5, 384, v5
v_cmp_lt_u32 vcc, 512, v4
s_nop 1
v_cndmask_b32 v13, v13, v5, vcc
v_subrev_u32 v5, 1024, v4
v_lshrrev_b32 v5, 3, v5
v_add_u32 v5, 512, v5
v_cmp_lt_u32 vcc, 1024, v4
s_nop 1
v_cndmask_b32 v13, v13, v5, vcc
v_lshl_add_u32 v13, v13, 2, s46
ds_read_b32 v14, v12
ds_read_b32 v15, v13
s_waitcnt lgkmcnt(0)
v_cvt_pk_bf16_f32 v14, v14, v15
v_lshl_add_u32 v16, v1, 2, s23
buffer_store_dword v14, v16, s[16:19], 0 offen offset:0
v_lshlrev_b32 v10, 1, v1
v_sub_u32 v10, 1919, v10
v_add_u32 v11, -1, v10
v_cvt_f32_u32 v4, v10
v_bfe_u32 v5, v4, 16, 1
v_add3_u32 v4, v4, v5, s60
v_and_b32 v4, 0xffff0000, v4
v_cvt_u32_f32 v4, v4
v_mov_b32 v12, v4
v_subrev_u32 v5, 256, v4
v_lshrrev_b32 v5, 1, v5
v_add_u32 v5, 256, v5
v_cmp_lt_u32 vcc, 256, v4
s_nop 1
v_cndmask_b32 v12, v12, v5, vcc
v_subrev_u32 v5, 512, v4
v_lshrrev_b32 v5, 2, v5
v_add_u32 v5, 384, v5
v_cmp_lt_u32 vcc, 512, v4
s_nop 1
v_cndmask_b32 v12, v12, v5, vcc
v_subrev_u32 v5, 1024, v4
v_lshrrev_b32 v5, 3, v5
v_add_u32 v5, 512, v5
v_cmp_lt_u32 vcc, 1024, v4
s_nop 1
v_cndmask_b32 v12, v12, v5, vcc
v_lshl_add_u32 v12, v12, 2, s46
v_cvt_f32_u32 v4, v11
v_bfe_u32 v5, v4, 16, 1
v_add3_u32 v4, v4, v5, s60
v_and_b32 v4, 0xffff0000, v4
v_cvt_u32_f32 v4, v4
v_mov_b32 v13, v4
v_subrev_u32 v5, 256, v4
v_lshrrev_b32 v5, 1, v5
v_add_u32 v5, 256, v5
v_cmp_lt_u32 vcc, 256, v4
s_nop 1
v_cndmask_b32 v13, v13, v5, vcc
v_subrev_u32 v5, 512, v4
v_lshrrev_b32 v5, 2, v5
v_add_u32 v5, 384, v5
v_cmp_lt_u32 vcc, 512, v4
s_nop 1
v_cndmask_b32 v13, v13, v5, vcc
v_subrev_u32 v5, 1024, v4
v_lshrrev_b32 v5, 3, v5
v_add_u32 v5, 512, v5
v_cmp_lt_u32 vcc, 1024, v4
s_nop 1
v_cndmask_b32 v13, v13, v5, vcc
v_lshl_add_u32 v13, v13, 2, s46
ds_read_b32 v14, v12
ds_read_b32 v15, v13
s_waitcnt lgkmcnt(0)
v_cvt_pk_bf16_f32 v14, v14, v15
v_lshl_add_u32 v16, v1, 2, s23
buffer_store_dword v14, v16, s[16:19], 0 offen offset:256
v_lshlrev_b32 v10, 1, v1
v_sub_u32 v10, 1791, v10
v_add_u32 v11, -1, v10
v_cvt_f32_u32 v4, v10
v_bfe_u32 v5, v4, 16, 1
v_add3_u32 v4, v4, v5, s60
v_and_b32 v4, 0xffff0000, v4
v_cvt_u32_f32 v4, v4
v_mov_b32 v12, v4
v_subrev_u32 v5, 256, v4
v_lshrrev_b32 v5, 1, v5
v_add_u32 v5, 256, v5
v_cmp_lt_u32 vcc, 256, v4
s_nop 1
v_cndmask_b32 v12, v12, v5, vcc
v_subrev_u32 v5, 512, v4
v_lshrrev_b32 v5, 2, v5
v_add_u32 v5, 384, v5
v_cmp_lt_u32 vcc, 512, v4
s_nop 1
v_cndmask_b32 v12, v12, v5, vcc
v_subrev_u32 v5, 1024, v4
v_lshrrev_b32 v5, 3, v5
v_add_u32 v5, 512, v5
v_cmp_lt_u32 vcc, 1024, v4
s_nop 1
v_cndmask_b32 v12, v12, v5, vcc
v_lshl_add_u32 v12, v12, 2, s46
v_cvt_f32_u32 v4, v11
v_bfe_u32 v5, v4, 16, 1
v_add3_u32 v4, v4, v5, s60
v_and_b32 v4, 0xffff0000, v4
v_cvt_u32_f32 v4, v4
v_mov_b32 v13, v4
v_subrev_u32 v5, 256, v4
v_lshrrev_b32 v5, 1, v5
v_add_u32 v5, 256, v5
v_cmp_lt_u32 vcc, 256, v4
s_nop 1
v_cndmask_b32 v13, v13, v5, vcc
v_subrev_u32 v5, 512, v4
v_lshrrev_b32 v5, 2, v5
v_add_u32 v5, 384, v5
v_cmp_lt_u32 vcc, 512, v4
s_nop 1
v_cndmask_b32 v13, v13, v5, vcc
v_subrev_u32 v5, 1024, v4
v_lshrrev_b32 v5, 3, v5
v_add_u32 v5, 512, v5
v_cmp_lt_u32 vcc, 1024, v4
s_nop 1
v_cndmask_b32 v13, v13, v5, vcc
v_lshl_add_u32 v13, v13, 2, s46
ds_read_b32 v14, v12
ds_read_b32 v15, v13
s_waitcnt lgkmcnt(0)
v_cvt_pk_bf16_f32 v14, v14, v15
v_lshl_add_u32 v16, v1, 2, s23
buffer_store_dword v14, v16, s[16:19], 0 offen offset:512
v_lshlrev_b32 v10, 1, v1
v_sub_u32 v10, 1663, v10
v_add_u32 v11, -1, v10
v_cvt_f32_u32 v4, v10
v_bfe_u32 v5, v4, 16, 1
v_add3_u32 v4, v4, v5, s60
v_and_b32 v4, 0xffff0000, v4
v_cvt_u32_f32 v4, v4
v_mov_b32 v12, v4
v_subrev_u32 v5, 256, v4
v_lshrrev_b32 v5, 1, v5
v_add_u32 v5, 256, v5
v_cmp_lt_u32 vcc, 256, v4
s_nop 1
v_cndmask_b32 v12, v12, v5, vcc
v_subrev_u32 v5, 512, v4
v_lshrrev_b32 v5, 2, v5
v_add_u32 v5, 384, v5
v_cmp_lt_u32 vcc, 512, v4
s_nop 1
v_cndmask_b32 v12, v12, v5, vcc
v_subrev_u32 v5, 1024, v4
v_lshrrev_b32 v5, 3, v5
v_add_u32 v5, 512, v5
v_cmp_lt_u32 vcc, 1024, v4
s_nop 1
v_cndmask_b32 v12, v12, v5, vcc
v_lshl_add_u32 v12, v12, 2, s46
v_cvt_f32_u32 v4, v11
v_bfe_u32 v5, v4, 16, 1
v_add3_u32 v4, v4, v5, s60
v_and_b32 v4, 0xffff0000, v4
v_cvt_u32_f32 v4, v4
v_mov_b32 v13, v4
v_subrev_u32 v5, 256, v4
v_lshrrev_b32 v5, 1, v5
v_add_u32 v5, 256, v5
v_cmp_lt_u32 vcc, 256, v4
s_nop 1
v_cndmask_b32 v13, v13, v5, vcc
v_subrev_u32 v5, 512, v4
v_lshrrev_b32 v5, 2, v5
v_add_u32 v5, 384, v5
v_cmp_lt_u32 vcc, 512, v4
s_nop 1
v_cndmask_b32 v13, v13, v5, vcc
v_subrev_u32 v5, 1024, v4
v_lshrrev_b32 v5, 3, v5
v_add_u32 v5, 512, v5
v_cmp_lt_u32 vcc, 1024, v4
s_nop 1
v_cndmask_b32 v13, v13, v5, vcc
v_lshl_add_u32 v13, v13, 2, s46
ds_read_b32 v14, v12
ds_read_b32 v15, v13
s_waitcnt lgkmcnt(0)
v_cvt_pk_bf16_f32 v14, v14, v15
v_lshl_add_u32 v16, v1, 2, s23
buffer_store_dword v14, v16, s[16:19], 0 offen offset:768
v_lshlrev_b32 v10, 1, v1
v_sub_u32 v10, 1535, v10
v_add_u32 v11, -1, v10
v_cvt_f32_u32 v4, v10
v_bfe_u32 v5, v4, 16, 1
v_add3_u32 v4, v4, v5, s60
v_and_b32 v4, 0xffff0000, v4
v_cvt_u32_f32 v4, v4
v_mov_b32 v12, v4
v_subrev_u32 v5, 256, v4
v_lshrrev_b32 v5, 1, v5
v_add_u32 v5, 256, v5
v_cmp_lt_u32 vcc, 256, v4
s_nop 1
v_cndmask_b32 v12, v12, v5, vcc
v_subrev_u32 v5, 512, v4
v_lshrrev_b32 v5, 2, v5
v_add_u32 v5, 384, v5
v_cmp_lt_u32 vcc, 512, v4
s_nop 1
v_cndmask_b32 v12, v12, v5, vcc
v_subrev_u32 v5, 1024, v4
v_lshrrev_b32 v5, 3, v5
v_add_u32 v5, 512, v5
v_cmp_lt_u32 vcc, 1024, v4
s_nop 1
v_cndmask_b32 v12, v12, v5, vcc
v_lshl_add_u32 v12, v12, 2, s46
v_cvt_f32_u32 v4, v11
v_bfe_u32 v5, v4, 16, 1
v_add3_u32 v4, v4, v5, s60
v_and_b32 v4, 0xffff0000, v4
v_cvt_u32_f32 v4, v4
v_mov_b32 v13, v4
v_subrev_u32 v5, 256, v4
v_lshrrev_b32 v5, 1, v5
v_add_u32 v5, 256, v5
v_cmp_lt_u32 vcc, 256, v4
s_nop 1
v_cndmask_b32 v13, v13, v5, vcc
v_subrev_u32 v5, 512, v4
v_lshrrev_b32 v5, 2, v5
v_add_u32 v5, 384, v5
v_cmp_lt_u32 vcc, 512, v4
s_nop 1
v_cndmask_b32 v13, v13, v5, vcc
v_subrev_u32 v5, 1024, v4
v_lshrrev_b32 v5, 3, v5
v_add_u32 v5, 512, v5
v_cmp_lt_u32 vcc, 1024, v4
s_nop 1
v_cndmask_b32 v13, v13, v5, vcc
v_lshl_add_u32 v13, v13, 2, s46
ds_read_b32 v14, v12
ds_read_b32 v15, v13
s_waitcnt lgkmcnt(0)
v_cvt_pk_bf16_f32 v14, v14, v15
v_lshl_add_u32 v16, v1, 2, s23
buffer_store_dword v14, v16, s[16:19], 0 offen offset:1024
v_lshlrev_b32 v10, 1, v1
v_sub_u32 v10, 1407, v10
v_add_u32 v11, -1, v10
v_cvt_f32_u32 v4, v10
v_bfe_u32 v5, v4, 16, 1
v_add3_u32 v4, v4, v5, s60
v_and_b32 v4, 0xffff0000, v4
v_cvt_u32_f32 v4, v4
v_mov_b32 v12, v4
v_subrev_u32 v5, 256, v4
v_lshrrev_b32 v5, 1, v5
v_add_u32 v5, 256, v5
v_cmp_lt_u32 vcc, 256, v4
s_nop 1
v_cndmask_b32 v12, v12, v5, vcc
v_subrev_u32 v5, 512, v4
v_lshrrev_b32 v5, 2, v5
v_add_u32 v5, 384, v5
v_cmp_lt_u32 vcc, 512, v4
s_nop 1
v_cndmask_b32 v12, v12, v5, vcc
v_subrev_u32 v5, 1024, v4
v_lshrrev_b32 v5, 3, v5
v_add_u32 v5, 512, v5
v_cmp_lt_u32 vcc, 1024, v4
s_nop 1
v_cndmask_b32 v12, v12, v5, vcc
v_lshl_add_u32 v12, v12, 2, s46
v_cvt_f32_u32 v4, v11
v_bfe_u32 v5, v4, 16, 1
v_add3_u32 v4, v4, v5, s60
v_and_b32 v4, 0xffff0000, v4
v_cvt_u32_f32 v4, v4
v_mov_b32 v13, v4
v_subrev_u32 v5, 256, v4
v_lshrrev_b32 v5, 1, v5
v_add_u32 v5, 256, v5
v_cmp_lt_u32 vcc, 256, v4
s_nop 1
v_cndmask_b32 v13, v13, v5, vcc
v_subrev_u32 v5, 512, v4
v_lshrrev_b32 v5, 2, v5
v_add_u32 v5, 384, v5
v_cmp_lt_u32 vcc, 512, v4
s_nop 1
v_cndmask_b32 v13, v13, v5, vcc
v_subrev_u32 v5, 1024, v4
v_lshrrev_b32 v5, 3, v5
v_add_u32 v5, 512, v5
v_cmp_lt_u32 vcc, 1024, v4
s_nop 1
v_cndmask_b32 v13, v13, v5, vcc
v_lshl_add_u32 v13, v13, 2, s46
ds_read_b32 v14, v12
ds_read_b32 v15, v13
s_waitcnt lgkmcnt(0)
v_cvt_pk_bf16_f32 v14, v14, v15
v_lshl_add_u32 v16, v1, 2, s23
buffer_store_dword v14, v16, s[16:19], 0 offen offset:1280
v_lshlrev_b32 v10, 1, v1
v_sub_u32 v10, 1279, v10
v_add_u32 v11, -1, v10
v_cvt_f32_u32 v4, v10
v_bfe_u32 v5, v4, 16, 1
v_add3_u32 v4, v4, v5, s60
v_and_b32 v4, 0xffff0000, v4
v_cvt_u32_f32 v4, v4
v_mov_b32 v12, v4
v_subrev_u32 v5, 256, v4
v_lshrrev_b32 v5, 1, v5
v_add_u32 v5, 256, v5
v_cmp_lt_u32 vcc, 256, v4
s_nop 1
v_cndmask_b32 v12, v12, v5, vcc
v_subrev_u32 v5, 512, v4
v_lshrrev_b32 v5, 2, v5
v_add_u32 v5, 384, v5
v_cmp_lt_u32 vcc, 512, v4
s_nop 1
v_cndmask_b32 v12, v12, v5, vcc
v_subrev_u32 v5, 1024, v4
v_lshrrev_b32 v5, 3, v5
v_add_u32 v5, 512, v5
v_cmp_lt_u32 vcc, 1024, v4
s_nop 1
v_cndmask_b32 v12, v12, v5, vcc
v_lshl_add_u32 v12, v12, 2, s46
v_cvt_f32_u32 v4, v11
v_bfe_u32 v5, v4, 16, 1
v_add3_u32 v4, v4, v5, s60
v_and_b32 v4, 0xffff0000, v4
v_cvt_u32_f32 v4, v4
v_mov_b32 v13, v4
v_subrev_u32 v5, 256, v4
v_lshrrev_b32 v5, 1, v5
v_add_u32 v5, 256, v5
v_cmp_lt_u32 vcc, 256, v4
s_nop 1
v_cndmask_b32 v13, v13, v5, vcc
v_subrev_u32 v5, 512, v4
v_lshrrev_b32 v5, 2, v5
v_add_u32 v5, 384, v5
v_cmp_lt_u32 vcc, 512, v4
s_nop 1
v_cndmask_b32 v13, v13, v5, vcc
v_subrev_u32 v5, 1024, v4
v_lshrrev_b32 v5, 3, v5
v_add_u32 v5, 512, v5
v_cmp_lt_u32 vcc, 1024, v4
s_nop 1
v_cndmask_b32 v13, v13, v5, vcc
v_lshl_add_u32 v13, v13, 2, s46
ds_read_b32 v14, v12
ds_read_b32 v15, v13
s_waitcnt lgkmcnt(0)
v_cvt_pk_bf16_f32 v14, v14, v15
v_lshl_add_u32 v16, v1, 2, s23
buffer_store_dword v14, v16, s[16:19], 0 offen offset:1536
v_lshlrev_b32 v10, 1, v1
v_sub_u32 v10, 1151, v10
v_add_u32 v11, -1, v10
v_cvt_f32_u32 v4, v10
v_bfe_u32 v5, v4, 16, 1
v_add3_u32 v4, v4, v5, s60
v_and_b32 v4, 0xffff0000, v4
v_cvt_u32_f32 v4, v4
v_mov_b32 v12, v4
v_subrev_u32 v5, 256, v4
v_lshrrev_b32 v5, 1, v5
v_add_u32 v5, 256, v5
v_cmp_lt_u32 vcc, 256, v4
s_nop 1
v_cndmask_b32 v12, v12, v5, vcc
v_subrev_u32 v5, 512, v4
v_lshrrev_b32 v5, 2, v5
v_add_u32 v5, 384, v5
v_cmp_lt_u32 vcc, 512, v4
s_nop 1
v_cndmask_b32 v12, v12, v5, vcc
v_subrev_u32 v5, 1024, v4
v_lshrrev_b32 v5, 3, v5
v_add_u32 v5, 512, v5
v_cmp_lt_u32 vcc, 1024, v4
s_nop 1
v_cndmask_b32 v12, v12, v5, vcc
v_lshl_add_u32 v12, v12, 2, s46
v_cvt_f32_u32 v4, v11
v_bfe_u32 v5, v4, 16, 1
v_add3_u32 v4, v4, v5, s60
v_and_b32 v4, 0xffff0000, v4
v_cvt_u32_f32 v4, v4
v_mov_b32 v13, v4
v_subrev_u32 v5, 256, v4
v_lshrrev_b32 v5, 1, v5
v_add_u32 v5, 256, v5
v_cmp_lt_u32 vcc, 256, v4
s_nop 1
v_cndmask_b32 v13, v13, v5, vcc
v_subrev_u32 v5, 512, v4
v_lshrrev_b32 v5, 2, v5
v_add_u32 v5, 384, v5
v_cmp_lt_u32 vcc, 512, v4
s_nop 1
v_cndmask_b32 v13, v13, v5, vcc
v_subrev_u32 v5, 1024, v4
v_lshrrev_b32 v5, 3, v5
v_add_u32 v5, 512, v5
v_cmp_lt_u32 vcc, 1024, v4
s_nop 1
v_cndmask_b32 v13, v13, v5, vcc
v_lshl_add_u32 v13, v13, 2, s46
ds_read_b32 v14, v12
ds_read_b32 v15, v13
s_waitcnt lgkmcnt(0)
v_cvt_pk_bf16_f32 v14, v14, v15
v_lshl_add_u32 v16, v1, 2, s23
buffer_store_dword v14, v16, s[16:19], 0 offen offset:1792
v_lshlrev_b32 v10, 1, v1
v_sub_u32 v10, 1023, v10
v_add_u32 v11, -1, v10
v_cvt_f32_u32 v4, v10
v_bfe_u32 v5, v4, 16, 1
v_add3_u32 v4, v4, v5, s60
v_and_b32 v4, 0xffff0000, v4
v_cvt_u32_f32 v4, v4
v_mov_b32 v12, v4
v_subrev_u32 v5, 256, v4
v_lshrrev_b32 v5, 1, v5
v_add_u32 v5, 256, v5
v_cmp_lt_u32 vcc, 256, v4
s_nop 1
v_cndmask_b32 v12, v12, v5, vcc
v_subrev_u32 v5, 512, v4
v_lshrrev_b32 v5, 2, v5
v_add_u32 v5, 384, v5
v_cmp_lt_u32 vcc, 512, v4
s_nop 1
v_cndmask_b32 v12, v12, v5, vcc
v_subrev_u32 v5, 1024, v4
v_lshrrev_b32 v5, 3, v5
v_add_u32 v5, 512, v5
v_cmp_lt_u32 vcc, 1024, v4
s_nop 1
v_cndmask_b32 v12, v12, v5, vcc
v_lshl_add_u32 v12, v12, 2, s46
v_cvt_f32_u32 v4, v11
v_bfe_u32 v5, v4, 16, 1
v_add3_u32 v4, v4, v5, s60
v_and_b32 v4, 0xffff0000, v4
v_cvt_u32_f32 v4, v4
v_mov_b32 v13, v4
v_subrev_u32 v5, 256, v4
v_lshrrev_b32 v5, 1, v5
v_add_u32 v5, 256, v5
v_cmp_lt_u32 vcc, 256, v4
s_nop 1
v_cndmask_b32 v13, v13, v5, vcc
v_subrev_u32 v5, 512, v4
v_lshrrev_b32 v5, 2, v5
v_add_u32 v5, 384, v5
v_cmp_lt_u32 vcc, 512, v4
s_nop 1
v_cndmask_b32 v13, v13, v5, vcc
v_subrev_u32 v5, 1024, v4
v_lshrrev_b32 v5, 3, v5
v_add_u32 v5, 512, v5
v_cmp_lt_u32 vcc, 1024, v4
s_nop 1
v_cndmask_b32 v13, v13, v5, vcc
v_lshl_add_u32 v13, v13, 2, s46
ds_read_b32 v14, v12
ds_read_b32 v15, v13
s_waitcnt lgkmcnt(0)
v_cvt_pk_bf16_f32 v14, v14, v15
v_lshl_add_u32 v16, v1, 2, s23
buffer_store_dword v14, v16, s[16:19], 0 offen offset:2048
v_lshlrev_b32 v10, 1, v1
v_sub_u32 v10, 895, v10
v_add_u32 v11, -1, v10
v_cvt_f32_u32 v4, v10
v_bfe_u32 v5, v4, 16, 1
v_add3_u32 v4, v4, v5, s60
v_and_b32 v4, 0xffff0000, v4
v_cvt_u32_f32 v4, v4
v_mov_b32 v12, v4
v_subrev_u32 v5, 256, v4
v_lshrrev_b32 v5, 1, v5
v_add_u32 v5, 256, v5
v_cmp_lt_u32 vcc, 256, v4
s_nop 1
v_cndmask_b32 v12, v12, v5, vcc
v_subrev_u32 v5, 512, v4
v_lshrrev_b32 v5, 2, v5
v_add_u32 v5, 384, v5
v_cmp_lt_u32 vcc, 512, v4
s_nop 1
v_cndmask_b32 v12, v12, v5, vcc
v_subrev_u32 v5, 1024, v4
v_lshrrev_b32 v5, 3, v5
v_add_u32 v5, 512, v5
v_cmp_lt_u32 vcc, 1024, v4
s_nop 1
v_cndmask_b32 v12, v12, v5, vcc
v_lshl_add_u32 v12, v12, 2, s46
v_cvt_f32_u32 v4, v11
v_bfe_u32 v5, v4, 16, 1
v_add3_u32 v4, v4, v5, s60
v_and_b32 v4, 0xffff0000, v4
v_cvt_u32_f32 v4, v4
v_mov_b32 v13, v4
v_subrev_u32 v5, 256, v4
v_lshrrev_b32 v5, 1, v5
v_add_u32 v5, 256, v5
v_cmp_lt_u32 vcc, 256, v4
s_nop 1
v_cndmask_b32 v13, v13, v5, vcc
v_subrev_u32 v5, 512, v4
v_lshrrev_b32 v5, 2, v5
v_add_u32 v5, 384, v5
v_cmp_lt_u32 vcc, 512, v4
s_nop 1
v_cndmask_b32 v13, v13, v5, vcc
v_subrev_u32 v5, 1024, v4
v_lshrrev_b32 v5, 3, v5
v_add_u32 v5, 512, v5
v_cmp_lt_u32 vcc, 1024, v4
s_nop 1
v_cndmask_b32 v13, v13, v5, vcc
v_lshl_add_u32 v13, v13, 2, s46
ds_read_b32 v14, v12
ds_read_b32 v15, v13
s_waitcnt lgkmcnt(0)
v_cvt_pk_bf16_f32 v14, v14, v15
v_lshl_add_u32 v16, v1, 2, s23
buffer_store_dword v14, v16, s[16:19], 0 offen offset:2304
v_lshlrev_b32 v10, 1, v1
v_sub_u32 v10, 767, v10
v_add_u32 v11, -1, v10
v_cvt_f32_u32 v4, v10
v_bfe_u32 v5, v4, 16, 1
v_add3_u32 v4, v4, v5, s60
v_and_b32 v4, 0xffff0000, v4
v_cvt_u32_f32 v4, v4
v_mov_b32 v12, v4
v_subrev_u32 v5, 256, v4
v_lshrrev_b32 v5, 1, v5
v_add_u32 v5, 256, v5
v_cmp_lt_u32 vcc, 256, v4
s_nop 1
v_cndmask_b32 v12, v12, v5, vcc
v_subrev_u32 v5, 512, v4
v_lshrrev_b32 v5, 2, v5
v_add_u32 v5, 384, v5
v_cmp_lt_u32 vcc, 512, v4
s_nop 1
v_cndmask_b32 v12, v12, v5, vcc
v_subrev_u32 v5, 1024, v4
v_lshrrev_b32 v5, 3, v5
v_add_u32 v5, 512, v5
v_cmp_lt_u32 vcc, 1024, v4
s_nop 1
v_cndmask_b32 v12, v12, v5, vcc
v_lshl_add_u32 v12, v12, 2, s46
v_cvt_f32_u32 v4, v11
v_bfe_u32 v5, v4, 16, 1
v_add3_u32 v4, v4, v5, s60
v_and_b32 v4, 0xffff0000, v4
v_cvt_u32_f32 v4, v4
v_mov_b32 v13, v4
v_subrev_u32 v5, 256, v4
v_lshrrev_b32 v5, 1, v5
v_add_u32 v5, 256, v5
v_cmp_lt_u32 vcc, 256, v4
s_nop 1
v_cndmask_b32 v13, v13, v5, vcc
v_subrev_u32 v5, 512, v4
v_lshrrev_b32 v5, 2, v5
v_add_u32 v5, 384, v5
v_cmp_lt_u32 vcc, 512, v4
s_nop 1
v_cndmask_b32 v13, v13, v5, vcc
v_subrev_u32 v5, 1024, v4
v_lshrrev_b32 v5, 3, v5
v_add_u32 v5, 512, v5
v_cmp_lt_u32 vcc, 1024, v4
s_nop 1
v_cndmask_b32 v13, v13, v5, vcc
v_lshl_add_u32 v13, v13, 2, s46
ds_read_b32 v14, v12
ds_read_b32 v15, v13
s_waitcnt lgkmcnt(0)
v_cvt_pk_bf16_f32 v14, v14, v15
v_lshl_add_u32 v16, v1, 2, s23
buffer_store_dword v14, v16, s[16:19], 0 offen offset:2560
v_lshlrev_b32 v10, 1, v1
v_sub_u32 v10, 639, v10
v_add_u32 v11, -1, v10
v_cvt_f32_u32 v4, v10
v_bfe_u32 v5, v4, 16, 1
v_add3_u32 v4, v4, v5, s60
v_and_b32 v4, 0xffff0000, v4
v_cvt_u32_f32 v4, v4
v_mov_b32 v12, v4
v_subrev_u32 v5, 256, v4
v_lshrrev_b32 v5, 1, v5
v_add_u32 v5, 256, v5
v_cmp_lt_u32 vcc, 256, v4
s_nop 1
v_cndmask_b32 v12, v12, v5, vcc
v_subrev_u32 v5, 512, v4
v_lshrrev_b32 v5, 2, v5
v_add_u32 v5, 384, v5
v_cmp_lt_u32 vcc, 512, v4
s_nop 1
v_cndmask_b32 v12, v12, v5, vcc
v_subrev_u32 v5, 1024, v4
v_lshrrev_b32 v5, 3, v5
v_add_u32 v5, 512, v5
v_cmp_lt_u32 vcc, 1024, v4
s_nop 1
v_cndmask_b32 v12, v12, v5, vcc
v_lshl_add_u32 v12, v12, 2, s46
v_cvt_f32_u32 v4, v11
v_bfe_u32 v5, v4, 16, 1
v_add3_u32 v4, v4, v5, s60
v_and_b32 v4, 0xffff0000, v4
v_cvt_u32_f32 v4, v4
v_mov_b32 v13, v4
v_subrev_u32 v5, 256, v4
v_lshrrev_b32 v5, 1, v5
v_add_u32 v5, 256, v5
v_cmp_lt_u32 vcc, 256, v4
s_nop 1
v_cndmask_b32 v13, v13, v5, vcc
v_subrev_u32 v5, 512, v4
v_lshrrev_b32 v5, 2, v5
v_add_u32 v5, 384, v5
v_cmp_lt_u32 vcc, 512, v4
s_nop 1
v_cndmask_b32 v13, v13, v5, vcc
v_subrev_u32 v5, 1024, v4
v_lshrrev_b32 v5, 3, v5
v_add_u32 v5, 512, v5
v_cmp_lt_u32 vcc, 1024, v4
s_nop 1
v_cndmask_b32 v13, v13, v5, vcc
v_lshl_add_u32 v13, v13, 2, s46
ds_read_b32 v14, v12
ds_read_b32 v15, v13
s_waitcnt lgkmcnt(0)
v_cvt_pk_bf16_f32 v14, v14, v15
v_lshl_add_u32 v16, v1, 2, s23
buffer_store_dword v14, v16, s[16:19], 0 offen offset:2816
v_lshlrev_b32 v10, 1, v1
v_sub_u32 v10, 511, v10
v_add_u32 v11, -1, v10
v_cvt_f32_u32 v4, v10
v_bfe_u32 v5, v4, 16, 1
v_add3_u32 v4, v4, v5, s60
v_and_b32 v4, 0xffff0000, v4
v_cvt_u32_f32 v4, v4
v_mov_b32 v12, v4
v_subrev_u32 v5, 256, v4
v_lshrrev_b32 v5, 1, v5
v_add_u32 v5, 256, v5
v_cmp_lt_u32 vcc, 256, v4
s_nop 1
v_cndmask_b32 v12, v12, v5, vcc
v_subrev_u32 v5, 512, v4
v_lshrrev_b32 v5, 2, v5
v_add_u32 v5, 384, v5
v_cmp_lt_u32 vcc, 512, v4
s_nop 1
v_cndmask_b32 v12, v12, v5, vcc
v_subrev_u32 v5, 1024, v4
v_lshrrev_b32 v5, 3, v5
v_add_u32 v5, 512, v5
v_cmp_lt_u32 vcc, 1024, v4
s_nop 1
v_cndmask_b32 v12, v12, v5, vcc
v_lshl_add_u32 v12, v12, 2, s46
v_cvt_f32_u32 v4, v11
v_bfe_u32 v5, v4, 16, 1
v_add3_u32 v4, v4, v5, s60
v_and_b32 v4, 0xffff0000, v4
v_cvt_u32_f32 v4, v4
v_mov_b32 v13, v4
v_subrev_u32 v5, 256, v4
v_lshrrev_b32 v5, 1, v5
v_add_u32 v5, 256, v5
v_cmp_lt_u32 vcc, 256, v4
s_nop 1
v_cndmask_b32 v13, v13, v5, vcc
v_subrev_u32 v5, 512, v4
v_lshrrev_b32 v5, 2, v5
v_add_u32 v5, 384, v5
v_cmp_lt_u32 vcc, 512, v4
s_nop 1
v_cndmask_b32 v13, v13, v5, vcc
v_subrev_u32 v5, 1024, v4
v_lshrrev_b32 v5, 3, v5
v_add_u32 v5, 512, v5
v_cmp_lt_u32 vcc, 1024, v4
s_nop 1
v_cndmask_b32 v13, v13, v5, vcc
v_lshl_add_u32 v13, v13, 2, s46
ds_read_b32 v14, v12
ds_read_b32 v15, v13
s_waitcnt lgkmcnt(0)
v_cvt_pk_bf16_f32 v14, v14, v15
v_lshl_add_u32 v16, v1, 2, s23
buffer_store_dword v14, v16, s[16:19], 0 offen offset:3072
v_lshlrev_b32 v10, 1, v1
v_sub_u32 v10, 383, v10
v_add_u32 v11, -1, v10
v_cvt_f32_u32 v4, v10
v_bfe_u32 v5, v4, 16, 1
v_add3_u32 v4, v4, v5, s60
v_and_b32 v4, 0xffff0000, v4
v_cvt_u32_f32 v4, v4
v_mov_b32 v12, v4
v_subrev_u32 v5, 256, v4
v_lshrrev_b32 v5, 1, v5
v_add_u32 v5, 256, v5
v_cmp_lt_u32 vcc, 256, v4
s_nop 1
v_cndmask_b32 v12, v12, v5, vcc
v_subrev_u32 v5, 512, v4
v_lshrrev_b32 v5, 2, v5
v_add_u32 v5, 384, v5
v_cmp_lt_u32 vcc, 512, v4
s_nop 1
v_cndmask_b32 v12, v12, v5, vcc
v_subrev_u32 v5, 1024, v4
v_lshrrev_b32 v5, 3, v5
v_add_u32 v5, 512, v5
v_cmp_lt_u32 vcc, 1024, v4
s_nop 1
v_cndmask_b32 v12, v12, v5, vcc
v_lshl_add_u32 v12, v12, 2, s46
v_cvt_f32_u32 v4, v11
v_bfe_u32 v5, v4, 16, 1
v_add3_u32 v4, v4, v5, s60
v_and_b32 v4, 0xffff0000, v4
v_cvt_u32_f32 v4, v4
v_mov_b32 v13, v4
v_subrev_u32 v5, 256, v4
v_lshrrev_b32 v5, 1, v5
v_add_u32 v5, 256, v5
v_cmp_lt_u32 vcc, 256, v4
s_nop 1
v_cndmask_b32 v13, v13, v5, vcc
v_subrev_u32 v5, 512, v4
v_lshrrev_b32 v5, 2, v5
v_add_u32 v5, 384, v5
v_cmp_lt_u32 vcc, 512, v4
s_nop 1
v_cndmask_b32 v13, v13, v5, vcc
v_subrev_u32 v5, 1024, v4
v_lshrrev_b32 v5, 3, v5
v_add_u32 v5, 512, v5
v_cmp_lt_u32 vcc, 1024, v4
s_nop 1
v_cndmask_b32 v13, v13, v5, vcc
v_lshl_add_u32 v13, v13, 2, s46
ds_read_b32 v14, v12
ds_read_b32 v15, v13
s_waitcnt lgkmcnt(0)
v_cvt_pk_bf16_f32 v14, v14, v15
v_lshl_add_u32 v16, v1, 2, s23
buffer_store_dword v14, v16, s[16:19], 0 offen offset:3328
v_lshlrev_b32 v10, 1, v1
v_sub_u32 v10, 255, v10
v_add_u32 v11, -1, v10
v_cvt_f32_u32 v4, v10
v_bfe_u32 v5, v4, 16, 1
v_add3_u32 v4, v4, v5, s60
v_and_b32 v4, 0xffff0000, v4
v_cvt_u32_f32 v4, v4
v_mov_b32 v12, v4
v_subrev_u32 v5, 256, v4
v_lshrrev_b32 v5, 1, v5
v_add_u32 v5, 256, v5
v_cmp_lt_u32 vcc, 256, v4
s_nop 1
v_cndmask_b32 v12, v12, v5, vcc
v_subrev_u32 v5, 512, v4
v_lshrrev_b32 v5, 2, v5
v_add_u32 v5, 384, v5
v_cmp_lt_u32 vcc, 512, v4
s_nop 1
v_cndmask_b32 v12, v12, v5, vcc
v_subrev_u32 v5, 1024, v4
v_lshrrev_b32 v5, 3, v5
v_add_u32 v5, 512, v5
v_cmp_lt_u32 vcc, 1024, v4
s_nop 1
v_cndmask_b32 v12, v12, v5, vcc
v_lshl_add_u32 v12, v12, 2, s46
v_cvt_f32_u32 v4, v11
v_bfe_u32 v5, v4, 16, 1
v_add3_u32 v4, v4, v5, s60
v_and_b32 v4, 0xffff0000, v4
v_cvt_u32_f32 v4, v4
v_mov_b32 v13, v4
v_subrev_u32 v5, 256, v4
v_lshrrev_b32 v5, 1, v5
v_add_u32 v5, 256, v5
v_cmp_lt_u32 vcc, 256, v4
s_nop 1
v_cndmask_b32 v13, v13, v5, vcc
v_subrev_u32 v5, 512, v4
v_lshrrev_b32 v5, 2, v5
v_add_u32 v5, 384, v5
v_cmp_lt_u32 vcc, 512, v4
s_nop 1
v_cndmask_b32 v13, v13, v5, vcc
v_subrev_u32 v5, 1024, v4
v_lshrrev_b32 v5, 3, v5
v_add_u32 v5, 512, v5
v_cmp_lt_u32 vcc, 1024, v4
s_nop 1
v_cndmask_b32 v13, v13, v5, vcc
v_lshl_add_u32 v13, v13, 2, s46
ds_read_b32 v14, v12
ds_read_b32 v15, v13
s_waitcnt lgkmcnt(0)
v_cvt_pk_bf16_f32 v14, v14, v15
v_lshl_add_u32 v16, v1, 2, s23
buffer_store_dword v14, v16, s[16:19], 0 offen offset:3584
v_lshlrev_b32 v10, 1, v1
v_sub_u32 v10, 127, v10
v_add_u32 v11, -1, v10
v_cvt_f32_u32 v4, v10
v_bfe_u32 v5, v4, 16, 1
v_add3_u32 v4, v4, v5, s60
v_and_b32 v4, 0xffff0000, v4
v_cvt_u32_f32 v4, v4
v_mov_b32 v12, v4
v_subrev_u32 v5, 256, v4
v_lshrrev_b32 v5, 1, v5
v_add_u32 v5, 256, v5
v_cmp_lt_u32 vcc, 256, v4
s_nop 1
v_cndmask_b32 v12, v12, v5, vcc
v_subrev_u32 v5, 512, v4
v_lshrrev_b32 v5, 2, v5
v_add_u32 v5, 384, v5
v_cmp_lt_u32 vcc, 512, v4
s_nop 1
v_cndmask_b32 v12, v12, v5, vcc
v_subrev_u32 v5, 1024, v4
v_lshrrev_b32 v5, 3, v5
v_add_u32 v5, 512, v5
v_cmp_lt_u32 vcc, 1024, v4
s_nop 1
v_cndmask_b32 v12, v12, v5, vcc
v_lshl_add_u32 v12, v12, 2, s46
v_cvt_f32_u32 v4, v11
v_bfe_u32 v5, v4, 16, 1
v_add3_u32 v4, v4, v5, s60
v_and_b32 v4, 0xffff0000, v4
v_cvt_u32_f32 v4, v4
v_mov_b32 v13, v4
v_subrev_u32 v5, 256, v4
v_lshrrev_b32 v5, 1, v5
v_add_u32 v5, 256, v5
v_cmp_lt_u32 vcc, 256, v4
s_nop 1
v_cndmask_b32 v13, v13, v5, vcc
v_subrev_u32 v5, 512, v4
v_lshrrev_b32 v5, 2, v5
v_add_u32 v5, 384, v5
v_cmp_lt_u32 vcc, 512, v4
s_nop 1
v_cndmask_b32 v13, v13, v5, vcc
v_subrev_u32 v5, 1024, v4
v_lshrrev_b32 v5, 3, v5
v_add_u32 v5, 512, v5
v_cmp_lt_u32 vcc, 1024, v4
s_nop 1
v_cndmask_b32 v13, v13, v5, vcc
v_lshl_add_u32 v13, v13, 2, s46
ds_read_b32 v14, v12
ds_read_b32 v15, v13
s_waitcnt lgkmcnt(0)
v_cvt_pk_bf16_f32 v14, v14, v15
v_lshl_add_u32 v16, v1, 2, s23
buffer_store_dword v14, v16, s[16:19], 0 offen offset:3840
s_load_dwordx2 s[28:29], s[0:1], 96
s_waitcnt lgkmcnt(0)
s_mov_b32 s8, s24
s_and_b32 s9, s25, 0xffff
s_mov_b32 s10, 4194304
s_mov_b32 s11, 0x20000
s_mov_b32 s12, s28
s_and_b32 s13, s29, 0xffff
s_mov_b32 s14, 2048
s_mov_b32 s15, 0x20000
v_lshlrev_b32 v3, 5, v1
buffer_load_dwordx4 v[40:43], v3, s[12:15], 0 offen
buffer_load_dwordx4 v[44:47], v3, s[12:15], 0 offen offset:16
s_lshl_b32 s21, s21, 1
s_add_u32 s22, s21, 0
s_lshl_b32 s23, s22, 11
buffer_load_dwordx4 v[20:23], v3, s[8:11], s23 offen
buffer_load_dwordx4 v[24:27], v3, s[8:11], s23 offen offset:16
s_waitcnt vmcnt(0)
v_mov_b32 v30, 0
v_lshlrev_b32 v4, 16, v20
v_lshlrev_b32 v5, 16, v40
v_mul_f32 v4, v4, v5
v_bfe_u32 v6, v4, 16, 1
v_add3_u32 v4, v4, v6, s60
v_and_b32 v4, 0xffff0000, v4
v_add_f32 v30, v30, v4
v_and_b32 v4, 0xffff0000, v20
v_and_b32 v5, 0xffff0000, v40
v_mul_f32 v4, v4, v5
v_bfe_u32 v6, v4, 16, 1
v_add3_u32 v4, v4, v6, s60
v_and_b32 v4, 0xffff0000, v4
v_add_f32 v30, v30, v4
v_lshlrev_b32 v4, 16, v21
v_lshlrev_b32 v5, 16, v41
v_mul_f32 v4, v4, v5
v_bfe_u32 v6, v4, 16, 1
v_add3_u32 v4, v4, v6, s60
v_and_b32 v4, 0xffff0000, v4
v_add_f32 v30, v30, v4
v_and_b32 v4, 0xffff0000, v21
v_and_b32 v5, 0xffff0000, v41
v_mul_f32 v4, v4, v5
v_bfe_u32 v6, v4, 16, 1
v_add3_u32 v4, v4, v6, s60
v_and_b32 v4, 0xffff0000, v4
v_add_f32 v30, v30, v4
v_lshlrev_b32 v4, 16, v22
v_lshlrev_b32 v5, 16, v42
v_mul_f32 v4, v4, v5
v_bfe_u32 v6, v4, 16, 1
v_add3_u32 v4, v4, v6, s60
v_and_b32 v4, 0xffff0000, v4
v_add_f32 v30, v30, v4
v_and_b32 v4, 0xffff0000, v22
v_and_b32 v5, 0xffff0000, v42
v_mul_f32 v4, v4, v5
v_bfe_u32 v6, v4, 16, 1
v_add3_u32 v4, v4, v6, s60
v_and_b32 v4, 0xffff0000, v4
v_add_f32 v30, v30, v4
v_lshlrev_b32 v4, 16, v23
v_lshlrev_b32 v5, 16, v43
v_mul_f32 v4, v4, v5
v_bfe_u32 v6, v4, 16, 1
v_add3_u32 v4, v4, v6, s60
v_and_b32 v4, 0xffff0000, v4
v_add_f32 v30, v30, v4
v_and_b32 v4, 0xffff0000, v23
v_and_b32 v5, 0xffff0000, v43
v_mul_f32 v4, v4, v5
v_bfe_u32 v6, v4, 16, 1
v_add3_u32 v4, v4, v6, s60
v_and_b32 v4, 0xffff0000, v4
v_add_f32 v30, v30, v4
v_lshlrev_b32 v4, 16, v24
v_lshlrev_b32 v5, 16, v44
v_mul_f32 v4, v4, v5
v_bfe_u32 v6, v4, 16, 1
v_add3_u32 v4, v4, v6, s60
v_and_b32 v4, 0xffff0000, v4
v_add_f32 v30, v30, v4
v_and_b32 v4, 0xffff0000, v24
v_and_b32 v5, 0xffff0000, v44
v_mul_f32 v4, v4, v5
v_bfe_u32 v6, v4, 16, 1
v_add3_u32 v4, v4, v6, s60
v_and_b32 v4, 0xffff0000, v4
v_add_f32 v30, v30, v4
v_lshlrev_b32 v4, 16, v25
v_lshlrev_b32 v5, 16, v45
v_mul_f32 v4, v4, v5
v_bfe_u32 v6, v4, 16, 1
v_add3_u32 v4, v4, v6, s60
v_and_b32 v4, 0xffff0000, v4
v_add_f32 v30, v30, v4
v_and_b32 v4, 0xffff0000, v25
v_and_b32 v5, 0xffff0000, v45
v_mul_f32 v4, v4, v5
v_bfe_u32 v6, v4, 16, 1
v_add3_u32 v4, v4, v6, s60
v_and_b32 v4, 0xffff0000, v4
v_add_f32 v30, v30, v4
v_lshlrev_b32 v4, 16, v26
v_lshlrev_b32 v5, 16, v46
v_mul_f32 v4, v4, v5
v_bfe_u32 v6, v4, 16, 1
v_add3_u32 v4, v4, v6, s60
v_and_b32 v4, 0xffff0000, v4
v_add_f32 v30, v30, v4
v_and_b32 v4, 0xffff0000, v26
v_and_b32 v5, 0xffff0000, v46
v_mul_f32 v4, v4, v5
v_bfe_u32 v6, v4, 16, 1
v_add3_u32 v4, v4, v6, s60
v_and_b32 v4, 0xffff0000, v4
v_add_f32 v30, v30, v4
v_lshlrev_b32 v4, 16, v27
v_lshlrev_b32 v5, 16, v47
v_mul_f32 v4, v4, v5
v_bfe_u32 v6, v4, 16, 1
v_add3_u32 v4, v4, v6, s60
v_and_b32 v4, 0xffff0000, v4
v_add_f32 v30, v30, v4
v_and_b32 v4, 0xffff0000, v27
v_and_b32 v5, 0xffff0000, v47
v_mul_f32 v4, v4, v5
v_bfe_u32 v6, v4, 16, 1
v_add3_u32 v4, v4, v6, s60
v_and_b32 v4, 0xffff0000, v4
v_add_f32 v30, v30, v4
v_xor_b32 v4, 1, v1
v_lshlrev_b32 v4, 2, v4
ds_bpermute_b32 v5, v4, v30
s_waitcnt lgkmcnt(0)
v_add_f32 v30, v30, v5
v_xor_b32 v4, 2, v1
v_lshlrev_b32 v4, 2, v4
ds_bpermute_b32 v5, v4, v30
s_waitcnt lgkmcnt(0)
v_add_f32 v30, v30, v5
v_xor_b32 v4, 4, v1
v_lshlrev_b32 v4, 2, v4
ds_bpermute_b32 v5, v4, v30
s_waitcnt lgkmcnt(0)
v_add_f32 v30, v30, v5
v_xor_b32 v4, 8, v1
v_lshlrev_b32 v4, 2, v4
ds_bpermute_b32 v5, v4, v30
s_waitcnt lgkmcnt(0)
v_add_f32 v30, v30, v5
v_xor_b32 v4, 16, v1
v_lshlrev_b32 v4, 2, v4
ds_bpermute_b32 v5, v4, v30
s_waitcnt lgkmcnt(0)
v_add_f32 v30, v30, v5
v_xor_b32 v4, 32, v1
v_lshlrev_b32 v4, 2, v4
ds_bpermute_b32 v5, v4, v30
s_waitcnt lgkmcnt(0)
v_add_f32 v30, v30, v5
v_bfe_u32 v4, v30, 16, 1
v_add3_u32 v30, v30, v4, s60
v_and_b32 v30, 0xffff0000, v30
v_mul_f32 v30, 0xbfb8aa3b, v30
v_exp_f32 v30, v30
s_nop 0
v_add_f32 v30, 1.0, v30
v_rcp_f32 v30, v30
s_nop 0
v_bfe_u32 v4, v30, 16, 1
v_add3_u32 v30, v30, v4, s60
v_and_b32 v30, 0xffff0000, v30
s_lshl_b32 s22, s22, 2
s_add_u32 s22, s22, 15728640
v_mov_b32 v4, s22
buffer_store_dword v30, v4, s[16:19], 0 offen
s_add_u32 s22, s21, 1
s_lshl_b32 s23, s22, 11
buffer_load_dwordx4 v[20:23], v3, s[8:11], s23 offen
buffer_load_dwordx4 v[24:27], v3, s[8:11], s23 offen offset:16
s_waitcnt vmcnt(0)
v_mov_b32 v30, 0
v_lshlrev_b32 v4, 16, v20
v_lshlrev_b32 v5, 16, v40
v_mul_f32 v4, v4, v5
v_bfe_u32 v6, v4, 16, 1
v_add3_u32 v4, v4, v6, s60
v_and_b32 v4, 0xffff0000, v4
v_add_f32 v30, v30, v4
v_and_b32 v4, 0xffff0000, v20
v_and_b32 v5, 0xffff0000, v40
v_mul_f32 v4, v4, v5
v_bfe_u32 v6, v4, 16, 1
v_add3_u32 v4, v4, v6, s60
v_and_b32 v4, 0xffff0000, v4
v_add_f32 v30, v30, v4
v_lshlrev_b32 v4, 16, v21
v_lshlrev_b32 v5, 16, v41
v_mul_f32 v4, v4, v5
v_bfe_u32 v6, v4, 16, 1
v_add3_u32 v4, v4, v6, s60
v_and_b32 v4, 0xffff0000, v4
v_add_f32 v30, v30, v4
v_and_b32 v4, 0xffff0000, v21
v_and_b32 v5, 0xffff0000, v41
v_mul_f32 v4, v4, v5
v_bfe_u32 v6, v4, 16, 1
v_add3_u32 v4, v4, v6, s60
v_and_b32 v4, 0xffff0000, v4
v_add_f32 v30, v30, v4
v_lshlrev_b32 v4, 16, v22
v_lshlrev_b32 v5, 16, v42
v_mul_f32 v4, v4, v5
v_bfe_u32 v6, v4, 16, 1
v_add3_u32 v4, v4, v6, s60
v_and_b32 v4, 0xffff0000, v4
v_add_f32 v30, v30, v4
v_and_b32 v4, 0xffff0000, v22
v_and_b32 v5, 0xffff0000, v42
v_mul_f32 v4, v4, v5
v_bfe_u32 v6, v4, 16, 1
v_add3_u32 v4, v4, v6, s60
v_and_b32 v4, 0xffff0000, v4
v_add_f32 v30, v30, v4
v_lshlrev_b32 v4, 16, v23
v_lshlrev_b32 v5, 16, v43
v_mul_f32 v4, v4, v5
v_bfe_u32 v6, v4, 16, 1
v_add3_u32 v4, v4, v6, s60
v_and_b32 v4, 0xffff0000, v4
v_add_f32 v30, v30, v4
v_and_b32 v4, 0xffff0000, v23
v_and_b32 v5, 0xffff0000, v43
v_mul_f32 v4, v4, v5
v_bfe_u32 v6, v4, 16, 1
v_add3_u32 v4, v4, v6, s60
v_and_b32 v4, 0xffff0000, v4
v_add_f32 v30, v30, v4
v_lshlrev_b32 v4, 16, v24
v_lshlrev_b32 v5, 16, v44
v_mul_f32 v4, v4, v5
v_bfe_u32 v6, v4, 16, 1
v_add3_u32 v4, v4, v6, s60
v_and_b32 v4, 0xffff0000, v4
v_add_f32 v30, v30, v4
v_and_b32 v4, 0xffff0000, v24
v_and_b32 v5, 0xffff0000, v44
v_mul_f32 v4, v4, v5
v_bfe_u32 v6, v4, 16, 1
v_add3_u32 v4, v4, v6, s60
v_and_b32 v4, 0xffff0000, v4
v_add_f32 v30, v30, v4
v_lshlrev_b32 v4, 16, v25
v_lshlrev_b32 v5, 16, v45
v_mul_f32 v4, v4, v5
v_bfe_u32 v6, v4, 16, 1
v_add3_u32 v4, v4, v6, s60
v_and_b32 v4, 0xffff0000, v4
v_add_f32 v30, v30, v4
v_and_b32 v4, 0xffff0000, v25
v_and_b32 v5, 0xffff0000, v45
v_mul_f32 v4, v4, v5
v_bfe_u32 v6, v4, 16, 1
v_add3_u32 v4, v4, v6, s60
v_and_b32 v4, 0xffff0000, v4
v_add_f32 v30, v30, v4
v_lshlrev_b32 v4, 16, v26
v_lshlrev_b32 v5, 16, v46
v_mul_f32 v4, v4, v5
v_bfe_u32 v6, v4, 16, 1
v_add3_u32 v4, v4, v6, s60
v_and_b32 v4, 0xffff0000, v4
v_add_f32 v30, v30, v4
v_and_b32 v4, 0xffff0000, v26
v_and_b32 v5, 0xffff0000, v46
v_mul_f32 v4, v4, v5
v_bfe_u32 v6, v4, 16, 1
v_add3_u32 v4, v4, v6, s60
v_and_b32 v4, 0xffff0000, v4
v_add_f32 v30, v30, v4
v_lshlrev_b32 v4, 16, v27
v_lshlrev_b32 v5, 16, v47
v_mul_f32 v4, v4, v5
v_bfe_u32 v6, v4, 16, 1
v_add3_u32 v4, v4, v6, s60
v_and_b32 v4, 0xffff0000, v4
v_add_f32 v30, v30, v4
v_and_b32 v4, 0xffff0000, v27
v_and_b32 v5, 0xffff0000, v47
v_mul_f32 v4, v4, v5
v_bfe_u32 v6, v4, 16, 1
v_add3_u32 v4, v4, v6, s60
v_and_b32 v4, 0xffff0000, v4
v_add_f32 v30, v30, v4
v_xor_b32 v4, 1, v1
v_lshlrev_b32 v4, 2, v4
ds_bpermute_b32 v5, v4, v30
s_waitcnt lgkmcnt(0)
v_add_f32 v30, v30, v5
v_xor_b32 v4, 2, v1
v_lshlrev_b32 v4, 2, v4
ds_bpermute_b32 v5, v4, v30
s_waitcnt lgkmcnt(0)
v_add_f32 v30, v30, v5
v_xor_b32 v4, 4, v1
v_lshlrev_b32 v4, 2, v4
ds_bpermute_b32 v5, v4, v30
s_waitcnt lgkmcnt(0)
v_add_f32 v30, v30, v5
v_xor_b32 v4, 8, v1
v_lshlrev_b32 v4, 2, v4
ds_bpermute_b32 v5, v4, v30
s_waitcnt lgkmcnt(0)
v_add_f32 v30, v30, v5
v_xor_b32 v4, 16, v1
v_lshlrev_b32 v4, 2, v4
ds_bpermute_b32 v5, v4, v30
s_waitcnt lgkmcnt(0)
v_add_f32 v30, v30, v5
v_xor_b32 v4, 32, v1
v_lshlrev_b32 v4, 2, v4
ds_bpermute_b32 v5, v4, v30
s_waitcnt lgkmcnt(0)
v_add_f32 v30, v30, v5
v_bfe_u32 v4, v30, 16, 1
v_add3_u32 v30, v30, v4, s60
v_and_b32 v30, 0xffff0000, v30
v_mul_f32 v30, 0xbfb8aa3b, v30
v_exp_f32 v30, v30
s_nop 0
v_add_f32 v30, 1.0, v30
v_rcp_f32 v30, v30
s_nop 0
v_bfe_u32 v4, v30, 16, 1
v_add3_u32 v30, v30, v4, s60
v_and_b32 v30, 0xffff0000, v30
s_lshl_b32 s22, s22, 2
s_add_u32 s22, s22, 15728640
v_mov_b32 v4, s22
buffer_store_dword v30, v4, s[16:19], 0 offen
K1_END:
s_endpgm
.globl k2_kernel
.p2align 8
.type k2_kernel,@function
k2_kernel:
s_cmp_ge_u32 s2, 256
s_cbranch_scc1 K2_END
s_load_dwordx2 s[24:25], s[0:1], 0
s_load_dwordx2 s[26:27], s[0:1], 64
s_load_dwordx2 s[28:29], s[0:1], 96
s_load_dwordx2 s[42:43], s[0:1], 120
s_mov_b32 s60, 0x7fff
v_and_b32 v1, 63, v0
v_lshrrev_b32 v2, 6, v0
s_nop 0
v_readfirstlane_b32 s20, v2
s_waitcnt lgkmcnt(0)
s_mov_b32 s16, s42
s_and_b32 s17, s43, 0xffff
s_mov_b32 s18, 20971520
s_mov_b32 s19, 0x20000
s_mov_b32 s8, s24
s_and_b32 s9, s25, 0xffff
s_mov_b32 s10, 4194304
s_mov_b32 s11, 0x20000
s_lshl_b32 s21, s2, 2
s_add_u32 s21, s21, s20
s_mul_i32 s46, s20, 40960
s_lshl_b32 s22, s21, 12
s_add_u32 s22, s22, 6291456
s_add_u32 s30, s42, s22
s_addc_u32 s31, s43, 0
s_mov_b32 s12, s30
s_and_b32 s13, s31, 0xffff
s_mov_b32 s14, 4096
s_mov_b32 s15, 0x20000
v_add_u32 v3, 0, v1
v_cmp_gt_u32 vcc, 260, v3
s_and_saveexec_b64 s[54:55], vcc
v_lshlrev_b32 v3, 4, v3
buffer_load_dwordx4 v[20:23], v3, s[12:15], 0 offen
buffer_load_dwordx4 v[24:27], v3, s[12:15], 0 offen offset:16
v_add_u32 v3, s46, v3
s_waitcnt vmcnt(0)
ds_write_b128 v3, v[20:23] offset:0
s_waitcnt lgkmcnt(0)
v_alignbyte_b32 v28, v21, v20, 2
v_alignbyte_b32 v29, v22, v21, 2
v_alignbyte_b32 v30, v23, v22, 2
v_alignbyte_b32 v31, v24, v23, 2
s_nop 0
ds_write_b128 v3, v[28:31] offset:4160
s_waitcnt lgkmcnt(0)
v_mov_b32 v28, v21
v_mov_b32 v29, v22
v_mov_b32 v30, v23
v_mov_b32 v31, v24
s_nop 0
ds_write_b128 v3, v[28:31] offset:8320
s_waitcnt lgkmcnt(0)
v_alignbyte_b32 v28, v22, v21, 2
v_alignbyte_b32 v29, v23, v22, 2
v_alignbyte_b32 v30, v24, v23, 2
v_alignbyte_b32 v31, v25, v24, 2
s_nop 0
ds_write_b128 v3, v[28:31] offset:12480
s_waitcnt lgkmcnt(0)
ds_write_b128 v3, v[22:25] offset:16640
s_waitcnt lgkmcnt(0)
v_alignbyte_b32 v28, v23, v22, 2
v_alignbyte_b32 v29, v24, v23, 2
v_alignbyte_b32 v30, v25, v24, 2
v_alignbyte_b32 v31, v26, v25, 2
s_nop 0
ds_write_b128 v3, v[28:31] offset:20800
s_waitcnt lgkmcnt(0)
v_mov_b32 v28, v23
v_mov_b32 v29, v24
v_mov_b32 v30, v25
v_mov_b32 v31, v26
s_nop 0
ds_write_b128 v3, v[28:31] offset:24960
s_waitcnt lgkmcnt(0)
v_alignbyte_b32 v28, v24, v23, 2
v_alignbyte_b32 v29, v25, v24, 2
v_alignbyte_b32 v30, v26, v25, 2
v_alignbyte_b32 v31, v27, v26, 2
s_nop 0
ds_write_b128 v3, v[28:31] offset:29120
s_waitcnt lgkmcnt(0)
s_mov_b64 exec, s[54:55]
v_add_u32 v3, 64, v1
v_cmp_gt_u32 vcc, 260, v3
s_and_saveexec_b64 s[54:55], vcc
v_lshlrev_b32 v3, 4, v3
buffer_load_dwordx4 v[20:23], v3, s[12:15], 0 offen
buffer_load_dwordx4 v[24:27], v3, s[12:15], 0 offen offset:16
v_add_u32 v3, s46, v3
s_waitcnt vmcnt(0)
ds_write_b128 v3, v[20:23] offset:0
s_waitcnt lgkmcnt(0)
v_alignbyte_b32 v28, v21, v20, 2
v_alignbyte_b32 v29, v22, v21, 2
v_alignbyte_b32 v30, v23, v22, 2
v_alignbyte_b32 v31, v24, v23, 2
s_nop 0
ds_write_b128 v3, v[28:31] offset:4160
s_waitcnt lgkmcnt(0)
v_mov_b32 v28, v21
v_mov_b32 v29, v22
v_mov_b32 v30, v23
v_mov_b32 v31, v24
s_nop 0
ds_write_b128 v3, v[28:31] offset:8320
s_waitcnt lgkmcnt(0)
v_alignbyte_b32 v28, v22, v21, 2
v_alignbyte_b32 v29, v23, v22, 2
v_alignbyte_b32 v30, v24, v23, 2
v_alignbyte_b32 v31, v25, v24, 2
s_nop 0
ds_write_b128 v3, v[28:31] offset:12480
s_waitcnt lgkmcnt(0)
ds_write_b128 v3, v[22:25] offset:16640
s_waitcnt lgkmcnt(0)
v_alignbyte_b32 v28, v23, v22, 2
v_alignbyte_b32 v29, v24, v23, 2
v_alignbyte_b32 v30, v25, v24, 2
v_alignbyte_b32 v31, v26, v25, 2
s_nop 0
ds_write_b128 v3, v[28:31] offset:20800
s_waitcnt lgkmcnt(0)
v_mov_b32 v28, v23
v_mov_b32 v29, v24
v_mov_b32 v30, v25
v_mov_b32 v31, v26
s_nop 0
ds_write_b128 v3, v[28:31] offset:24960
s_waitcnt lgkmcnt(0)
v_alignbyte_b32 v28, v24, v23, 2
v_alignbyte_b32 v29, v25, v24, 2
v_alignbyte_b32 v30, v26, v25, 2
v_alignbyte_b32 v31, v27, v26, 2
s_nop 0
ds_write_b128 v3, v[28:31] offset:29120
s_waitcnt lgkmcnt(0)
s_mov_b64 exec, s[54:55]
v_add_u32 v3, 128, v1
v_cmp_gt_u32 vcc, 260, v3
s_and_saveexec_b64 s[54:55], vcc
v_lshlrev_b32 v3, 4, v3
buffer_load_dwordx4 v[20:23], v3, s[12:15], 0 offen
buffer_load_dwordx4 v[24:27], v3, s[12:15], 0 offen offset:16
v_add_u32 v3, s46, v3
s_waitcnt vmcnt(0)
ds_write_b128 v3, v[20:23] offset:0
s_waitcnt lgkmcnt(0)
v_alignbyte_b32 v28, v21, v20, 2
v_alignbyte_b32 v29, v22, v21, 2
v_alignbyte_b32 v30, v23, v22, 2
v_alignbyte_b32 v31, v24, v23, 2
s_nop 0
ds_write_b128 v3, v[28:31] offset:4160
s_waitcnt lgkmcnt(0)
v_mov_b32 v28, v21
v_mov_b32 v29, v22
v_mov_b32 v30, v23
v_mov_b32 v31, v24
s_nop 0
ds_write_b128 v3, v[28:31] offset:8320
s_waitcnt lgkmcnt(0)
v_alignbyte_b32 v28, v22, v21, 2
v_alignbyte_b32 v29, v23, v22, 2
v_alignbyte_b32 v30, v24, v23, 2
v_alignbyte_b32 v31, v25, v24, 2
s_nop 0
ds_write_b128 v3, v[28:31] offset:12480
s_waitcnt lgkmcnt(0)
ds_write_b128 v3, v[22:25] offset:16640
s_waitcnt lgkmcnt(0)
v_alignbyte_b32 v28, v23, v22, 2
v_alignbyte_b32 v29, v24, v23, 2
v_alignbyte_b32 v30, v25, v24, 2
v_alignbyte_b32 v31, v26, v25, 2
s_nop 0
ds_write_b128 v3, v[28:31] offset:20800
s_waitcnt lgkmcnt(0)
v_mov_b32 v28, v23
v_mov_b32 v29, v24
v_mov_b32 v30, v25
v_mov_b32 v31, v26
s_nop 0
ds_write_b128 v3, v[28:31] offset:24960
s_waitcnt lgkmcnt(0)
v_alignbyte_b32 v28, v24, v23, 2
v_alignbyte_b32 v29, v25, v24, 2
v_alignbyte_b32 v30, v26, v25, 2
v_alignbyte_b32 v31, v27, v26, 2
s_nop 0
ds_write_b128 v3, v[28:31] offset:29120
s_waitcnt lgkmcnt(0)
s_mov_b64 exec, s[54:55]
v_add_u32 v3, 192, v1
v_cmp_gt_u32 vcc, 260, v3
s_and_saveexec_b64 s[54:55], vcc
v_lshlrev_b32 v3, 4, v3
buffer_load_dwordx4 v[20:23], v3, s[12:15], 0 offen
buffer_load_dwordx4 v[24:27], v3, s[12:15], 0 offen offset:16
v_add_u32 v3, s46, v3
s_waitcnt vmcnt(0)
ds_write_b128 v3, v[20:23] offset:0
s_waitcnt lgkmcnt(0)
v_alignbyte_b32 v28, v21, v20, 2
v_alignbyte_b32 v29, v22, v21, 2
v_alignbyte_b32 v30, v23, v22, 2
v_alignbyte_b32 v31, v24, v23, 2
s_nop 0
ds_write_b128 v3, v[28:31] offset:4160
s_waitcnt lgkmcnt(0)
v_mov_b32 v28, v21
v_mov_b32 v29, v22
v_mov_b32 v30, v23
v_mov_b32 v31, v24
s_nop 0
ds_write_b128 v3, v[28:31] offset:8320
s_waitcnt lgkmcnt(0)
v_alignbyte_b32 v28, v22, v21, 2
v_alignbyte_b32 v29, v23, v22, 2
v_alignbyte_b32 v30, v24, v23, 2
v_alignbyte_b32 v31, v25, v24, 2
s_nop 0
ds_write_b128 v3, v[28:31] offset:12480
s_waitcnt lgkmcnt(0)
ds_write_b128 v3, v[22:25] offset:16640
s_waitcnt lgkmcnt(0)
v_alignbyte_b32 v28, v23, v22, 2
v_alignbyte_b32 v29, v24, v23, 2
v_alignbyte_b32 v30, v25, v24, 2
v_alignbyte_b32 v31, v26, v25, 2
s_nop 0
ds_write_b128 v3, v[28:31] offset:20800
s_waitcnt lgkmcnt(0)
v_mov_b32 v28, v23
v_mov_b32 v29, v24
v_mov_b32 v30, v25
v_mov_b32 v31, v26
s_nop 0
ds_write_b128 v3, v[28:31] offset:24960
s_waitcnt lgkmcnt(0)
v_alignbyte_b32 v28, v24, v23, 2
v_alignbyte_b32 v29, v25, v24, 2
v_alignbyte_b32 v30, v26, v25, 2
v_alignbyte_b32 v31, v27, v26, 2
s_nop 0
ds_write_b128 v3, v[28:31] offset:29120
s_waitcnt lgkmcnt(0)
s_mov_b64 exec, s[54:55]
v_add_u32 v3, 256, v1
v_cmp_gt_u32 vcc, 260, v3
s_and_saveexec_b64 s[54:55], vcc
v_lshlrev_b32 v3, 4, v3
buffer_load_dwordx4 v[20:23], v3, s[12:15], 0 offen
buffer_load_dwordx4 v[24:27], v3, s[12:15], 0 offen offset:16
v_add_u32 v3, s46, v3
s_waitcnt vmcnt(0)
ds_write_b128 v3, v[20:23] offset:0
s_waitcnt lgkmcnt(0)
v_alignbyte_b32 v28, v21, v20, 2
v_alignbyte_b32 v29, v22, v21, 2
v_alignbyte_b32 v30, v23, v22, 2
v_alignbyte_b32 v31, v24, v23, 2
s_nop 0
ds_write_b128 v3, v[28:31] offset:4160
s_waitcnt lgkmcnt(0)
v_mov_b32 v28, v21
v_mov_b32 v29, v22
v_mov_b32 v30, v23
v_mov_b32 v31, v24
s_nop 0
ds_write_b128 v3, v[28:31] offset:8320
s_waitcnt lgkmcnt(0)
v_alignbyte_b32 v28, v22, v21, 2
v_alignbyte_b32 v29, v23, v22, 2
v_alignbyte_b32 v30, v24, v23, 2
v_alignbyte_b32 v31, v25, v24, 2
s_nop 0
ds_write_b128 v3, v[28:31] offset:12480
s_waitcnt lgkmcnt(0)
ds_write_b128 v3, v[22:25] offset:16640
s_waitcnt lgkmcnt(0)
v_alignbyte_b32 v28, v23, v22, 2
v_alignbyte_b32 v29, v24, v23, 2
v_alignbyte_b32 v30, v25, v24, 2
v_alignbyte_b32 v31, v26, v25, 2
s_nop 0
ds_write_b128 v3, v[28:31] offset:20800
s_waitcnt lgkmcnt(0)
v_mov_b32 v28, v23
v_mov_b32 v29, v24
v_mov_b32 v30, v25
v_mov_b32 v31, v26
s_nop 0
ds_write_b128 v3, v[28:31] offset:24960
s_waitcnt lgkmcnt(0)
v_alignbyte_b32 v28, v24, v23, 2
v_alignbyte_b32 v29, v25, v24, 2
v_alignbyte_b32 v30, v26, v25, 2
v_alignbyte_b32 v31, v27, v26, 2
s_nop 0
ds_write_b128 v3, v[28:31] offset:29120
s_waitcnt lgkmcnt(0)
s_mov_b64 exec, s[54:55]
v_mov_b32 v28, 0
v_mov_b32 v29, 0
v_mov_b32 v30, 0
v_mov_b32 v31, 0
v_lshl_add_u32 v3, v1, 4, s46
ds_write_b128 v3, v[28:31] offset:33280
ds_write_b128 v3, v[28:31] offset:34304
v_cmp_gt_u32 vcc, 27, v1
s_and_saveexec_b64 s[54:55], vcc
ds_write_b128 v3, v[28:31] offset:35328
s_mov_b64 exec, s[54:55]
s_lshl_b32 s23, s21, 12
s_add_u32 s23, s23, 16777216
v_lshlrev_b32 v5, 4, v1
v_lshrrev_b32 v4, 2, v1
v_mul_u32_u24 v4, 80, v4
v_and_b32 v6, 3, v1
v_lshl_add_u32 v4, v6, 4, v4
v_add_u32 v4, s46, v4
buffer_load_dwordx4 v[64:67], v5, s[16:19], s23 offen offset:0
buffer_load_dwordx4 v[68:71], v5, s[16:19], s23 offen offset:1024
buffer_load_dwordx4 v[72:75], v5, s[16:19], s23 offen offset:2048
buffer_load_dwordx4 v[76:79], v5, s[16:19], s23 offen offset:3072
s_waitcnt vmcnt(0)
ds_write_b128 v4, v[64:67] offset:35760
ds_write_b128 v4, v[68:71] offset:37040
ds_write_b128 v4, v[72:75] offset:38320
ds_write_b128 v4, v[76:79] offset:39600
v_and_b32 v5, 31, v1
v_lshrrev_b32 v6, 5, v1
v_mul_u32_u24 v7, 80, v5
v_lshl_add_u32 v7, v6, 4, v7
v_add_u32 v7, s46, v7
v_add_u32 v7, 33280, v7
v_sub_u32 v8, 7, v5
v_and_b32 v8, 7, v8
v_mul_u32_u24 v8, 4160, v8
v_lshrrev_b32 v9, 3, v5
v_sub_u32 v9, v6, v9
v_add_u32 v9, 3, v9
v_lshl_add_u32 v8, v9, 4, v8
v_add_u32 v8, s46, v8
v_mov_b32 v64, 0
v_mov_b32 v65, 0
v_mov_b32 v66, 0
v_mov_b32 v67, 0
v_mov_b32 v68, 0
v_mov_b32 v69, 0
v_mov_b32 v70, 0
v_mov_b32 v71, 0
v_mov_b32 v72, 0
v_mov_b32 v73, 0
v_mov_b32 v74, 0
v_mov_b32 v75, 0
v_mov_b32 v76, 0
v_mov_b32 v77, 0
v_mov_b32 v78, 0
v_mov_b32 v79, 0
v_mov_b32 v80, 0
v_mov_b32 v81, 0
v_mov_b32 v82, 0
v_mov_b32 v83, 0
v_mov_b32 v84, 0
v_mov_b32 v85, 0
v_mov_b32 v86, 0
v_mov_b32 v87, 0
v_mov_b32 v88, 0
v_mov_b32 v89, 0
v_mov_b32 v90, 0
v_mov_b32 v91, 0
v_mov_b32 v92, 0
v_mov_b32 v93, 0
v_mov_b32 v94, 0
v_mov_b32 v95, 0
s_waitcnt lgkmcnt(0)
ds_read_b128 v[20:23], v8 offset:4032
ds_read_b128 v[24:27], v7 offset:5040
ds_read_b128 v[28:31], v7 offset:2480
ds_read_b128 v[32:35], v8 offset:4064
ds_read_b128 v[36:39], v7 offset:5072
ds_read_b128 v[40:43], v7 offset:2512
ds_read_b128 v[44:47], v8 offset:3968
ds_read_b128 v[48:51], v7 offset:4960
ds_read_b128 v[52:55], v7 offset:2400
s_waitcnt lgkmcnt(6)
v_mfma_f32_32x32x16_bf16 v[80:95], v[20:23], v[24:27], v[80:95]
v_mfma_f32_32x32x16_bf16 v[64:79], v[20:23], v[28:31], v[64:79]
ds_read_b128 v[20:23], v8 offset:4000
ds_read_b128 v[24:27], v7 offset:4992
ds_read_b128 v[28:31], v7 offset:2432
s_waitcnt lgkmcnt(6)
v_mfma_f32_32x32x16_bf16 v[80:95], v[32:35], v[36:39], v[80:95]
v_mfma_f32_32x32x16_bf16 v[64:79], v[32:35], v[40:43], v[64:79]
ds_read_b128 v[32:35], v8 offset:3904
ds_read_b128 v[36:39], v7 offset:4880
ds_read_b128 v[40:43], v7 offset:2320
s_waitcnt lgkmcnt(6)
v_mfma_f32_32x32x16_bf16 v[80:95], v[44:47], v[48:51], v[80:95]
v_mfma_f32_32x32x16_bf16 v[64:79], v[44:47], v[52:55], v[64:79]
ds_read_b128 v[44:47], v8 offset:3936
ds_read_b128 v[48:51], v7 offset:4912
ds_read_b128 v[52:55], v7 offset:2352
s_waitcnt lgkmcnt(6)
v_mfma_f32_32x32x16_bf16 v[80:95], v[20:23], v[24:27], v[80:95]
v_mfma_f32_32x32x16_bf16 v[64:79], v[20:23], v[28:31], v[64:79]
ds_read_b128 v[20:23], v8 offset:3840
ds_read_b128 v[24:27], v7 offset:4800
ds_read_b128 v[28:31], v7 offset:2240
s_waitcnt lgkmcnt(6)
v_mfma_f32_32x32x16_bf16 v[80:95], v[32:35], v[36:39], v[80:95]
v_mfma_f32_32x32x16_bf16 v[64:79], v[32:35], v[40:43], v[64:79]
ds_read_b128 v[32:35], v8 offset:3872
ds_read_b128 v[36:39], v7 offset:4832
ds_read_b128 v[40:43], v7 offset:2272
s_waitcnt lgkmcnt(6)
v_mfma_f32_32x32x16_bf16 v[80:95], v[44:47], v[48:51], v[80:95]
v_mfma_f32_32x32x16_bf16 v[64:79], v[44:47], v[52:55], v[64:79]
ds_read_b128 v[44:47], v8 offset:3776
ds_read_b128 v[48:51], v7 offset:4720
ds_read_b128 v[52:55], v7 offset:2160
s_waitcnt lgkmcnt(6)
v_mfma_f32_32x32x16_bf16 v[80:95], v[20:23], v[24:27], v[80:95]
v_mfma_f32_32x32x16_bf16 v[64:79], v[20:23], v[28:31], v[64:79]
ds_read_b128 v[20:23], v8 offset:3808
ds_read_b128 v[24:27], v7 offset:4752
ds_read_b128 v[28:31], v7 offset:2192
s_waitcnt lgkmcnt(6)
v_mfma_f32_32x32x16_bf16 v[80:95], v[32:35], v[36:39], v[80:95]
v_mfma_f32_32x32x16_bf16 v[64:79], v[32:35], v[40:43], v[64:79]
ds_read_b128 v[32:35], v8 offset:3712
ds_read_b128 v[36:39], v7 offset:4640
ds_read_b128 v[40:43], v7 offset:2080
s_waitcnt lgkmcnt(6)
v_mfma_f32_32x32x16_bf16 v[80:95], v[44:47], v[48:51], v[80:95]
v_mfma_f32_32x32x16_bf16 v[64:79], v[44:47], v[52:55], v[64:79]
ds_read_b128 v[44:47], v8 offset:3744
ds_read_b128 v[48:51], v7 offset:4672
ds_read_b128 v[52:55], v7 offset:2112
s_waitcnt lgkmcnt(6)
v_mfma_f32_32x32x16_bf16 v[80:95], v[20:23], v[24:27], v[80:95]
v_mfma_f32_32x32x16_bf16 v[64:79], v[20:23], v[28:31], v[64:79]
ds_read_b128 v[20:23], v8 offset:3648
ds_read_b128 v[24:27], v7 offset:4560
ds_read_b128 v[28:31], v7 offset:2000
s_waitcnt lgkmcnt(6)
v_mfma_f32_32x32x16_bf16 v[80:95], v[32:35], v[36:39], v[80:95]
v_mfma_f32_32x32x16_bf16 v[64:79], v[32:35], v[40:43], v[64:79]
ds_read_b128 v[32:35], v8 offset:3680
ds_read_b128 v[36:39], v7 offset:4592
ds_read_b128 v[40:43], v7 offset:2032
s_waitcnt lgkmcnt(6)
v_mfma_f32_32x32x16_bf16 v[80:95], v[44:47], v[48:51], v[80:95]
v_mfma_f32_32x32x16_bf16 v[64:79], v[44:47], v[52:55], v[64:79]
ds_read_b128 v[44:47], v8 offset:3584
ds_read_b128 v[48:51], v7 offset:4480
ds_read_b128 v[52:55], v7 offset:1920
s_waitcnt lgkmcnt(6)
v_mfma_f32_32x32x16_bf16 v[80:95], v[20:23], v[24:27], v[80:95]
v_mfma_f32_32x32x16_bf16 v[64:79], v[20:23], v[28:31], v[64:79]
ds_read_b128 v[20:23], v8 offset:3616
ds_read_b128 v[24:27], v7 offset:4512
ds_read_b128 v[28:31], v7 offset:1952
s_waitcnt lgkmcnt(6)
v_mfma_f32_32x32x16_bf16 v[80:95], v[32:35], v[36:39], v[80:95]
v_mfma_f32_32x32x16_bf16 v[64:79], v[32:35], v[40:43], v[64:79]
ds_read_b128 v[32:35], v8 offset:3520
ds_read_b128 v[36:39], v7 offset:4400
ds_read_b128 v[40:43], v7 offset:1840
s_waitcnt lgkmcnt(6)
v_mfma_f32_32x32x16_bf16 v[80:95], v[44:47], v[48:51], v[80:95]
v_mfma_f32_32x32x16_bf16 v[64:79], v[44:47], v[52:55], v[64:79]
ds_read_b128 v[44:47], v8 offset:3552
ds_read_b128 v[48:51], v7 offset:4432
ds_read_b128 v[52:55], v7 offset:1872
s_waitcnt lgkmcnt(6)
v_mfma_f32_32x32x16_bf16 v[80:95], v[20:23], v[24:27], v[80:95]
v_mfma_f32_32x32x16_bf16 v[64:79], v[20:23], v[28:31], v[64:79]
ds_read_b128 v[20:23], v8 offset:3456
ds_read_b128 v[24:27], v7 offset:4320
ds_read_b128 v[28:31], v7 offset:1760
s_waitcnt lgkmcnt(6)
v_mfma_f32_32x32x16_bf16 v[80:95], v[32:35], v[36:39], v[80:95]
v_mfma_f32_32x32x16_bf16 v[64:79], v[32:35], v[40:43], v[64:79]
ds_read_b128 v[32:35], v8 offset:3488
ds_read_b128 v[36:39], v7 offset:4352
ds_read_b128 v[40:43], v7 offset:1792
s_waitcnt lgkmcnt(6)
v_mfma_f32_32x32x16_bf16 v[80:95], v[44:47], v[48:51], v[80:95]
v_mfma_f32_32x32x16_bf16 v[64:79], v[44:47], v[52:55], v[64:79]
ds_read_b128 v[44:47], v8 offset:3392
ds_read_b128 v[48:51], v7 offset:4240
ds_read_b128 v[52:55], v7 offset:1680
s_waitcnt lgkmcnt(6)
v_mfma_f32_32x32x16_bf16 v[80:95], v[20:23], v[24:27], v[80:95]
v_mfma_f32_32x32x16_bf16 v[64:79], v[20:23], v[28:31], v[64:79]
ds_read_b128 v[20:23], v8 offset:3424
ds_read_b128 v[24:27], v7 offset:4272
ds_read_b128 v[28:31], v7 offset:1712
s_waitcnt lgkmcnt(6)
v_mfma_f32_32x32x16_bf16 v[80:95], v[32:35], v[36:39], v[80:95]
v_mfma_f32_32x32x16_bf16 v[64:79], v[32:35], v[40:43], v[64:79]
ds_read_b128 v[32:35], v8 offset:3328
ds_read_b128 v[36:39], v7 offset:4160
ds_read_b128 v[40:43], v7 offset:1600
s_waitcnt lgkmcnt(6)
v_mfma_f32_32x32x16_bf16 v[80:95], v[44:47], v[48:51], v[80:95]
v_mfma_f32_32x32x16_bf16 v[64:79], v[44:47], v[52:55], v[64:79]
ds_read_b128 v[44:47], v8 offset:3360
ds_read_b128 v[48:51], v7 offset:4192
ds_read_b128 v[52:55], v7 offset:1632
s_waitcnt lgkmcnt(6)
v_mfma_f32_32x32x16_bf16 v[80:95], v[20:23], v[24:27], v[80:95]
v_mfma_f32_32x32x16_bf16 v[64:79], v[20:23], v[28:31], v[64:79]
ds_read_b128 v[20:23], v8 offset:3264
ds_read_b128 v[24:27], v7 offset:4080
ds_read_b128 v[28:31], v7 offset:1520
s_waitcnt lgkmcnt(6)
v_mfma_f32_32x32x16_bf16 v[80:95], v[32:35], v[36:39], v[80:95]
v_mfma_f32_32x32x16_bf16 v[64:79], v[32:35], v[40:43], v[64:79]
ds_read_b128 v[32:35], v8 offset:3296
ds_read_b128 v[36:39], v7 offset:4112
ds_read_b128 v[40:43], v7 offset:1552
s_waitcnt lgkmcnt(6)
v_mfma_f32_32x32x16_bf16 v[80:95], v[44:47], v[48:51], v[80:95]
v_mfma_f32_32x32x16_bf16 v[64:79], v[44:47], v[52:55], v[64:79]
ds_read_b128 v[44:47], v8 offset:3200
ds_read_b128 v[48:51], v7 offset:4000
ds_read_b128 v[52:55], v7 offset:1440
s_waitcnt lgkmcnt(6)
v_mfma_f32_32x32x16_bf16 v[80:95], v[20:23], v[24:27], v[80:95]
v_mfma_f32_32x32x16_bf16 v[64:79], v[20:23], v[28:31], v[64:79]
ds_read_b128 v[20:23], v8 offset:3232
ds_read_b128 v[24:27], v7 offset:4032
ds_read_b128 v[28:31], v7 offset:1472
s_waitcnt lgkmcnt(6)
v_mfma_f32_32x32x16_bf16 v[80:95], v[32:35], v[36:39], v[80:95]
v_mfma_f32_32x32x16_bf16 v[64:79], v[32:35], v[40:43], v[64:79]
ds_read_b128 v[32:35], v8 offset:3136
ds_read_b128 v[36:39], v7 offset:3920
ds_read_b128 v[40:43], v7 offset:1360
s_waitcnt lgkmcnt(6)
v_mfma_f32_32x32x16_bf16 v[80:95], v[44:47], v[48:51], v[80:95]
v_mfma_f32_32x32x16_bf16 v[64:79], v[44:47], v[52:55], v[64:79]
ds_read_b128 v[44:47], v8 offset:3168
ds_read_b128 v[48:51], v7 offset:3952
ds_read_b128 v[52:55], v7 offset:1392
s_waitcnt lgkmcnt(6)
v_mfma_f32_32x32x16_bf16 v[80:95], v[20:23], v[24:27], v[80:95]
v_mfma_f32_32x32x16_bf16 v[64:79], v[20:23], v[28:31], v[64:79]
ds_read_b128 v[20:23], v8 offset:3072
ds_read_b128 v[24:27], v7 offset:3840
ds_read_b128 v[28:31], v7 offset:1280
s_waitcnt lgkmcnt(6)
v_mfma_f32_32x32x16_bf16 v[80:95], v[32:35], v[36:39], v[80:95]
v_mfma_f32_32x32x16_bf16 v[64:79], v[32:35], v[40:43], v[64:79]
ds_read_b128 v[32:35], v8 offset:3104
ds_read_b128 v[36:39], v7 offset:3872
ds_read_b128 v[40:43], v7 offset:1312
s_waitcnt lgkmcnt(6)
v_mfma_f32_32x32x16_bf16 v[80:95], v[44:47], v[48:51], v[80:95]
v_mfma_f32_32x32x16_bf16 v[64:79], v[44:47], v[52:55], v[64:79]
ds_read_b128 v[44:47], v8 offset:3008
ds_read_b128 v[48:51], v7 offset:3760
ds_read_b128 v[52:55], v7 offset:1200
s_waitcnt lgkmcnt(6)
v_mfma_f32_32x32x16_bf16 v[80:95], v[20:23], v[24:27], v[80:95]
v_mfma_f32_32x32x16_bf16 v[64:79], v[20:23], v[28:31], v[64:79]
ds_read_b128 v[20:23], v8 offset:3040
ds_read_b128 v[24:27], v7 offset:3792
ds_read_b128 v[28:31], v7 offset:1232
s_waitcnt lgkmcnt(6)
v_mfma_f32_32x32x16_bf16 v[80:95], v[32:35], v[36:39], v[80:95]
v_mfma_f32_32x32x16_bf16 v[64:79], v[32:35], v[40:43], v[64:79]
ds_read_b128 v[32:35], v8 offset:2944
ds_read_b128 v[36:39], v7 offset:3680
ds_read_b128 v[40:43], v7 offset:1120
s_waitcnt lgkmcnt(6)
v_mfma_f32_32x32x16_bf16 v[80:95], v[44:47], v[48:51], v[80:95]
v_mfma_f32_32x32x16_bf16 v[64:79], v[44:47], v[52:55], v[64:79]
ds_read_b128 v[44:47], v8 offset:2976
ds_read_b128 v[48:51], v7 offset:3712
ds_read_b128 v[52:55], v7 offset:1152
s_waitcnt lgkmcnt(6)
v_mfma_f32_32x32x16_bf16 v[80:95], v[20:23], v[24:27], v[80:95]
v_mfma_f32_32x32x16_bf16 v[64:79], v[20:23], v[28:31], v[64:79]
ds_read_b128 v[20:23], v8 offset:2880
ds_read_b128 v[24:27], v7 offset:3600
ds_read_b128 v[28:31], v7 offset:1040
s_waitcnt lgkmcnt(6)
v_mfma_f32_32x32x16_bf16 v[80:95], v[32:35], v[36:39], v[80:95]
v_mfma_f32_32x32x16_bf16 v[64:79], v[32:35], v[40:43], v[64:79]
ds_read_b128 v[32:35], v8 offset:2912
ds_read_b128 v[36:39], v7 offset:3632
ds_read_b128 v[40:43], v7 offset:1072
s_waitcnt lgkmcnt(6)
v_mfma_f32_32x32x16_bf16 v[80:95], v[44:47], v[48:51], v[80:95]
v_mfma_f32_32x32x16_bf16 v[64:79], v[44:47], v[52:55], v[64:79]
ds_read_b128 v[44:47], v8 offset:2816
ds_read_b128 v[48:51], v7 offset:3520
ds_read_b128 v[52:55], v7 offset:960
s_waitcnt lgkmcnt(6)
v_mfma_f32_32x32x16_bf16 v[80:95], v[20:23], v[24:27], v[80:95]
v_mfma_f32_32x32x16_bf16 v[64:79], v[20:23], v[28:31], v[64:79]
ds_read_b128 v[20:23], v8 offset:2848
ds_read_b128 v[24:27], v7 offset:3552
ds_read_b128 v[28:31], v7 offset:992
s_waitcnt lgkmcnt(6)
v_mfma_f32_32x32x16_bf16 v[80:95], v[32:35], v[36:39], v[80:95]
v_mfma_f32_32x32x16_bf16 v[64:79], v[32:35], v[40:43], v[64:79]
ds_read_b128 v[32:35], v8 offset:2752
ds_read_b128 v[36:39], v7 offset:3440
ds_read_b128 v[40:43], v7 offset:880
s_waitcnt lgkmcnt(6)
v_mfma_f32_32x32x16_bf16 v[80:95], v[44:47], v[48:51], v[80:95]
v_mfma_f32_32x32x16_bf16 v[64:79], v[44:47], v[52:55], v[64:79]
ds_read_b128 v[44:47], v8 offset:2784
ds_read_b128 v[48:51], v7 offset:3472
ds_read_b128 v[52:55], v7 offset:912
s_waitcnt lgkmcnt(6)
v_mfma_f32_32x32x16_bf16 v[80:95], v[20:23], v[24:27], v[80:95]
v_mfma_f32_32x32x16_bf16 v[64:79], v[20:23], v[28:31], v[64:79]
ds_read_b128 v[20:23], v8 offset:2688
ds_read_b128 v[24:27], v7 offset:3360
ds_read_b128 v[28:31], v7 offset:800
s_waitcnt lgkmcnt(6)
v_mfma_f32_32x32x16_bf16 v[80:95], v[32:35], v[36:39], v[80:95]
v_mfma_f32_32x32x16_bf16 v[64:79], v[32:35], v[40:43], v[64:79]
ds_read_b128 v[32:35], v8 offset:2720
ds_read_b128 v[36:39], v7 offset:3392
ds_read_b128 v[40:43], v7 offset:832
s_waitcnt lgkmcnt(6)
v_mfma_f32_32x32x16_bf16 v[80:95], v[44:47], v[48:51], v[80:95]
v_mfma_f32_32x32x16_bf16 v[64:79], v[44:47], v[52:55], v[64:79]
ds_read_b128 v[44:47], v8 offset:2624
ds_read_b128 v[48:51], v7 offset:3280
ds_read_b128 v[52:55], v7 offset:720
s_waitcnt lgkmcnt(6)
v_mfma_f32_32x32x16_bf16 v[80:95], v[20:23], v[24:27], v[80:95]
v_mfma_f32_32x32x16_bf16 v[64:79], v[20:23], v[28:31], v[64:79]
ds_read_b128 v[20:23], v8 offset:2656
ds_read_b128 v[24:27], v7 offset:3312
ds_read_b128 v[28:31], v7 offset:752
s_waitcnt lgkmcnt(6)
v_mfma_f32_32x32x16_bf16 v[80:95], v[32:35], v[36:39], v[80:95]
v_mfma_f32_32x32x16_bf16 v[64:79], v[32:35], v[40:43], v[64:79]
ds_read_b128 v[32:35], v8 offset:2560
ds_read_b128 v[36:39], v7 offset:3200
ds_read_b128 v[40:43], v7 offset:640
s_waitcnt lgkmcnt(6)
v_mfma_f32_32x32x16_bf16 v[80:95], v[44:47], v[48:51], v[80:95]
v_mfma_f32_32x32x16_bf16 v[64:79], v[44:47], v[52:55], v[64:79]
ds_read_b128 v[44:47], v8 offset:2592
ds_read_b128 v[48:51], v7 offset:3232
ds_read_b128 v[52:55], v7 offset:672
s_waitcnt lgkmcnt(6)
v_mfma_f32_32x32x16_bf16 v[80:95], v[20:23], v[24:27], v[80:95]
v_mfma_f32_32x32x16_bf16 v[64:79], v[20:23], v[28:31], v[64:79]
ds_read_b128 v[20:23], v8 offset:2496
ds_read_b128 v[24:27], v7 offset:3120
ds_read_b128 v[28:31], v7 offset:560
s_waitcnt lgkmcnt(6)
v_mfma_f32_32x32x16_bf16 v[80:95], v[32:35], v[36:39], v[80:95]
v_mfma_f32_32x32x16_bf16 v[64:79], v[32:35], v[40:43], v[64:79]
ds_read_b128 v[32:35], v8 offset:2528
ds_read_b128 v[36:39], v7 offset:3152
ds_read_b128 v[40:43], v7 offset:592
s_waitcnt lgkmcnt(6)
v_mfma_f32_32x32x16_bf16 v[80:95], v[44:47], v[48:51], v[80:95]
v_mfma_f32_32x32x16_bf16 v[64:79], v[44:47], v[52:55], v[64:79]
ds_read_b128 v[44:47], v8 offset:2432
ds_read_b128 v[48:51], v7 offset:3040
ds_read_b128 v[52:55], v7 offset:480
s_waitcnt lgkmcnt(6)
v_mfma_f32_32x32x16_bf16 v[80:95], v[20:23], v[24:27], v[80:95]
v_mfma_f32_32x32x16_bf16 v[64:79], v[20:23], v[28:31], v[64:79]
ds_read_b128 v[20:23], v8 offset:2464
ds_read_b128 v[24:27], v7 offset:3072
ds_read_b128 v[28:31], v7 offset:512
s_waitcnt lgkmcnt(6)
v_mfma_f32_32x32x16_bf16 v[80:95], v[32:35], v[36:39], v[80:95]
v_mfma_f32_32x32x16_bf16 v[64:79], v[32:35], v[40:43], v[64:79]
ds_read_b128 v[32:35], v8 offset:2368
ds_read_b128 v[36:39], v7 offset:2960
ds_read_b128 v[40:43], v7 offset:400
s_waitcnt lgkmcnt(6)
v_mfma_f32_32x32x16_bf16 v[80:95], v[44:47], v[48:51], v[80:95]
v_mfma_f32_32x32x16_bf16 v[64:79], v[44:47], v[52:55], v[64:79]
ds_read_b128 v[44:47], v8 offset:2400
ds_read_b128 v[48:51], v7 offset:2992
ds_read_b128 v[52:55], v7 offset:432
s_waitcnt lgkmcnt(6)
v_mfma_f32_32x32x16_bf16 v[80:95], v[20:23], v[24:27], v[80:95]
v_mfma_f32_32x32x16_bf16 v[64:79], v[20:23], v[28:31], v[64:79]
ds_read_b128 v[20:23], v8 offset:2304
ds_read_b128 v[24:27], v7 offset:2880
ds_read_b128 v[28:31], v7 offset:320
s_waitcnt lgkmcnt(6)
v_mfma_f32_32x32x16_bf16 v[80:95], v[32:35], v[36:39], v[80:95]
v_mfma_f32_32x32x16_bf16 v[64:79], v[32:35], v[40:43], v[64:79]
ds_read_b128 v[32:35], v8 offset:2336
ds_read_b128 v[36:39], v7 offset:2912
ds_read_b128 v[40:43], v7 offset:352
s_waitcnt lgkmcnt(6)
v_mfma_f32_32x32x16_bf16 v[80:95], v[44:47], v[48:51], v[80:95]
v_mfma_f32_32x32x16_bf16 v[64:79], v[44:47], v[52:55], v[64:79]
ds_read_b128 v[44:47], v8 offset:2240
ds_read_b128 v[48:51], v7 offset:2800
ds_read_b128 v[52:55], v7 offset:240
s_waitcnt lgkmcnt(6)
v_mfma_f32_32x32x16_bf16 v[80:95], v[20:23], v[24:27], v[80:95]
v_mfma_f32_32x32x16_bf16 v[64:79], v[20:23], v[28:31], v[64:79]
ds_read_b128 v[20:23], v8 offset:2272
ds_read_b128 v[24:27], v7 offset:2832
ds_read_b128 v[28:31], v7 offset:272
s_waitcnt lgkmcnt(6)
v_mfma_f32_32x32x16_bf16 v[80:95], v[32:35], v[36:39], v[80:95]
v_mfma_f32_32x32x16_bf16 v[64:79], v[32:35], v[40:43], v[64:79]
ds_read_b128 v[32:35], v8 offset:2176
ds_read_b128 v[36:39], v7 offset:2720
ds_read_b128 v[40:43], v7 offset:160
s_waitcnt lgkmcnt(6)
v_mfma_f32_32x32x16_bf16 v[80:95], v[44:47], v[48:51], v[80:95]
v_mfma_f32_32x32x16_bf16 v[64:79], v[44:47], v[52:55], v[64:79]
ds_read_b128 v[44:47], v8 offset:2208
ds_read_b128 v[48:51], v7 offset:2752
ds_read_b128 v[52:55], v7 offset:192
s_waitcnt lgkmcnt(6)
v_mfma_f32_32x32x16_bf16 v[80:95], v[20:23], v[24:27], v[80:95]
v_mfma_f32_32x32x16_bf16 v[64:79], v[20:23], v[28:31], v[64:79]
ds_read_b128 v[20:23], v8 offset:2112
ds_read_b128 v[24:27], v7 offset:2640
ds_read_b128 v[28:31], v7 offset:80
s_waitcnt lgkmcnt(6)
v_mfma_f32_32x32x16_bf16 v[80:95], v[32:35], v[36:39], v[80:95]
v_mfma_f32_32x32x16_bf16 v[64:79], v[32:35], v[40:43], v[64:79]
ds_read_b128 v[32:35], v8 offset:2144
ds_read_b128 v[36:39], v7 offset:2672
ds_read_b128 v[40:43], v7 offset:112
s_waitcnt lgkmcnt(6)
v_mfma_f32_32x32x16_bf16 v[80:95], v[44:47], v[48:51], v[80:95]
v_mfma_f32_32x32x16_bf16 v[64:79], v[44:47], v[52:55], v[64:79]
ds_read_b128 v[44:47], v8 offset:2048
ds_read_b128 v[48:51], v7 offset:2560
ds_read_b128 v[52:55], v7 offset:0
s_waitcnt lgkmcnt(6)
v_mfma_f32_32x32x16_bf16 v[80:95], v[20:23], v[24:27], v[80:95]
v_mfma_f32_32x32x16_bf16 v[64:79], v[20:23], v[28:31], v[64:79]
ds_read_b128 v[20:23], v8 offset:2080
ds_read_b128 v[24:27], v7 offset:2592
ds_read_b128 v[28:31], v7 offset:32
s_waitcnt lgkmcnt(6)
v_mfma_f32_32x32x16_bf16 v[80:95], v[32:35], v[36:39], v[80:95]
v_mfma_f32_32x32x16_bf16 v[64:79], v[32:35], v[40:43], v[64:79]
ds_read_b128 v[32:35], v8 offset:1984
ds_read_b128 v[36:39], v7 offset:2480
s_waitcnt lgkmcnt(5)
v_mfma_f32_32x32x16_bf16 v[80:95], v[44:47], v[48:51], v[80:95]
v_mfma_f32_32x32x16_bf16 v[64:79], v[44:47], v[52:55], v[64:79]
ds_read_b128 v[44:47], v8 offset:2016
ds_read_b128 v[48:51], v7 offset:2512
s_waitcnt lgkmcnt(4)
v_mfma_f32_32x32x16_bf16 v[80:95], v[20:23], v[24:27], v[80:95]
v_mfma_f32_32x32x16_bf16 v[64:79], v[20:23], v[28:31], v[64:79]
ds_read_b128 v[20:23], v8 offset:1920
ds_read_b128 v[24:27], v7 offset:2400
s_waitcnt lgkmcnt(4)
v_mfma_f32_32x32x16_bf16 v[80:95], v[32:35], v[36:39], v[80:95]
ds_read_b128 v[32:35], v8 offset:1952
ds_read_b128 v[36:39], v7 offset:2432
s_waitcnt lgkmcnt(4)
v_mfma_f32_32x32x16_bf16 v[80:95], v[44:47], v[48:51], v[80:95]
ds_read_b128 v[44:47], v8 offset:1856
ds_read_b128 v[48:51], v7 offset:2320
s_waitcnt lgkmcnt(4)
v_mfma_f32_32x32x16_bf16 v[80:95], v[20:23], v[24:27], v[80:95]
ds_read_b128 v[20:23], v8 offset:1888
ds_read_b128 v[24:27], v7 offset:2352
s_waitcnt lgkmcnt(4)
v_mfma_f32_32x32x16_bf16 v[80:95], v[32:35], v[36:39], v[80:95]
ds_read_b128 v[32:35], v8 offset:1792
ds_read_b128 v[36:39], v7 offset:2240
s_waitcnt lgkmcnt(4)
v_mfma_f32_32x32x16_bf16 v[80:95], v[44:47], v[48:51], v[80:95]
ds_read_b128 v[44:47], v8 offset:1824
ds_read_b128 v[48:51], v7 offset:2272
s_waitcnt lgkmcnt(4)
v_mfma_f32_32x32x16_bf16 v[80:95], v[20:23], v[24:27], v[80:95]
ds_read_b128 v[20:23], v8 offset:1728
ds_read_b128 v[24:27], v7 offset:2160
s_waitcnt lgkmcnt(4)
v_mfma_f32_32x32x16_bf16 v[80:95], v[32:35], v[36:39], v[80:95]
ds_read_b128 v[32:35], v8 offset:1760
ds_read_b128 v[36:39], v7 offset:2192
s_waitcnt lgkmcnt(4)
v_mfma_f32_32x32x16_bf16 v[80:95], v[44:47], v[48:51], v[80:95]
ds_read_b128 v[44:47], v8 offset:1664
ds_read_b128 v[48:51], v7 offset:2080
s_waitcnt lgkmcnt(4)
v_mfma_f32_32x32x16_bf16 v[80:95], v[20:23], v[24:27], v[80:95]
ds_read_b128 v[20:23], v8 offset:1696
ds_read_b128 v[24:27], v7 offset:2112
s_waitcnt lgkmcnt(4)
v_mfma_f32_32x32x16_bf16 v[80:95], v[32:35], v[36:39], v[80:95]
ds_read_b128 v[32:35], v8 offset:1600
ds_read_b128 v[36:39], v7 offset:2000
s_waitcnt lgkmcnt(4)
v_mfma_f32_32x32x16_bf16 v[80:95], v[44:47], v[48:51], v[80:95]
ds_read_b128 v[44:47], v8 offset:1632
ds_read_b128 v[48:51], v7 offset:2032
s_waitcnt lgkmcnt(4)
v_mfma_f32_32x32x16_bf16 v[80:95], v[20:23], v[24:27], v[80:95]
ds_read_b128 v[20:23], v8 offset:1536
ds_read_b128 v[24:27], v7 offset:1920
s_waitcnt lgkmcnt(4)
v_mfma_f32_32x32x16_bf16 v[80:95], v[32:35], v[36:39], v[80:95]
ds_read_b128 v[32:35], v8 offset:1568
ds_read_b128 v[36:39], v7 offset:1952
s_waitcnt lgkmcnt(4)
v_mfma_f32_32x32x16_bf16 v[80:95], v[44:47], v[48:51], v[80:95]
ds_read_b128 v[44:47], v8 offset:1472
ds_read_b128 v[48:51], v7 offset:1840
s_waitcnt lgkmcnt(4)
v_mfma_f32_32x32x16_bf16 v[80:95], v[20:23], v[24:27], v[80:95]
ds_read_b128 v[20:23], v8 offset:1504
ds_read_b128 v[24:27], v7 offset:1872
s_waitcnt lgkmcnt(4)
v_mfma_f32_32x32x16_bf16 v[80:95], v[32:35], v[36:39], v[80:95]
ds_read_b128 v[32:35], v8 offset:1408
ds_read_b128 v[36:39], v7 offset:1760
s_waitcnt lgkmcnt(4)
v_mfma_f32_32x32x16_bf16 v[80:95], v[44:47], v[48:51], v[80:95]
ds_read_b128 v[44:47], v8 offset:1440
ds_read_b128 v[48:51], v7 offset:1792
s_waitcnt lgkmcnt(4)
v_mfma_f32_32x32x16_bf16 v[80:95], v[20:23], v[24:27], v[80:95]
ds_read_b128 v[20:23], v8 offset:1344
ds_read_b128 v[24:27], v7 offset:1680
s_waitcnt lgkmcnt(4)
v_mfma_f32_32x32x16_bf16 v[80:95], v[32:35], v[36:39], v[80:95]
ds_read_b128 v[32:35], v8 offset:1376
ds_read_b128 v[36:39], v7 offset:1712
s_waitcnt lgkmcnt(4)
v_mfma_f32_32x32x16_bf16 v[80:95], v[44:47], v[48:51], v[80:95]
ds_read_b128 v[44:47], v8 offset:1280
ds_read_b128 v[48:51], v7 offset:1600
s_waitcnt lgkmcnt(4)
v_mfma_f32_32x32x16_bf16 v[80:95], v[20:23], v[24:27], v[80:95]
ds_read_b128 v[20:23], v8 offset:1312
ds_read_b128 v[24:27], v7 offset:1632
s_waitcnt lgkmcnt(4)
v_mfma_f32_32x32x16_bf16 v[80:95], v[32:35], v[36:39], v[80:95]
ds_read_b128 v[32:35], v8 offset:1216
ds_read_b128 v[36:39], v7 offset:1520
s_waitcnt lgkmcnt(4)
v_mfma_f32_32x32x16_bf16 v[80:95], v[44:47], v[48:51], v[80:95]
ds_read_b128 v[44:47], v8 offset:1248
ds_read_b128 v[48:51], v7 offset:1552
s_waitcnt lgkmcnt(4)
v_mfma_f32_32x32x16_bf16 v[80:95], v[20:23], v[24:27], v[80:95]
ds_read_b128 v[20:23], v8 offset:1152
ds_read_b128 v[24:27], v7 offset:1440
s_waitcnt lgkmcnt(4)
v_mfma_f32_32x32x16_bf16 v[80:95], v[32:35], v[36:39], v[80:95]
ds_read_b128 v[32:35], v8 offset:1184
ds_read_b128 v[36:39], v7 offset:1472
s_waitcnt lgkmcnt(4)
v_mfma_f32_32x32x16_bf16 v[80:95], v[44:47], v[48:51], v[80:95]
ds_read_b128 v[44:47], v8 offset:1088
ds_read_b128 v[48:51], v7 offset:1360
s_waitcnt lgkmcnt(4)
v_mfma_f32_32x32x16_bf16 v[80:95], v[20:23], v[24:27], v[80:95]
ds_read_b128 v[20:23], v8 offset:1120
ds_read_b128 v[24:27], v7 offset:1392
s_waitcnt lgkmcnt(4)
v_mfma_f32_32x32x16_bf16 v[80:95], v[32:35], v[36:39], v[80:95]
ds_read_b128 v[32:35], v8 offset:1024
ds_read_b128 v[36:39], v7 offset:1280
s_waitcnt lgkmcnt(4)
v_mfma_f32_32x32x16_bf16 v[80:95], v[44:47], v[48:51], v[80:95]
ds_read_b128 v[44:47], v8 offset:1056
ds_read_b128 v[48:51], v7 offset:1312
s_waitcnt lgkmcnt(4)
v_mfma_f32_32x32x16_bf16 v[80:95], v[20:23], v[24:27], v[80:95]
ds_read_b128 v[20:23], v8 offset:960
ds_read_b128 v[24:27], v7 offset:1200
s_waitcnt lgkmcnt(4)
v_mfma_f32_32x32x16_bf16 v[80:95], v[32:35], v[36:39], v[80:95]
ds_read_b128 v[32:35], v8 offset:992
ds_read_b128 v[36:39], v7 offset:1232
s_waitcnt lgkmcnt(4)
v_mfma_f32_32x32x16_bf16 v[80:95], v[44:47], v[48:51], v[80:95]
ds_read_b128 v[44:47], v8 offset:896
ds_read_b128 v[48:51], v7 offset:1120
s_waitcnt lgkmcnt(4)
v_mfma_f32_32x32x16_bf16 v[80:95], v[20:23], v[24:27], v[80:95]
ds_read_b128 v[20:23], v8 offset:928
ds_read_b128 v[24:27], v7 offset:1152
s_waitcnt lgkmcnt(4)
v_mfma_f32_32x32x16_bf16 v[80:95], v[32:35], v[36:39], v[80:95]
ds_read_b128 v[32:35], v8 offset:832
ds_read_b128 v[36:39], v7 offset:1040
s_waitcnt lgkmcnt(4)
v_mfma_f32_32x32x16_bf16 v[80:95], v[44:47], v[48:51], v[80:95]
ds_read_b128 v[44:47], v8 offset:864
ds_read_b128 v[48:51], v7 offset:1072
s_waitcnt lgkmcnt(4)
v_mfma_f32_32x32x16_bf16 v[80:95], v[20:23], v[24:27], v[80:95]
ds_read_b128 v[20:23], v8 offset:768
ds_read_b128 v[24:27], v7 offset:960
s_waitcnt lgkmcnt(4)
v_mfma_f32_32x32x16_bf16 v[80:95], v[32:35], v[36:39], v[80:95]
ds_read_b128 v[32:35], v8 offset:800
ds_read_b128 v[36:39], v7 offset:992
s_waitcnt lgkmcnt(4)
v_mfma_f32_32x32x16_bf16 v[80:95], v[44:47], v[48:51], v[80:95]
ds_read_b128 v[44:47], v8 offset:704
ds_read_b128 v[48:51], v7 offset:880
s_waitcnt lgkmcnt(4)
v_mfma_f32_32x32x16_bf16 v[80:95], v[20:23], v[24:27], v[80:95]
ds_read_b128 v[20:23], v8 offset:736
ds_read_b128 v[24:27], v7 offset:912
s_waitcnt lgkmcnt(4)
v_mfma_f32_32x32x16_bf16 v[80:95], v[32:35], v[36:39], v[80:95]
ds_read_b128 v[32:35], v8 offset:640
ds_read_b128 v[36:39], v7 offset:800
s_waitcnt lgkmcnt(4)
v_mfma_f32_32x32x16_bf16 v[80:95], v[44:47], v[48:51], v[80:95]
ds_read_b128 v[44:47], v8 offset:672
ds_read_b128 v[48:51], v7 offset:832
s_waitcnt lgkmcnt(4)
v_mfma_f32_32x32x16_bf16 v[80:95], v[20:23], v[24:27], v[80:95]
ds_read_b128 v[20:23], v8 offset:576
ds_read_b128 v[24:27], v7 offset:720
s_waitcnt lgkmcnt(4)
v_mfma_f32_32x32x16_bf16 v[80:95], v[32:35], v[36:39], v[80:95]
ds_read_b128 v[32:35], v8 offset:608
ds_read_b128 v[36:39], v7 offset:752
s_waitcnt lgkmcnt(4)
v_mfma_f32_32x32x16_bf16 v[80:95], v[44:47], v[48:51], v[80:95]
ds_read_b128 v[44:47], v8 offset:512
ds_read_b128 v[48:51], v7 offset:640
s_waitcnt lgkmcnt(4)
v_mfma_f32_32x32x16_bf16 v[80:95], v[20:23], v[24:27], v[80:95]
ds_read_b128 v[20:23], v8 offset:544
ds_read_b128 v[24:27], v7 offset:672
s_waitcnt lgkmcnt(4)
v_mfma_f32_32x32x16_bf16 v[80:95], v[32:35], v[36:39], v[80:95]
ds_read_b128 v[32:35], v8 offset:448
ds_read_b128 v[36:39], v7 offset:560
s_waitcnt lgkmcnt(4)
v_mfma_f32_32x32x16_bf16 v[80:95], v[44:47], v[48:51], v[80:95]
ds_read_b128 v[44:47], v8 offset:480
ds_read_b128 v[48:51], v7 offset:592
s_waitcnt lgkmcnt(4)
v_mfma_f32_32x32x16_bf16 v[80:95], v[20:23], v[24:27], v[80:95]
ds_read_b128 v[20:23], v8 offset:384
ds_read_b128 v[24:27], v7 offset:480
s_waitcnt lgkmcnt(4)
v_mfma_f32_32x32x16_bf16 v[80:95], v[32:35], v[36:39], v[80:95]
ds_read_b128 v[32:35], v8 offset:416
ds_read_b128 v[36:39], v7 offset:512
s_waitcnt lgkmcnt(4)
v_mfma_f32_32x32x16_bf16 v[80:95], v[44:47], v[48:51], v[80:95]
ds_read_b128 v[44:47], v8 offset:320
ds_read_b128 v[48:51], v7 offset:400
s_waitcnt lgkmcnt(4)
v_mfma_f32_32x32x16_bf16 v[80:95], v[20:23], v[24:27], v[80:95]
ds_read_b128 v[20:23], v8 offset:352
ds_read_b128 v[24:27], v7 offset:432
s_waitcnt lgkmcnt(4)
v_mfma_f32_32x32x16_bf16 v[80:95], v[32:35], v[36:39], v[80:95]
ds_read_b128 v[32:35], v8 offset:256
ds_read_b128 v[36:39], v7 offset:320
s_waitcnt lgkmcnt(4)
v_mfma_f32_32x32x16_bf16 v[80:95], v[44:47], v[48:51], v[80:95]
ds_read_b128 v[44:47], v8 offset:288
ds_read_b128 v[48:51], v7 offset:352
s_waitcnt lgkmcnt(4)
v_mfma_f32_32x32x16_bf16 v[80:95], v[20:23], v[24:27], v[80:95]
ds_read_b128 v[20:23], v8 offset:192
ds_read_b128 v[24:27], v7 offset:240
s_waitcnt lgkmcnt(4)
v_mfma_f32_32x32x16_bf16 v[80:95], v[32:35], v[36:39], v[80:95]
ds_read_b128 v[32:35], v8 offset:224
ds_read_b128 v[36:39], v7 offset:272
s_waitcnt lgkmcnt(4)
v_mfma_f32_32x32x16_bf16 v[80:95], v[44:47], v[48:51], v[80:95]
ds_read_b128 v[44:47], v8 offset:128
ds_read_b128 v[48:51], v7 offset:160
s_waitcnt lgkmcnt(4)
v_mfma_f32_32x32x16_bf16 v[80:95], v[20:23], v[24:27], v[80:95]
ds_read_b128 v[20:23], v8 offset:160
ds_read_b128 v[24:27], v7 offset:192
s_waitcnt lgkmcnt(4)
v_mfma_f32_32x32x16_bf16 v[80:95], v[32:35], v[36:39], v[80:95]
ds_read_b128 v[32:35], v8 offset:64
ds_read_b128 v[36:39], v7 offset:80
s_waitcnt lgkmcnt(4)
v_mfma_f32_32x32x16_bf16 v[80:95], v[44:47], v[48:51], v[80:95]
ds_read_b128 v[44:47], v8 offset:96
ds_read_b128 v[48:51], v7 offset:112
s_waitcnt lgkmcnt(4)
v_mfma_f32_32x32x16_bf16 v[80:95], v[20:23], v[24:27], v[80:95]
ds_read_b128 v[20:23], v8 offset:0
ds_read_b128 v[24:27], v7 offset:0
s_waitcnt lgkmcnt(4)
v_mfma_f32_32x32x16_bf16 v[80:95], v[32:35], v[36:39], v[80:95]
ds_read_b128 v[32:35], v8 offset:32
ds_read_b128 v[36:39], v7 offset:32
s_waitcnt lgkmcnt(4)
v_mfma_f32_32x32x16_bf16 v[80:95], v[44:47], v[48:51], v[80:95]
s_waitcnt lgkmcnt(2)
v_mfma_f32_32x32x16_bf16 v[80:95], v[20:23], v[24:27], v[80:95]
s_waitcnt lgkmcnt(0)
v_mfma_f32_32x32x16_bf16 v[80:95], v[32:35], v[36:39], v[80:95]
s_nop 7
s_nop 7
s_mov_b32 s12, s26
s_and_b32 s13, s27, 0xffff
s_mov_b32 s14, 2048
s_mov_b32 s15, 0x20000
s_lshl_b32 s23, s21, 1
v_mov_b32 v2, s23
buffer_load_ushort v2, v2, s[12:15], 0 offen
s_lshl_b32 s23, s21, 12
s_add_u32 s23, s23, 10485760
v_lshlrev_b32 v10, 6, v5
v_lshl_add_u32 v10, v6, 3, v10
v_mul_u32_u24 v11, 80, v5
v_lshl_add_u32 v11, v6, 3, v11
v_add_u32 v11, s46, v11
s_waitcnt vmcnt(0)
v_lshlrev_b32 v2, 16, v2
ds_read_b64 v[12:13], v11 offset:35760
s_waitcnt lgkmcnt(0)
v_bfe_u32 v4, v64, 16, 1
v_add3_u32 v64, v64, v4, s60
v_and_b32 v64, 0xffff0000, v64
v_lshlrev_b32 v3, 16, v12
v_mul_f32 v3, v3, v2
v_bfe_u32 v4, v3, 16, 1
v_add3_u32 v3, v3, v4, s60
v_and_b32 v3, 0xffff0000, v3
v_add_f32 v64, v64, v3
v_bfe_u32 v4, v64, 16, 1
v_add3_u32 v64, v64, v4, s60
v_and_b32 v64, 0xffff0000, v64
v_bfe_u32 v4, v65, 16, 1
v_add3_u32 v65, v65, v4, s60
v_and_b32 v65, 0xffff0000, v65
v_and_b32 v3, 0xffff0000, v12
v_mul_f32 v3, v3, v2
v_bfe_u32 v4, v3, 16, 1
v_add3_u32 v3, v3, v4, s60
v_and_b32 v3, 0xffff0000, v3
v_add_f32 v65, v65, v3
v_bfe_u32 v4, v65, 16, 1
v_add3_u32 v65, v65, v4, s60
v_and_b32 v65, 0xffff0000, v65
v_bfe_u32 v4, v66, 16, 1
v_add3_u32 v66, v66, v4, s60
v_and_b32 v66, 0xffff0000, v66
v_lshlrev_b32 v3, 16, v13
v_mul_f32 v3, v3, v2
v_bfe_u32 v4, v3, 16, 1
v_add3_u32 v3, v3, v4, s60
v_and_b32 v3, 0xffff0000, v3
v_add_f32 v66, v66, v3
v_bfe_u32 v4, v66, 16, 1
v_add3_u32 v66, v66, v4, s60
v_and_b32 v66, 0xffff0000, v66
v_bfe_u32 v4, v67, 16, 1
v_add3_u32 v67, v67, v4, s60
v_and_b32 v67, 0xffff0000, v67
v_and_b32 v3, 0xffff0000, v13
v_mul_f32 v3, v3, v2
v_bfe_u32 v4, v3, 16, 1
v_add3_u32 v3, v3, v4, s60
v_and_b32 v3, 0xffff0000, v3
v_add_f32 v67, v67, v3
v_bfe_u32 v4, v67, 16, 1
v_add3_u32 v67, v67, v4, s60
v_and_b32 v67, 0xffff0000, v67
v_lshrrev_b32 v14, 16, v64
v_or_b32 v14, v65, v14
v_lshrrev_b32 v15, 16, v66
v_or_b32 v15, v67, v15
buffer_store_dwordx2 v[14:15], v10, s[16:19], s23 offen offset:0
s_nop 1
ds_read_b64 v[12:13], v11 offset:35776
s_waitcnt lgkmcnt(0)
v_bfe_u32 v4, v68, 16, 1
v_add3_u32 v68, v68, v4, s60
v_and_b32 v68, 0xffff0000, v68
v_lshlrev_b32 v3, 16, v12
v_mul_f32 v3, v3, v2
v_bfe_u32 v4, v3, 16, 1
v_add3_u32 v3, v3, v4, s60
v_and_b32 v3, 0xffff0000, v3
v_add_f32 v68, v68, v3
v_bfe_u32 v4, v68, 16, 1
v_add3_u32 v68, v68, v4, s60
v_and_b32 v68, 0xffff0000, v68
v_bfe_u32 v4, v69, 16, 1
v_add3_u32 v69, v69, v4, s60
v_and_b32 v69, 0xffff0000, v69
v_and_b32 v3, 0xffff0000, v12
v_mul_f32 v3, v3, v2
v_bfe_u32 v4, v3, 16, 1
v_add3_u32 v3, v3, v4, s60
v_and_b32 v3, 0xffff0000, v3
v_add_f32 v69, v69, v3
v_bfe_u32 v4, v69, 16, 1
v_add3_u32 v69, v69, v4, s60
v_and_b32 v69, 0xffff0000, v69
v_bfe_u32 v4, v70, 16, 1
v_add3_u32 v70, v70, v4, s60
v_and_b32 v70, 0xffff0000, v70
v_lshlrev_b32 v3, 16, v13
v_mul_f32 v3, v3, v2
v_bfe_u32 v4, v3, 16, 1
v_add3_u32 v3, v3, v4, s60
v_and_b32 v3, 0xffff0000, v3
v_add_f32 v70, v70, v3
v_bfe_u32 v4, v70, 16, 1
v_add3_u32 v70, v70, v4, s60
v_and_b32 v70, 0xffff0000, v70
v_bfe_u32 v4, v71, 16, 1
v_add3_u32 v71, v71, v4, s60
v_and_b32 v71, 0xffff0000, v71
v_and_b32 v3, 0xffff0000, v13
v_mul_f32 v3, v3, v2
v_bfe_u32 v4, v3, 16, 1
v_add3_u32 v3, v3, v4, s60
v_and_b32 v3, 0xffff0000, v3
v_add_f32 v71, v71, v3
v_bfe_u32 v4, v71, 16, 1
v_add3_u32 v71, v71, v4, s60
v_and_b32 v71, 0xffff0000, v71
v_lshrrev_b32 v14, 16, v68
v_or_b32 v14, v69, v14
v_lshrrev_b32 v15, 16, v70
v_or_b32 v15, v71, v15
buffer_store_dwordx2 v[14:15], v10, s[16:19], s23 offen offset:16
s_nop 1
ds_read_b64 v[12:13], v11 offset:35792
s_waitcnt lgkmcnt(0)
v_bfe_u32 v4, v72, 16, 1
v_add3_u32 v72, v72, v4, s60
v_and_b32 v72, 0xffff0000, v72
v_lshlrev_b32 v3, 16, v12
v_mul_f32 v3, v3, v2
v_bfe_u32 v4, v3, 16, 1
v_add3_u32 v3, v3, v4, s60
v_and_b32 v3, 0xffff0000, v3
v_add_f32 v72, v72, v3
v_bfe_u32 v4, v72, 16, 1
v_add3_u32 v72, v72, v4, s60
v_and_b32 v72, 0xffff0000, v72
v_bfe_u32 v4, v73, 16, 1
v_add3_u32 v73, v73, v4, s60
v_and_b32 v73, 0xffff0000, v73
v_and_b32 v3, 0xffff0000, v12
v_mul_f32 v3, v3, v2
v_bfe_u32 v4, v3, 16, 1
v_add3_u32 v3, v3, v4, s60
v_and_b32 v3, 0xffff0000, v3
v_add_f32 v73, v73, v3
v_bfe_u32 v4, v73, 16, 1
v_add3_u32 v73, v73, v4, s60
v_and_b32 v73, 0xffff0000, v73
v_bfe_u32 v4, v74, 16, 1
v_add3_u32 v74, v74, v4, s60
v_and_b32 v74, 0xffff0000, v74
v_lshlrev_b32 v3, 16, v13
v_mul_f32 v3, v3, v2
v_bfe_u32 v4, v3, 16, 1
v_add3_u32 v3, v3, v4, s60
v_and_b32 v3, 0xffff0000, v3
v_add_f32 v74, v74, v3
v_bfe_u32 v4, v74, 16, 1
v_add3_u32 v74, v74, v4, s60
v_and_b32 v74, 0xffff0000, v74
v_bfe_u32 v4, v75, 16, 1
v_add3_u32 v75, v75, v4, s60
v_and_b32 v75, 0xffff0000, v75
v_and_b32 v3, 0xffff0000, v13
v_mul_f32 v3, v3, v2
v_bfe_u32 v4, v3, 16, 1
v_add3_u32 v3, v3, v4, s60
v_and_b32 v3, 0xffff0000, v3
v_add_f32 v75, v75, v3
v_bfe_u32 v4, v75, 16, 1
v_add3_u32 v75, v75, v4, s60
v_and_b32 v75, 0xffff0000, v75
v_lshrrev_b32 v14, 16, v72
v_or_b32 v14, v73, v14
v_lshrrev_b32 v15, 16, v74
v_or_b32 v15, v75, v15
buffer_store_dwordx2 v[14:15], v10, s[16:19], s23 offen offset:32
s_nop 1
ds_read_b64 v[12:13], v11 offset:35808
s_waitcnt lgkmcnt(0)
v_bfe_u32 v4, v76, 16, 1
v_add3_u32 v76, v76, v4, s60
v_and_b32 v76, 0xffff0000, v76
v_lshlrev_b32 v3, 16, v12
v_mul_f32 v3, v3, v2
v_bfe_u32 v4, v3, 16, 1
v_add3_u32 v3, v3, v4, s60
v_and_b32 v3, 0xffff0000, v3
v_add_f32 v76, v76, v3
v_bfe_u32 v4, v76, 16, 1
v_add3_u32 v76, v76, v4, s60
v_and_b32 v76, 0xffff0000, v76
v_bfe_u32 v4, v77, 16, 1
v_add3_u32 v77, v77, v4, s60
v_and_b32 v77, 0xffff0000, v77
v_and_b32 v3, 0xffff0000, v12
v_mul_f32 v3, v3, v2
v_bfe_u32 v4, v3, 16, 1
v_add3_u32 v3, v3, v4, s60
v_and_b32 v3, 0xffff0000, v3
v_add_f32 v77, v77, v3
v_bfe_u32 v4, v77, 16, 1
v_add3_u32 v77, v77, v4, s60
v_and_b32 v77, 0xffff0000, v77
v_bfe_u32 v4, v78, 16, 1
v_add3_u32 v78, v78, v4, s60
v_and_b32 v78, 0xffff0000, v78
v_lshlrev_b32 v3, 16, v13
v_mul_f32 v3, v3, v2
v_bfe_u32 v4, v3, 16, 1
v_add3_u32 v3, v3, v4, s60
v_and_b32 v3, 0xffff0000, v3
v_add_f32 v78, v78, v3
v_bfe_u32 v4, v78, 16, 1
v_add3_u32 v78, v78, v4, s60
v_and_b32 v78, 0xffff0000, v78
v_bfe_u32 v4, v79, 16, 1
v_add3_u32 v79, v79, v4, s60
v_and_b32 v79, 0xffff0000, v79
v_and_b32 v3, 0xffff0000, v13
v_mul_f32 v3, v3, v2
v_bfe_u32 v4, v3, 16, 1
v_add3_u32 v3, v3, v4, s60
v_and_b32 v3, 0xffff0000, v3
v_add_f32 v79, v79, v3
v_bfe_u32 v4, v79, 16, 1
v_add3_u32 v79, v79, v4, s60
v_and_b32 v79, 0xffff0000, v79
v_lshrrev_b32 v14, 16, v76
v_or_b32 v14, v77, v14
v_lshrrev_b32 v15, 16, v78
v_or_b32 v15, v79, v15
buffer_store_dwordx2 v[14:15], v10, s[16:19], s23 offen offset:48
s_nop 1
ds_read_b64 v[12:13], v11 offset:38320
s_waitcnt lgkmcnt(0)
v_bfe_u32 v4, v80, 16, 1
v_add3_u32 v80, v80, v4, s60
v_and_b32 v80, 0xffff0000, v80
v_lshlrev_b32 v3, 16, v12
v_mul_f32 v3, v3, v2
v_bfe_u32 v4, v3, 16, 1
v_add3_u32 v3, v3, v4, s60
v_and_b32 v3, 0xffff0000, v3
v_add_f32 v80, v80, v3
v_bfe_u32 v4, v80, 16, 1
v_add3_u32 v80, v80, v4, s60
v_and_b32 v80, 0xffff0000, v80
v_bfe_u32 v4, v81, 16, 1
v_add3_u32 v81, v81, v4, s60
v_and_b32 v81, 0xffff0000, v81
v_and_b32 v3, 0xffff0000, v12
v_mul_f32 v3, v3, v2
v_bfe_u32 v4, v3, 16, 1
v_add3_u32 v3, v3, v4, s60
v_and_b32 v3, 0xffff0000, v3
v_add_f32 v81, v81, v3
v_bfe_u32 v4, v81, 16, 1
v_add3_u32 v81, v81, v4, s60
v_and_b32 v81, 0xffff0000, v81
v_bfe_u32 v4, v82, 16, 1
v_add3_u32 v82, v82, v4, s60
v_and_b32 v82, 0xffff0000, v82
v_lshlrev_b32 v3, 16, v13
v_mul_f32 v3, v3, v2
v_bfe_u32 v4, v3, 16, 1
v_add3_u32 v3, v3, v4, s60
v_and_b32 v3, 0xffff0000, v3
v_add_f32 v82, v82, v3
v_bfe_u32 v4, v82, 16, 1
v_add3_u32 v82, v82, v4, s60
v_and_b32 v82, 0xffff0000, v82
v_bfe_u32 v4, v83, 16, 1
v_add3_u32 v83, v83, v4, s60
v_and_b32 v83, 0xffff0000, v83
v_and_b32 v3, 0xffff0000, v13
v_mul_f32 v3, v3, v2
v_bfe_u32 v4, v3, 16, 1
v_add3_u32 v3, v3, v4, s60
v_and_b32 v3, 0xffff0000, v3
v_add_f32 v83, v83, v3
v_bfe_u32 v4, v83, 16, 1
v_add3_u32 v83, v83, v4, s60
v_and_b32 v83, 0xffff0000, v83
v_lshrrev_b32 v14, 16, v80
v_or_b32 v14, v81, v14
v_lshrrev_b32 v15, 16, v82
v_or_b32 v15, v83, v15
buffer_store_dwordx2 v[14:15], v10, s[16:19], s23 offen offset:2048
s_nop 1
ds_read_b64 v[12:13], v11 offset:38336
s_waitcnt lgkmcnt(0)
v_bfe_u32 v4, v84, 16, 1
v_add3_u32 v84, v84, v4, s60
v_and_b32 v84, 0xffff0000, v84
v_lshlrev_b32 v3, 16, v12
v_mul_f32 v3, v3, v2
v_bfe_u32 v4, v3, 16, 1
v_add3_u32 v3, v3, v4, s60
v_and_b32 v3, 0xffff0000, v3
v_add_f32 v84, v84, v3
v_bfe_u32 v4, v84, 16, 1
v_add3_u32 v84, v84, v4, s60
v_and_b32 v84, 0xffff0000, v84
v_bfe_u32 v4, v85, 16, 1
v_add3_u32 v85, v85, v4, s60
v_and_b32 v85, 0xffff0000, v85
v_and_b32 v3, 0xffff0000, v12
v_mul_f32 v3, v3, v2
v_bfe_u32 v4, v3, 16, 1
v_add3_u32 v3, v3, v4, s60
v_and_b32 v3, 0xffff0000, v3
v_add_f32 v85, v85, v3
v_bfe_u32 v4, v85, 16, 1
v_add3_u32 v85, v85, v4, s60
v_and_b32 v85, 0xffff0000, v85
v_bfe_u32 v4, v86, 16, 1
v_add3_u32 v86, v86, v4, s60
v_and_b32 v86, 0xffff0000, v86
v_lshlrev_b32 v3, 16, v13
v_mul_f32 v3, v3, v2
v_bfe_u32 v4, v3, 16, 1
v_add3_u32 v3, v3, v4, s60
v_and_b32 v3, 0xffff0000, v3
v_add_f32 v86, v86, v3
v_bfe_u32 v4, v86, 16, 1
v_add3_u32 v86, v86, v4, s60
v_and_b32 v86, 0xffff0000, v86
v_bfe_u32 v4, v87, 16, 1
v_add3_u32 v87, v87, v4, s60
v_and_b32 v87, 0xffff0000, v87
v_and_b32 v3, 0xffff0000, v13
v_mul_f32 v3, v3, v2
v_bfe_u32 v4, v3, 16, 1
v_add3_u32 v3, v3, v4, s60
v_and_b32 v3, 0xffff0000, v3
v_add_f32 v87, v87, v3
v_bfe_u32 v4, v87, 16, 1
v_add3_u32 v87, v87, v4, s60
v_and_b32 v87, 0xffff0000, v87
v_lshrrev_b32 v14, 16, v84
v_or_b32 v14, v85, v14
v_lshrrev_b32 v15, 16, v86
v_or_b32 v15, v87, v15
buffer_store_dwordx2 v[14:15], v10, s[16:19], s23 offen offset:2064
s_nop 1
ds_read_b64 v[12:13], v11 offset:38352
s_waitcnt lgkmcnt(0)
v_bfe_u32 v4, v88, 16, 1
v_add3_u32 v88, v88, v4, s60
v_and_b32 v88, 0xffff0000, v88
v_lshlrev_b32 v3, 16, v12
v_mul_f32 v3, v3, v2
v_bfe_u32 v4, v3, 16, 1
v_add3_u32 v3, v3, v4, s60
v_and_b32 v3, 0xffff0000, v3
v_add_f32 v88, v88, v3
v_bfe_u32 v4, v88, 16, 1
v_add3_u32 v88, v88, v4, s60
v_and_b32 v88, 0xffff0000, v88
v_bfe_u32 v4, v89, 16, 1
v_add3_u32 v89, v89, v4, s60
v_and_b32 v89, 0xffff0000, v89
v_and_b32 v3, 0xffff0000, v12
v_mul_f32 v3, v3, v2
v_bfe_u32 v4, v3, 16, 1
v_add3_u32 v3, v3, v4, s60
v_and_b32 v3, 0xffff0000, v3
v_add_f32 v89, v89, v3
v_bfe_u32 v4, v89, 16, 1
v_add3_u32 v89, v89, v4, s60
v_and_b32 v89, 0xffff0000, v89
v_bfe_u32 v4, v90, 16, 1
v_add3_u32 v90, v90, v4, s60
v_and_b32 v90, 0xffff0000, v90
v_lshlrev_b32 v3, 16, v13
v_mul_f32 v3, v3, v2
v_bfe_u32 v4, v3, 16, 1
v_add3_u32 v3, v3, v4, s60
v_and_b32 v3, 0xffff0000, v3
v_add_f32 v90, v90, v3
v_bfe_u32 v4, v90, 16, 1
v_add3_u32 v90, v90, v4, s60
v_and_b32 v90, 0xffff0000, v90
v_bfe_u32 v4, v91, 16, 1
v_add3_u32 v91, v91, v4, s60
v_and_b32 v91, 0xffff0000, v91
v_and_b32 v3, 0xffff0000, v13
v_mul_f32 v3, v3, v2
v_bfe_u32 v4, v3, 16, 1
v_add3_u32 v3, v3, v4, s60
v_and_b32 v3, 0xffff0000, v3
v_add_f32 v91, v91, v3
v_bfe_u32 v4, v91, 16, 1
v_add3_u32 v91, v91, v4, s60
v_and_b32 v91, 0xffff0000, v91
v_lshrrev_b32 v14, 16, v88
v_or_b32 v14, v89, v14
v_lshrrev_b32 v15, 16, v90
v_or_b32 v15, v91, v15
buffer_store_dwordx2 v[14:15], v10, s[16:19], s23 offen offset:2080
s_nop 1
ds_read_b64 v[12:13], v11 offset:38368
s_waitcnt lgkmcnt(0)
v_bfe_u32 v4, v92, 16, 1
v_add3_u32 v92, v92, v4, s60
v_and_b32 v92, 0xffff0000, v92
v_lshlrev_b32 v3, 16, v12
v_mul_f32 v3, v3, v2
v_bfe_u32 v4, v3, 16, 1
v_add3_u32 v3, v3, v4, s60
v_and_b32 v3, 0xffff0000, v3
v_add_f32 v92, v92, v3
v_bfe_u32 v4, v92, 16, 1
v_add3_u32 v92, v92, v4, s60
v_and_b32 v92, 0xffff0000, v92
v_bfe_u32 v4, v93, 16, 1
v_add3_u32 v93, v93, v4, s60
v_and_b32 v93, 0xffff0000, v93
v_and_b32 v3, 0xffff0000, v12
v_mul_f32 v3, v3, v2
v_bfe_u32 v4, v3, 16, 1
v_add3_u32 v3, v3, v4, s60
v_and_b32 v3, 0xffff0000, v3
v_add_f32 v93, v93, v3
v_bfe_u32 v4, v93, 16, 1
v_add3_u32 v93, v93, v4, s60
v_and_b32 v93, 0xffff0000, v93
v_bfe_u32 v4, v94, 16, 1
v_add3_u32 v94, v94, v4, s60
v_and_b32 v94, 0xffff0000, v94
v_lshlrev_b32 v3, 16, v13
v_mul_f32 v3, v3, v2
v_bfe_u32 v4, v3, 16, 1
v_add3_u32 v3, v3, v4, s60
v_and_b32 v3, 0xffff0000, v3
v_add_f32 v94, v94, v3
v_bfe_u32 v4, v94, 16, 1
v_add3_u32 v94, v94, v4, s60
v_and_b32 v94, 0xffff0000, v94
v_bfe_u32 v4, v95, 16, 1
v_add3_u32 v95, v95, v4, s60
v_and_b32 v95, 0xffff0000, v95
v_and_b32 v3, 0xffff0000, v13
v_mul_f32 v3, v3, v2
v_bfe_u32 v4, v3, 16, 1
v_add3_u32 v3, v3, v4, s60
v_and_b32 v3, 0xffff0000, v3
v_add_f32 v95, v95, v3
v_bfe_u32 v4, v95, 16, 1
v_add3_u32 v95, v95, v4, s60
v_and_b32 v95, 0xffff0000, v95
v_lshrrev_b32 v14, 16, v92
v_or_b32 v14, v93, v14
v_lshrrev_b32 v15, 16, v94
v_or_b32 v15, v95, v15
buffer_store_dwordx2 v[14:15], v10, s[16:19], s23 offen offset:2096
s_nop 1
s_cmp_ge_u32 s2, 32
s_cbranch_scc1 K2_END
s_mov_b32 s21, s2
s_mul_i32 s22, s21, 4224
s_add_u32 s22, s22, 4194304
s_lshl_b32 s23, s21, 12
s_add_u32 s23, s23, 14680064
v_add_u32 v3, 0, v0
v_lshl_add_u32 v4, v3, 2, s22
s_mov_b32 s30, 0
buffer_load_dword v20, v4, s[16:19], s30 offen
s_mov_b32 s30, 135168
buffer_load_dword v21, v4, s[16:19], s30 offen
s_mov_b32 s30, 270336
buffer_load_dword v22, v4, s[16:19], s30 offen
s_mov_b32 s30, 405504
buffer_load_dword v23, v4, s[16:19], s30 offen
s_mov_b32 s30, 540672
buffer_load_dword v24, v4, s[16:19], s30 offen
s_mov_b32 s30, 675840
buffer_load_dword v25, v4, s[16:19], s30 offen
s_mov_b32 s30, 811008
buffer_load_dword v26, v4, s[16:19], s30 offen
s_mov_b32 s30, 946176
buffer_load_dword v27, v4, s[16:19], s30 offen
s_waitcnt vmcnt(0)
v_add_f32 v20, v20, v21
v_add_f32 v20, v20, v22
v_add_f32 v20, v20, v23
v_add_f32 v20, v20, v24
v_add_f32 v20, v20, v25
v_add_f32 v20, v20, v26
v_add_f32 v20, v20, v27
v_bfe_u32 v5, v20, 16, 1
v_add3_u32 v20, v20, v5, s60
v_and_b32 v20, 0xffff0000, v20
v_lshrrev_b32 v5, 5, v3
v_and_b32 v6, 31, v3
v_lshl_add_u32 v5, v6, 5, v5
v_lshl_add_u32 v5, v5, 1, s23
buffer_store_short_d16_hi v20, v5, s[16:19], 0 offen
v_add_u32 v3, 256, v0
v_lshl_add_u32 v4, v3, 2, s22
s_mov_b32 s30, 0
buffer_load_dword v20, v4, s[16:19], s30 offen
s_mov_b32 s30, 135168
buffer_load_dword v21, v4, s[16:19], s30 offen
s_mov_b32 s30, 270336
buffer_load_dword v22, v4, s[16:19], s30 offen
s_mov_b32 s30, 405504
buffer_load_dword v23, v4, s[16:19], s30 offen
s_mov_b32 s30, 540672
buffer_load_dword v24, v4, s[16:19], s30 offen
s_mov_b32 s30, 675840
buffer_load_dword v25, v4, s[16:19], s30 offen
s_mov_b32 s30, 811008
buffer_load_dword v26, v4, s[16:19], s30 offen
s_mov_b32 s30, 946176
buffer_load_dword v27, v4, s[16:19], s30 offen
s_waitcnt vmcnt(0)
v_add_f32 v20, v20, v21
v_add_f32 v20, v20, v22
v_add_f32 v20, v20, v23
v_add_f32 v20, v20, v24
v_add_f32 v20, v20, v25
v_add_f32 v20, v20, v26
v_add_f32 v20, v20, v27
v_bfe_u32 v5, v20, 16, 1
v_add3_u32 v20, v20, v5, s60
v_and_b32 v20, 0xffff0000, v20
v_lshrrev_b32 v5, 5, v3
v_and_b32 v6, 31, v3
v_lshl_add_u32 v5, v6, 5, v5
v_lshl_add_u32 v5, v5, 1, s23
buffer_store_short_d16_hi v20, v5, s[16:19], 0 offen
v_add_u32 v3, 512, v0
v_lshl_add_u32 v4, v3, 2, s22
s_mov_b32 s30, 0
buffer_load_dword v20, v4, s[16:19], s30 offen
s_mov_b32 s30, 135168
buffer_load_dword v21, v4, s[16:19], s30 offen
s_mov_b32 s30, 270336
buffer_load_dword v22, v4, s[16:19], s30 offen
s_mov_b32 s30, 405504
buffer_load_dword v23, v4, s[16:19], s30 offen
s_mov_b32 s30, 540672
buffer_load_dword v24, v4, s[16:19], s30 offen
s_mov_b32 s30, 675840
buffer_load_dword v25, v4, s[16:19], s30 offen
s_mov_b32 s30, 811008
buffer_load_dword v26, v4, s[16:19], s30 offen
s_mov_b32 s30, 946176
buffer_load_dword v27, v4, s[16:19], s30 offen
s_waitcnt vmcnt(0)
v_add_f32 v20, v20, v21
v_add_f32 v20, v20, v22
v_add_f32 v20, v20, v23
v_add_f32 v20, v20, v24
v_add_f32 v20, v20, v25
v_add_f32 v20, v20, v26
v_add_f32 v20, v20, v27
v_bfe_u32 v5, v20, 16, 1
v_add3_u32 v20, v20, v5, s60
v_and_b32 v20, 0xffff0000, v20
v_lshrrev_b32 v5, 5, v3
v_and_b32 v6, 31, v3
v_lshl_add_u32 v5, v6, 5, v5
v_lshl_add_u32 v5, v5, 1, s23
buffer_store_short_d16_hi v20, v5, s[16:19], 0 offen
v_add_u32 v3, 768, v0
v_lshl_add_u32 v4, v3, 2, s22
s_mov_b32 s30, 0
buffer_load_dword v20, v4, s[16:19], s30 offen
s_mov_b32 s30, 135168
buffer_load_dword v21, v4, s[16:19], s30 offen
s_mov_b32 s30, 270336
buffer_load_dword v22, v4, s[16:19], s30 offen
s_mov_b32 s30, 405504
buffer_load_dword v23, v4, s[16:19], s30 offen
s_mov_b32 s30, 540672
buffer_load_dword v24, v4, s[16:19], s30 offen
s_mov_b32 s30, 675840
buffer_load_dword v25, v4, s[16:19], s30 offen
s_mov_b32 s30, 811008
buffer_load_dword v26, v4, s[16:19], s30 offen
s_mov_b32 s30, 946176
buffer_load_dword v27, v4, s[16:19], s30 offen
s_waitcnt vmcnt(0)
v_add_f32 v20, v20, v21
v_add_f32 v20, v20, v22
v_add_f32 v20, v20, v23
v_add_f32 v20, v20, v24
v_add_f32 v20, v20, v25
v_add_f32 v20, v20, v26
v_add_f32 v20, v20, v27
v_bfe_u32 v5, v20, 16, 1
v_add3_u32 v20, v20, v5, s60
v_and_b32 v20, 0xffff0000, v20
v_lshrrev_b32 v5, 5, v3
v_and_b32 v6, 31, v3
v_lshl_add_u32 v5, v6, 5, v5
v_lshl_add_u32 v5, v5, 1, s23
buffer_store_short_d16_hi v20, v5, s[16:19], 0 offen
v_add_u32 v3, 1024, v0
v_and_b32 v3, 31, v0
v_add_u32 v3, 1024, v3
v_lshl_add_u32 v4, v3, 2, s22
s_mov_b32 s30, 0
buffer_load_dword v20, v4, s[16:19], s30 offen
s_mov_b32 s30, 135168
buffer_load_dword v21, v4, s[16:19], s30 offen
s_mov_b32 s30, 270336
buffer_load_dword v22, v4, s[16:19], s30 offen
s_mov_b32 s30, 405504
buffer_load_dword v23, v4, s[16:19], s30 offen
s_mov_b32 s30, 540672
buffer_load_dword v24, v4, s[16:19], s30 offen
s_mov_b32 s30, 675840
buffer_load_dword v25, v4, s[16:19], s30 offen
s_mov_b32 s30, 811008
buffer_load_dword v26, v4, s[16:19], s30 offen
s_mov_b32 s30, 946176
buffer_load_dword v27, v4, s[16:19], s30 offen
s_waitcnt vmcnt(0)
v_add_f32 v20, v20, v21
v_add_f32 v20, v20, v22
v_add_f32 v20, v20, v23
v_add_f32 v20, v20, v24
v_add_f32 v20, v20, v25
v_add_f32 v20, v20, v26
v_add_f32 v20, v20, v27
v_bfe_u32 v5, v20, 16, 1
v_add3_u32 v20, v20, v5, s60
v_and_b32 v20, 0xffff0000, v20
v_lshrrev_b32 v5, 5, v0
v_add_u32 v5, 0, v5
v_and_b32 v6, 27, v5
v_cmp_eq_u32 vcc, 0, v6
s_nop 1
v_cndmask_b32 v7, 0, v20, vcc
v_add_u32 v6, 0, v0
v_lshl_add_u32 v6, v6, 1, s23
buffer_store_short_d16_hi v7, v6, s[16:19], 0 offen offset:2048
v_lshrrev_b32 v5, 5, v0
v_add_u32 v5, 8, v5
v_and_b32 v6, 27, v5
v_cmp_eq_u32 vcc, 0, v6
s_nop 1
v_cndmask_b32 v7, 0, v20, vcc
v_add_u32 v6, 256, v0
v_lshl_add_u32 v6, v6, 1, s23
buffer_store_short_d16_hi v7, v6, s[16:19], 0 offen offset:2048
v_lshrrev_b32 v5, 5, v0
v_add_u32 v5, 16, v5
v_and_b32 v6, 27, v5
v_cmp_eq_u32 vcc, 0, v6
s_nop 1
v_cndmask_b32 v7, 0, v20, vcc
v_add_u32 v6, 512, v0
v_lshl_add_u32 v6, v6, 1, s23
buffer_store_short_d16_hi v7, v6, s[16:19], 0 offen offset:2048
v_lshrrev_b32 v5, 5, v0
v_add_u32 v5, 24, v5
v_and_b32 v6, 27, v5
v_cmp_eq_u32 vcc, 0, v6
s_nop 1
v_cndmask_b32 v7, 0, v20, vcc
v_add_u32 v6, 768, v0
v_lshl_add_u32 v6, v6, 1, s23
buffer_store_short_d16_hi v7, v6, s[16:19], 0 offen offset:2048
K2_END:
s_endpgm
.globl k3_kernel
.p2align 8
.type k3_kernel,@function
k3_kernel:
s_cmp_ge_u32 s2, 256
s_cbranch_scc1 K3_END
s_load_dwordx2 s[24:25], s[0:1], 88
s_load_dwordx2 s[26:27], s[0:1], 104
s_load_dwordx2 s[42:43], s[0:1], 120
s_mov_b32 s60, 0x7fff
s_mov_b32 s61, 0x358637bd
v_and_b32 v1, 63, v0
v_lshrrev_b32 v2, 6, v0
s_nop 0
v_readfirstlane_b32 s20, v2
s_waitcnt lgkmcnt(0)
s_mov_b32 s16, s42
s_and_b32 s17, s43, 0xffff
s_mov_b32 s18, 20971520
s_mov_b32 s19, 0x20000
s_mov_b32 s8, s24
s_and_b32 s9, s25, 0xffff
s_mov_b32 s10, 2097152
s_mov_b32 s11, 0x20000
s_mov_b32 s12, s26
s_and_b32 s13, s27, 0xffff
s_mov_b32 s14, 4194304
s_mov_b32 s15, 0x20000
s_and_b32 s21, s2, 15
s_lshr_b32 s22, s2, 4
s_lshl_b32 s23, s20, 6
v_add_u32 v3, s23, v1
v_lshrrev_b32 v4, 3, v3
v_and_b32 v5, 7, v3
v_lshlrev_b32 v4, 11, v4
v_lshl_add_u32 v8, v5, 4, v4
s_lshl_b32 s23, s21, 7
v_add_u32 v8, s23, v8
v_and_b32 v5, 31, v1
v_lshrrev_b32 v6, 5, v1
v_lshlrev_b32 v10, 6, v5
v_lshl_add_u32 v10, v6, 4, v10
v_add_u32 v10, 14680064, v10
s_lshl_b32 s23, s22, 7
s_lshl_b32 s30, s20, 5
s_add_u32 s23, s23, s30
v_add_u32 v11, s23, v5
v_lshlrev_b32 v11, 6, v11
v_lshl_add_u32 v11, v6, 4, v11
v_lshlrev_b32 v3, 2, v6
v_bfe_u32 v4, v1, 2, 2
v_add_u32 v3, v3, v4
v_bfe_u32 v4, v1, 4, 1
v_lshlrev_b32 v4, 5, v4
v_and_b32 v7, 3, v1
v_lshl_add_u32 v4, v7, 3, v4
v_lshl_add_u32 v12, v3, 7, v4
v_mov_b32 v128, 0
v_mov_b32 v129, 0
v_mov_b32 v130, 0
v_mov_b32 v131, 0
v_mov_b32 v132, 0
v_mov_b32 v133, 0
v_mov_b32 v134, 0
v_mov_b32 v135, 0
v_mov_b32 v136, 0
v_mov_b32 v137, 0
v_mov_b32 v138, 0
v_mov_b32 v139, 0
v_mov_b32 v140, 0
v_mov_b32 v141, 0
v_mov_b32 v142, 0
v_mov_b32 v143, 0
v_mov_b32 v144, 0
v_mov_b32 v145, 0
v_mov_b32 v146, 0
v_mov_b32 v147, 0
v_mov_b32 v148, 0
v_mov_b32 v149, 0
v_mov_b32 v150, 0
v_mov_b32 v151, 0
v_mov_b32 v152, 0
v_mov_b32 v153, 0
v_mov_b32 v154, 0
v_mov_b32 v155, 0
v_mov_b32 v156, 0
v_mov_b32 v157, 0
v_mov_b32 v158, 0
v_mov_b32 v159, 0
s_mov_b32 s51, 0
s_mov_b32 s52, 0
s_lshl_b32 s32, s52, 12
s_lshl_b32 s33, s52, 17
s_lshl_b32 s31, s52, 16
s_lshl_b32 s30, s20, 10
s_add_u32 m0, s30, s51
s_nop 0
buffer_load_dwordx4 v8, s[8:11], s31 offen lds
buffer_load_dwordx4 v[20:23], v10, s[16:19], s32 offen offset:0
buffer_load_dwordx4 v[28:31], v10, s[16:19], s32 offen offset:2048
buffer_load_dwordx4 v[36:39], v11, s[16:19], s33 offen offset:0
buffer_load_dwordx4 v[24:27], v10, s[16:19], s32 offen offset:32
buffer_load_dwordx4 v[32:35], v10, s[16:19], s32 offen offset:2080
buffer_load_dwordx4 v[40:43], v11, s[16:19], s33 offen offset:32
s_mov_b32 s51, 4096
s_mov_b32 s53, 1
s_lshl_b32 s32, s53, 12
s_lshl_b32 s33, s53, 17
s_lshl_b32 s31, s53, 16
s_lshl_b32 s30, s20, 10
s_add_u32 m0, s30, s51
s_nop 0
buffer_load_dwordx4 v8, s[8:11], s31 offen lds
buffer_load_dwordx4 v[160:163], v10, s[16:19], s32 offen offset:0
buffer_load_dwordx4 v[168:171], v10, s[16:19], s32 offen offset:2048
buffer_load_dwordx4 v[176:179], v11, s[16:19], s33 offen offset:0
buffer_load_dwordx4 v[164:167], v10, s[16:19], s32 offen offset:32
buffer_load_dwordx4 v[172:175], v10, s[16:19], s32 offen offset:2080
buffer_load_dwordx4 v[180:183], v11, s[16:19], s33 offen offset:32
s_mov_b32 s50, 0
K3_LOOP:
v_mov_b32 v64, 0
v_mov_b32 v65, 0
v_mov_b32 v66, 0
v_mov_b32 v67, 0
v_mov_b32 v68, 0
v_mov_b32 v69, 0
v_mov_b32 v70, 0
v_mov_b32 v71, 0
v_mov_b32 v72, 0
v_mov_b32 v73, 0
v_mov_b32 v74, 0
v_mov_b32 v75, 0
v_mov_b32 v76, 0
v_mov_b32 v77, 0
v_mov_b32 v78, 0
v_mov_b32 v79, 0
v_mov_b32 v80, 0
v_mov_b32 v81, 0
v_mov_b32 v82, 0
v_mov_b32 v83, 0
v_mov_b32 v84, 0
v_mov_b32 v85, 0
v_mov_b32 v86, 0
v_mov_b32 v87, 0
v_mov_b32 v88, 0
v_mov_b32 v89, 0
v_mov_b32 v90, 0
v_mov_b32 v91, 0
v_mov_b32 v92, 0
v_mov_b32 v93, 0
v_mov_b32 v94, 0
v_mov_b32 v95, 0
s_waitcnt vmcnt(7)
v_mfma_f32_32x32x16_bf16 v[64:79], v[20:23], v[36:39], v[64:79]
v_mfma_f32_32x32x16_bf16 v[80:95], v[28:31], v[36:39], v[80:95]
v_mfma_f32_32x32x16_bf16 v[64:79], v[24:27], v[40:43], v[64:79]
v_mfma_f32_32x32x16_bf16 v[80:95], v[32:35], v[40:43], v[80:95]
s_barrier
s_add_u32 s51, s51, 4096
s_cmp_eq_u32 s51, 12288
s_cselect_b32 s51, 0, s51
s_add_u32 s53, s52, 2
s_min_u32 s53, s53, 31
s_lshl_b32 s32, s53, 12
s_lshl_b32 s33, s53, 17
s_lshl_b32 s31, s53, 16
s_lshl_b32 s30, s20, 10
s_add_u32 m0, s30, s51
s_nop 0
buffer_load_dwordx4 v8, s[8:11], s31 offen lds
buffer_load_dwordx4 v[20:23], v10, s[16:19], s32 offen offset:0
buffer_load_dwordx4 v[28:31], v10, s[16:19], s32 offen offset:2048
buffer_load_dwordx4 v[36:39], v11, s[16:19], s33 offen offset:0
buffer_load_dwordx4 v[24:27], v10, s[16:19], s32 offen offset:32
buffer_load_dwordx4 v[32:35], v10, s[16:19], s32 offen offset:2080
buffer_load_dwordx4 v[40:43], v11, s[16:19], s33 offen offset:32
v_add_u32 v13, s50, v12
ds_read_b64_tr_b16 v[104:105], v13 offset:0
ds_read_b64_tr_b16 v[106:107], v13 offset:1024
ds_read_b64_tr_b16 v[108:109], v13 offset:64
ds_read_b64_tr_b16 v[110:111], v13 offset:1088
ds_read_b64_tr_b16 v[112:113], v13 offset:2048
ds_read_b64_tr_b16 v[114:115], v13 offset:3072
ds_read_b64_tr_b16 v[116:117], v13 offset:2112
ds_read_b64_tr_b16 v[118:119], v13 offset:3136
s_nop 7
v_bfe_u32 v2, v80, 16, 1
v_add3_u32 v80, v80, v2, s60
v_and_b32 v80, 0xffff0000, v80
v_add_f32 v80, s61, v80
v_bfe_u32 v2, v80, 16, 1
v_add3_u32 v80, v80, v2, s60
v_and_b32 v80, 0xffff0000, v80
v_rcp_f32 v80, v80
s_nop 0
v_bfe_u32 v2, v64, 16, 1
v_add3_u32 v64, v64, v2, s60
v_and_b32 v64, 0xffff0000, v64
v_mul_f32 v64, v64, v80
v_bfe_u32 v2, v65, 16, 1
v_add3_u32 v65, v65, v2, s60
v_and_b32 v65, 0xffff0000, v65
v_mul_f32 v65, v65, v80
v_bfe_u32 v2, v66, 16, 1
v_add3_u32 v66, v66, v2, s60
v_and_b32 v66, 0xffff0000, v66
v_mul_f32 v66, v66, v80
v_bfe_u32 v2, v67, 16, 1
v_add3_u32 v67, v67, v2, s60
v_and_b32 v67, 0xffff0000, v67
v_mul_f32 v67, v67, v80
v_bfe_u32 v2, v68, 16, 1
v_add3_u32 v68, v68, v2, s60
v_and_b32 v68, 0xffff0000, v68
v_mul_f32 v68, v68, v80
v_bfe_u32 v2, v69, 16, 1
v_add3_u32 v69, v69, v2, s60
v_and_b32 v69, 0xffff0000, v69
v_mul_f32 v69, v69, v80
v_bfe_u32 v2, v70, 16, 1
v_add3_u32 v70, v70, v2, s60
v_and_b32 v70, 0xffff0000, v70
v_mul_f32 v70, v70, v80
v_bfe_u32 v2, v71, 16, 1
v_add3_u32 v71, v71, v2, s60
v_and_b32 v71, 0xffff0000, v71
v_mul_f32 v71, v71, v80
v_bfe_u32 v2, v72, 16, 1
v_add3_u32 v72, v72, v2, s60
v_and_b32 v72, 0xffff0000, v72
v_mul_f32 v72, v72, v80
v_bfe_u32 v2, v73, 16, 1
v_add3_u32 v73, v73, v2, s60
v_and_b32 v73, 0xffff0000, v73
v_mul_f32 v73, v73, v80
v_bfe_u32 v2, v74, 16, 1
v_add3_u32 v74, v74, v2, s60
v_and_b32 v74, 0xffff0000, v74
v_mul_f32 v74, v74, v80
v_bfe_u32 v2, v75, 16, 1
v_add3_u32 v75, v75, v2, s60
v_and_b32 v75, 0xffff0000, v75
v_mul_f32 v75, v75, v80
v_bfe_u32 v2, v76, 16, 1
v_add3_u32 v76, v76, v2, s60
v_and_b32 v76, 0xffff0000, v76
v_mul_f32 v76, v76, v80
v_bfe_u32 v2, v77, 16, 1
v_add3_u32 v77, v77, v2, s60
v_and_b32 v77, 0xffff0000, v77
v_mul_f32 v77, v77, v80
v_bfe_u32 v2, v78, 16, 1
v_add3_u32 v78, v78, v2, s60
v_and_b32 v78, 0xffff0000, v78
v_mul_f32 v78, v78, v80
v_bfe_u32 v2, v79, 16, 1
v_add3_u32 v79, v79, v2, s60
v_and_b32 v79, 0xffff0000, v79
v_mul_f32 v79, v79, v80
v_cvt_pk_bf16_f32 v96, v64, v65
v_cvt_pk_bf16_f32 v97, v66, v67
v_cvt_pk_bf16_f32 v98, v68, v69
v_cvt_pk_bf16_f32 v99, v70, v71
v_cvt_pk_bf16_f32 v100, v72, v73
v_cvt_pk_bf16_f32 v101, v74, v75
v_cvt_pk_bf16_f32 v102, v76, v77
v_cvt_pk_bf16_f32 v103, v78, v79
s_waitcnt lgkmcnt(0)
v_mfma_f32_32x32x16_bf16 v[128:143], v[96:99], v[104:107], v[128:143]
v_mfma_f32_32x32x16_bf16 v[144:159], v[96:99], v[108:111], v[144:159]
v_mfma_f32_32x32x16_bf16 v[128:143], v[100:103], v[112:115], v[128:143]
v_mfma_f32_32x32x16_bf16 v[144:159], v[100:103], v[116:119], v[144:159]
s_add_u32 s50, s50, 4096
s_cmp_eq_u32 s50, 12288
s_cselect_b32 s50, 0, s50
s_add_u32 s52, s52, 1
v_mov_b32 v64, 0
v_mov_b32 v65, 0
v_mov_b32 v66, 0
v_mov_b32 v67, 0
v_mov_b32 v68, 0
v_mov_b32 v69, 0
v_mov_b32 v70, 0
v_mov_b32 v71, 0
v_mov_b32 v72, 0
v_mov_b32 v73, 0
v_mov_b32 v74, 0
v_mov_b32 v75, 0
v_mov_b32 v76, 0
v_mov_b32 v77, 0
v_mov_b32 v78, 0
v_mov_b32 v79, 0
v_mov_b32 v80, 0
v_mov_b32 v81, 0
v_mov_b32 v82, 0
v_mov_b32 v83, 0
v_mov_b32 v84, 0
v_mov_b32 v85, 0
v_mov_b32 v86, 0
v_mov_b32 v87, 0
v_mov_b32 v88, 0
v_mov_b32 v89, 0
v_mov_b32 v90, 0
v_mov_b32 v91, 0
v_mov_b32 v92, 0
v_mov_b32 v93, 0
v_mov_b32 v94, 0
v_mov_b32 v95, 0
s_waitcnt vmcnt(7)
v_mfma_f32_32x32x16_bf16 v[64:79], v[160:163], v[176:179], v[64:79]
v_mfma_f32_32x32x16_bf16 v[80:95], v[168:171], v[176:179], v[80:95]
v_mfma_f32_32x32x16_bf16 v[64:79], v[164:167], v[180:183], v[64:79]
v_mfma_f32_32x32x16_bf16 v[80:95], v[172:175], v[180:183], v[80:95]
s_barrier
s_add_u32 s51, s51, 4096
s_cmp_eq_u32 s51, 12288
s_cselect_b32 s51, 0, s51
s_add_u32 s53, s52, 2
s_min_u32 s53, s53, 31
s_lshl_b32 s32, s53, 12
s_lshl_b32 s33, s53, 17
s_lshl_b32 s31, s53, 16
s_lshl_b32 s30, s20, 10
s_add_u32 m0, s30, s51
s_nop 0
buffer_load_dwordx4 v8, s[8:11], s31 offen lds
buffer_load_dwordx4 v[160:163], v10, s[16:19], s32 offen offset:0
buffer_load_dwordx4 v[168:171], v10, s[16:19], s32 offen offset:2048
buffer_load_dwordx4 v[176:179], v11, s[16:19], s33 offen offset:0
buffer_load_dwordx4 v[164:167], v10, s[16:19], s32 offen offset:32
buffer_load_dwordx4 v[172:175], v10, s[16:19], s32 offen offset:2080
buffer_load_dwordx4 v[180:183], v11, s[16:19], s33 offen offset:32
v_add_u32 v13, s50, v12
ds_read_b64_tr_b16 v[104:105], v13 offset:0
ds_read_b64_tr_b16 v[106:107], v13 offset:1024
ds_read_b64_tr_b16 v[108:109], v13 offset:64
ds_read_b64_tr_b16 v[110:111], v13 offset:1088
ds_read_b64_tr_b16 v[112:113], v13 offset:2048
ds_read_b64_tr_b16 v[114:115], v13 offset:3072
ds_read_b64_tr_b16 v[116:117], v13 offset:2112
ds_read_b64_tr_b16 v[118:119], v13 offset:3136
s_nop 7
v_bfe_u32 v2, v80, 16, 1
v_add3_u32 v80, v80, v2, s60
v_and_b32 v80, 0xffff0000, v80
v_add_f32 v80, s61, v80
v_bfe_u32 v2, v80, 16, 1
v_add3_u32 v80, v80, v2, s60
v_and_b32 v80, 0xffff0000, v80
v_rcp_f32 v80, v80
s_nop 0
v_bfe_u32 v2, v64, 16, 1
v_add3_u32 v64, v64, v2, s60
v_and_b32 v64, 0xffff0000, v64
v_mul_f32 v64, v64, v80
v_bfe_u32 v2, v65, 16, 1
v_add3_u32 v65, v65, v2, s60
v_and_b32 v65, 0xffff0000, v65
v_mul_f32 v65, v65, v80
v_bfe_u32 v2, v66, 16, 1
v_add3_u32 v66, v66, v2, s60
v_and_b32 v66, 0xffff0000, v66
v_mul_f32 v66, v66, v80
v_bfe_u32 v2, v67, 16, 1
v_add3_u32 v67, v67, v2, s60
v_and_b32 v67, 0xffff0000, v67
v_mul_f32 v67, v67, v80
v_bfe_u32 v2, v68, 16, 1
v_add3_u32 v68, v68, v2, s60
v_and_b32 v68, 0xffff0000, v68
v_mul_f32 v68, v68, v80
v_bfe_u32 v2, v69, 16, 1
v_add3_u32 v69, v69, v2, s60
v_and_b32 v69, 0xffff0000, v69
v_mul_f32 v69, v69, v80
v_bfe_u32 v2, v70, 16, 1
v_add3_u32 v70, v70, v2, s60
v_and_b32 v70, 0xffff0000, v70
v_mul_f32 v70, v70, v80
v_bfe_u32 v2, v71, 16, 1
v_add3_u32 v71, v71, v2, s60
v_and_b32 v71, 0xffff0000, v71
v_mul_f32 v71, v71, v80
v_bfe_u32 v2, v72, 16, 1
v_add3_u32 v72, v72, v2, s60
v_and_b32 v72, 0xffff0000, v72
v_mul_f32 v72, v72, v80
v_bfe_u32 v2, v73, 16, 1
v_add3_u32 v73, v73, v2, s60
v_and_b32 v73, 0xffff0000, v73
v_mul_f32 v73, v73, v80
v_bfe_u32 v2, v74, 16, 1
v_add3_u32 v74, v74, v2, s60
v_and_b32 v74, 0xffff0000, v74
v_mul_f32 v74, v74, v80
v_bfe_u32 v2, v75, 16, 1
v_add3_u32 v75, v75, v2, s60
v_and_b32 v75, 0xffff0000, v75
v_mul_f32 v75, v75, v80
v_bfe_u32 v2, v76, 16, 1
v_add3_u32 v76, v76, v2, s60
v_and_b32 v76, 0xffff0000, v76
v_mul_f32 v76, v76, v80
v_bfe_u32 v2, v77, 16, 1
v_add3_u32 v77, v77, v2, s60
v_and_b32 v77, 0xffff0000, v77
v_mul_f32 v77, v77, v80
v_bfe_u32 v2, v78, 16, 1
v_add3_u32 v78, v78, v2, s60
v_and_b32 v78, 0xffff0000, v78
v_mul_f32 v78, v78, v80
v_bfe_u32 v2, v79, 16, 1
v_add3_u32 v79, v79, v2, s60
v_and_b32 v79, 0xffff0000, v79
v_mul_f32 v79, v79, v80
v_cvt_pk_bf16_f32 v96, v64, v65
v_cvt_pk_bf16_f32 v97, v66, v67
v_cvt_pk_bf16_f32 v98, v68, v69
v_cvt_pk_bf16_f32 v99, v70, v71
v_cvt_pk_bf16_f32 v100, v72, v73
v_cvt_pk_bf16_f32 v101, v74, v75
v_cvt_pk_bf16_f32 v102, v76, v77
v_cvt_pk_bf16_f32 v103, v78, v79
s_waitcnt lgkmcnt(0)
v_mfma_f32_32x32x16_bf16 v[128:143], v[96:99], v[104:107], v[128:143]
v_mfma_f32_32x32x16_bf16 v[144:159], v[96:99], v[108:111], v[144:159]
v_mfma_f32_32x32x16_bf16 v[128:143], v[100:103], v[112:115], v[128:143]
v_mfma_f32_32x32x16_bf16 v[144:159], v[100:103], v[116:119], v[144:159]
s_add_u32 s50, s50, 4096
s_cmp_eq_u32 s50, 12288
s_cselect_b32 s50, 0, s50
s_add_u32 s52, s52, 1
s_cmp_lt_u32 s52, 32
s_cbranch_scc1 K3_LOOP
s_waitcnt vmcnt(0)
v_lshlrev_b32 v3, 2, v6
v_add_u32 v3, s23, v3
v_lshlrev_b32 v4, 2, v3
v_add_u32 v4, 15728640, v4
v_lshlrev_b32 v3, 11, v3
v_lshl_add_u32 v3, v5, 1, v3
s_lshl_b32 s30, s21, 7
v_add_u32 v3, s30, v3
buffer_load_dword v20, v4, s[16:19], 0 offen offset:0
s_mov_b32 s30, 10485760
buffer_load_dword v21, v4, s[16:19], 0 offen offset:4
s_mov_b32 s30, 10487808
buffer_load_dword v22, v4, s[16:19], 0 offen offset:8
s_mov_b32 s30, 10489856
buffer_load_dword v23, v4, s[16:19], 0 offen offset:12
s_mov_b32 s30, 10491904
buffer_load_dword v24, v4, s[16:19], 0 offen offset:32
s_mov_b32 s30, 10502144
buffer_load_dword v25, v4, s[16:19], 0 offen offset:36
s_mov_b32 s30, 10504192
buffer_load_dword v26, v4, s[16:19], 0 offen offset:40
s_mov_b32 s30, 10506240
buffer_load_dword v27, v4, s[16:19], 0 offen offset:44
s_mov_b32 s30, 10508288
buffer_load_dword v28, v4, s[16:19], 0 offen offset:64
s_mov_b32 s30, 10518528
buffer_load_dword v29, v4, s[16:19], 0 offen offset:68
s_mov_b32 s30, 10520576
buffer_load_dword v30, v4, s[16:19], 0 offen offset:72
s_mov_b32 s30, 10522624
buffer_load_dword v31, v4, s[16:19], 0 offen offset:76
s_mov_b32 s30, 10524672
buffer_load_dword v32, v4, s[16:19], 0 offen offset:96
s_mov_b32 s30, 10534912
buffer_load_dword v33, v4, s[16:19], 0 offen offset:100
s_mov_b32 s30, 10536960
buffer_load_dword v34, v4, s[16:19], 0 offen offset:104
s_mov_b32 s30, 10539008
buffer_load_dword v35, v4, s[16:19], 0 offen offset:108
s_mov_b32 s30, 10541056
s_lshl_b32 s30, s21, 6
v_add_u32 v7, s30, v5
v_lshlrev_b32 v7, 12, v7
v_lshl_add_u32 v7, v6, 3, v7
s_lshl_b32 s30, s23, 1
s_add_u32 s30, s30, 10485760
s_add_u32 s31, s30, 0
buffer_load_dwordx2 v[64:65], v7, s[16:19], s31 offen offset:0
s_add_u32 s31, s30, 0
buffer_load_dwordx2 v[66:67], v7, s[16:19], s31 offen offset:16
s_add_u32 s31, s30, 0
buffer_load_dwordx2 v[68:69], v7, s[16:19], s31 offen offset:32
s_add_u32 s31, s30, 0
buffer_load_dwordx2 v[70:71], v7, s[16:19], s31 offen offset:48
s_add_u32 s31, s30, 131072
buffer_load_dwordx2 v[72:73], v7, s[16:19], s31 offen offset:0
s_add_u32 s31, s30, 131072
buffer_load_dwordx2 v[74:75], v7, s[16:19], s31 offen offset:16
s_add_u32 s31, s30, 131072
buffer_load_dwordx2 v[76:77], v7, s[16:19], s31 offen offset:32
s_add_u32 s31, s30, 131072
buffer_load_dwordx2 v[78:79], v7, s[16:19], s31 offen offset:48
s_waitcnt vmcnt(0)
s_mov_b32 s31, 0
v_sub_f32 v40, 1.0, v20
v_bfe_u32 v2, v40, 16, 1
v_add3_u32 v40, v40, v2, s60
v_and_b32 v40, 0xffff0000, v40
v_lshlrev_b32 v41, 16, v64
v_mul_f32 v41, v20, v41
v_bfe_u32 v2, v41, 16, 1
v_add3_u32 v41, v41, v2, s60
v_and_b32 v41, 0xffff0000, v41
v_bfe_u32 v2, v128, 16, 1
v_add3_u32 v128, v128, v2, s60
v_and_b32 v128, 0xffff0000, v128
v_mul_f32 v128, v40, v128
v_bfe_u32 v2, v128, 16, 1
v_add3_u32 v128, v128, v2, s60
v_and_b32 v128, 0xffff0000, v128
v_add_f32 v128, v128, v41
v_bfe_u32 v2, v128, 16, 1
v_add3_u32 v128, v128, v2, s60
v_and_b32 v128, 0xffff0000, v128
buffer_store_short_d16_hi v128, v3, s[12:15], s31 offen offset:0
v_lshlrev_b32 v41, 16, v72
v_mul_f32 v41, v20, v41
v_bfe_u32 v2, v41, 16, 1
v_add3_u32 v41, v41, v2, s60
v_and_b32 v41, 0xffff0000, v41
v_bfe_u32 v2, v144, 16, 1
v_add3_u32 v144, v144, v2, s60
v_and_b32 v144, 0xffff0000, v144
v_mul_f32 v144, v40, v144
v_bfe_u32 v2, v144, 16, 1
v_add3_u32 v144, v144, v2, s60
v_and_b32 v144, 0xffff0000, v144
v_add_f32 v144, v144, v41
v_bfe_u32 v2, v144, 16, 1
v_add3_u32 v144, v144, v2, s60
v_and_b32 v144, 0xffff0000, v144
buffer_store_short_d16_hi v144, v3, s[12:15], s31 offen offset:64
s_mov_b32 s31, 2048
v_sub_f32 v40, 1.0, v21
v_bfe_u32 v2, v40, 16, 1
v_add3_u32 v40, v40, v2, s60
v_and_b32 v40, 0xffff0000, v40
v_and_b32 v41, 0xffff0000, v64
v_mul_f32 v41, v21, v41
v_bfe_u32 v2, v41, 16, 1
v_add3_u32 v41, v41, v2, s60
v_and_b32 v41, 0xffff0000, v41
v_bfe_u32 v2, v129, 16, 1
v_add3_u32 v129, v129, v2, s60
v_and_b32 v129, 0xffff0000, v129
v_mul_f32 v129, v40, v129
v_bfe_u32 v2, v129, 16, 1
v_add3_u32 v129, v129, v2, s60
v_and_b32 v129, 0xffff0000, v129
v_add_f32 v129, v129, v41
v_bfe_u32 v2, v129, 16, 1
v_add3_u32 v129, v129, v2, s60
v_and_b32 v129, 0xffff0000, v129
buffer_store_short_d16_hi v129, v3, s[12:15], s31 offen offset:0
v_and_b32 v41, 0xffff0000, v72
v_mul_f32 v41, v21, v41
v_bfe_u32 v2, v41, 16, 1
v_add3_u32 v41, v41, v2, s60
v_and_b32 v41, 0xffff0000, v41
v_bfe_u32 v2, v145, 16, 1
v_add3_u32 v145, v145, v2, s60
v_and_b32 v145, 0xffff0000, v145
v_mul_f32 v145, v40, v145
v_bfe_u32 v2, v145, 16, 1
v_add3_u32 v145, v145, v2, s60
v_and_b32 v145, 0xffff0000, v145
v_add_f32 v145, v145, v41
v_bfe_u32 v2, v145, 16, 1
v_add3_u32 v145, v145, v2, s60
v_and_b32 v145, 0xffff0000, v145
buffer_store_short_d16_hi v145, v3, s[12:15], s31 offen offset:64
s_mov_b32 s31, 4096
v_sub_f32 v40, 1.0, v22
v_bfe_u32 v2, v40, 16, 1
v_add3_u32 v40, v40, v2, s60
v_and_b32 v40, 0xffff0000, v40
v_lshlrev_b32 v41, 16, v65
v_mul_f32 v41, v22, v41
v_bfe_u32 v2, v41, 16, 1
v_add3_u32 v41, v41, v2, s60
v_and_b32 v41, 0xffff0000, v41
v_bfe_u32 v2, v130, 16, 1
v_add3_u32 v130, v130, v2, s60
v_and_b32 v130, 0xffff0000, v130
v_mul_f32 v130, v40, v130
v_bfe_u32 v2, v130, 16, 1
v_add3_u32 v130, v130, v2, s60
v_and_b32 v130, 0xffff0000, v130
v_add_f32 v130, v130, v41
v_bfe_u32 v2, v130, 16, 1
v_add3_u32 v130, v130, v2, s60
v_and_b32 v130, 0xffff0000, v130
buffer_store_short_d16_hi v130, v3, s[12:15], s31 offen offset:0
v_lshlrev_b32 v41, 16, v73
v_mul_f32 v41, v22, v41
v_bfe_u32 v2, v41, 16, 1
v_add3_u32 v41, v41, v2, s60
v_and_b32 v41, 0xffff0000, v41
v_bfe_u32 v2, v146, 16, 1
v_add3_u32 v146, v146, v2, s60
v_and_b32 v146, 0xffff0000, v146
v_mul_f32 v146, v40, v146
v_bfe_u32 v2, v146, 16, 1
v_add3_u32 v146, v146, v2, s60
v_and_b32 v146, 0xffff0000, v146
v_add_f32 v146, v146, v41
v_bfe_u32 v2, v146, 16, 1
v_add3_u32 v146, v146, v2, s60
v_and_b32 v146, 0xffff0000, v146
buffer_store_short_d16_hi v146, v3, s[12:15], s31 offen offset:64
s_mov_b32 s31, 6144
v_sub_f32 v40, 1.0, v23
v_bfe_u32 v2, v40, 16, 1
v_add3_u32 v40, v40, v2, s60
v_and_b32 v40, 0xffff0000, v40
v_and_b32 v41, 0xffff0000, v65
v_mul_f32 v41, v23, v41
v_bfe_u32 v2, v41, 16, 1
v_add3_u32 v41, v41, v2, s60
v_and_b32 v41, 0xffff0000, v41
v_bfe_u32 v2, v131, 16, 1
v_add3_u32 v131, v131, v2, s60
v_and_b32 v131, 0xffff0000, v131
v_mul_f32 v131, v40, v131
v_bfe_u32 v2, v131, 16, 1
v_add3_u32 v131, v131, v2, s60
v_and_b32 v131, 0xffff0000, v131
v_add_f32 v131, v131, v41
v_bfe_u32 v2, v131, 16, 1
v_add3_u32 v131, v131, v2, s60
v_and_b32 v131, 0xffff0000, v131
buffer_store_short_d16_hi v131, v3, s[12:15], s31 offen offset:0
v_and_b32 v41, 0xffff0000, v73
v_mul_f32 v41, v23, v41
v_bfe_u32 v2, v41, 16, 1
v_add3_u32 v41, v41, v2, s60
v_and_b32 v41, 0xffff0000, v41
v_bfe_u32 v2, v147, 16, 1
v_add3_u32 v147, v147, v2, s60
v_and_b32 v147, 0xffff0000, v147
v_mul_f32 v147, v40, v147
v_bfe_u32 v2, v147, 16, 1
v_add3_u32 v147, v147, v2, s60
v_and_b32 v147, 0xffff0000, v147
v_add_f32 v147, v147, v41
v_bfe_u32 v2, v147, 16, 1
v_add3_u32 v147, v147, v2, s60
v_and_b32 v147, 0xffff0000, v147
buffer_store_short_d16_hi v147, v3, s[12:15], s31 offen offset:64
s_mov_b32 s31, 16384
v_sub_f32 v40, 1.0, v24
v_bfe_u32 v2, v40, 16, 1
v_add3_u32 v40, v40, v2, s60
v_and_b32 v40, 0xffff0000, v40
v_lshlrev_b32 v41, 16, v66
v_mul_f32 v41, v24, v41
v_bfe_u32 v2, v41, 16, 1
v_add3_u32 v41, v41, v2, s60
v_and_b32 v41, 0xffff0000, v41
v_bfe_u32 v2, v132, 16, 1
v_add3_u32 v132, v132, v2, s60
v_and_b32 v132, 0xffff0000, v132
v_mul_f32 v132, v40, v132
v_bfe_u32 v2, v132, 16, 1
v_add3_u32 v132, v132, v2, s60
v_and_b32 v132, 0xffff0000, v132
v_add_f32 v132, v132, v41
v_bfe_u32 v2, v132, 16, 1
v_add3_u32 v132, v132, v2, s60
v_and_b32 v132, 0xffff0000, v132
buffer_store_short_d16_hi v132, v3, s[12:15], s31 offen offset:0
v_lshlrev_b32 v41, 16, v74
v_mul_f32 v41, v24, v41
v_bfe_u32 v2, v41, 16, 1
v_add3_u32 v41, v41, v2, s60
v_and_b32 v41, 0xffff0000, v41
v_bfe_u32 v2, v148, 16, 1
v_add3_u32 v148, v148, v2, s60
v_and_b32 v148, 0xffff0000, v148
v_mul_f32 v148, v40, v148
v_bfe_u32 v2, v148, 16, 1
v_add3_u32 v148, v148, v2, s60
v_and_b32 v148, 0xffff0000, v148
v_add_f32 v148, v148, v41
v_bfe_u32 v2, v148, 16, 1
v_add3_u32 v148, v148, v2, s60
v_and_b32 v148, 0xffff0000, v148
buffer_store_short_d16_hi v148, v3, s[12:15], s31 offen offset:64
s_mov_b32 s31, 18432
v_sub_f32 v40, 1.0, v25
v_bfe_u32 v2, v40, 16, 1
v_add3_u32 v40, v40, v2, s60
v_and_b32 v40, 0xffff0000, v40
v_and_b32 v41, 0xffff0000, v66
v_mul_f32 v41, v25, v41
v_bfe_u32 v2, v41, 16, 1
v_add3_u32 v41, v41, v2, s60
v_and_b32 v41, 0xffff0000, v41
v_bfe_u32 v2, v133, 16, 1
v_add3_u32 v133, v133, v2, s60
v_and_b32 v133, 0xffff0000, v133
v_mul_f32 v133, v40, v133
v_bfe_u32 v2, v133, 16, 1
v_add3_u32 v133, v133, v2, s60
v_and_b32 v133, 0xffff0000, v133
v_add_f32 v133, v133, v41
v_bfe_u32 v2, v133, 16, 1
v_add3_u32 v133, v133, v2, s60
v_and_b32 v133, 0xffff0000, v133
buffer_store_short_d16_hi v133, v3, s[12:15], s31 offen offset:0
v_and_b32 v41, 0xffff0000, v74
v_mul_f32 v41, v25, v41
v_bfe_u32 v2, v41, 16, 1
v_add3_u32 v41, v41, v2, s60
v_and_b32 v41, 0xffff0000, v41
v_bfe_u32 v2, v149, 16, 1
v_add3_u32 v149, v149, v2, s60
v_and_b32 v149, 0xffff0000, v149
v_mul_f32 v149, v40, v149
v_bfe_u32 v2, v149, 16, 1
v_add3_u32 v149, v149, v2, s60
v_and_b32 v149, 0xffff0000, v149
v_add_f32 v149, v149, v41
v_bfe_u32 v2, v149, 16, 1
v_add3_u32 v149, v149, v2, s60
v_and_b32 v149, 0xffff0000, v149
buffer_store_short_d16_hi v149, v3, s[12:15], s31 offen offset:64
s_mov_b32 s31, 20480
v_sub_f32 v40, 1.0, v26
v_bfe_u32 v2, v40, 16, 1
v_add3_u32 v40, v40, v2, s60
v_and_b32 v40, 0xffff0000, v40
v_lshlrev_b32 v41, 16, v67
v_mul_f32 v41, v26, v41
v_bfe_u32 v2, v41, 16, 1
v_add3_u32 v41, v41, v2, s60
v_and_b32 v41, 0xffff0000, v41
v_bfe_u32 v2, v134, 16, 1
v_add3_u32 v134, v134, v2, s60
v_and_b32 v134, 0xffff0000, v134
v_mul_f32 v134, v40, v134
v_bfe_u32 v2, v134, 16, 1
v_add3_u32 v134, v134, v2, s60
v_and_b32 v134, 0xffff0000, v134
v_add_f32 v134, v134, v41
v_bfe_u32 v2, v134, 16, 1
v_add3_u32 v134, v134, v2, s60
v_and_b32 v134, 0xffff0000, v134
buffer_store_short_d16_hi v134, v3, s[12:15], s31 offen offset:0
v_lshlrev_b32 v41, 16, v75
v_mul_f32 v41, v26, v41
v_bfe_u32 v2, v41, 16, 1
v_add3_u32 v41, v41, v2, s60
v_and_b32 v41, 0xffff0000, v41
v_bfe_u32 v2, v150, 16, 1
v_add3_u32 v150, v150, v2, s60
v_and_b32 v150, 0xffff0000, v150
v_mul_f32 v150, v40, v150
v_bfe_u32 v2, v150, 16, 1
v_add3_u32 v150, v150, v2, s60
v_and_b32 v150, 0xffff0000, v150
v_add_f32 v150, v150, v41
v_bfe_u32 v2, v150, 16, 1
v_add3_u32 v150, v150, v2, s60
v_and_b32 v150, 0xffff0000, v150
buffer_store_short_d16_hi v150, v3, s[12:15], s31 offen offset:64
s_mov_b32 s31, 22528
v_sub_f32 v40, 1.0, v27
v_bfe_u32 v2, v40, 16, 1
v_add3_u32 v40, v40, v2, s60
v_and_b32 v40, 0xffff0000, v40
v_and_b32 v41, 0xffff0000, v67
v_mul_f32 v41, v27, v41
v_bfe_u32 v2, v41, 16, 1
v_add3_u32 v41, v41, v2, s60
v_and_b32 v41, 0xffff0000, v41
v_bfe_u32 v2, v135, 16, 1
v_add3_u32 v135, v135, v2, s60
v_and_b32 v135, 0xffff0000, v135
v_mul_f32 v135, v40, v135
v_bfe_u32 v2, v135, 16, 1
v_add3_u32 v135, v135, v2, s60
v_and_b32 v135, 0xffff0000, v135
v_add_f32 v135, v135, v41
v_bfe_u32 v2, v135, 16, 1
v_add3_u32 v135, v135, v2, s60
v_and_b32 v135, 0xffff0000, v135
buffer_store_short_d16_hi v135, v3, s[12:15], s31 offen offset:0
v_and_b32 v41, 0xffff0000, v75
v_mul_f32 v41, v27, v41
v_bfe_u32 v2, v41, 16, 1
v_add3_u32 v41, v41, v2, s60
v_and_b32 v41, 0xffff0000, v41
v_bfe_u32 v2, v151, 16, 1
v_add3_u32 v151, v151, v2, s60
v_and_b32 v151, 0xffff0000, v151
v_mul_f32 v151, v40, v151
v_bfe_u32 v2, v151, 16, 1
v_add3_u32 v151, v151, v2, s60
v_and_b32 v151, 0xffff0000, v151
v_add_f32 v151, v151, v41
v_bfe_u32 v2, v151, 16, 1
v_add3_u32 v151, v151, v2, s60
v_and_b32 v151, 0xffff0000, v151
buffer_store_short_d16_hi v151, v3, s[12:15], s31 offen offset:64
s_mov_b32 s31, 32768
v_sub_f32 v40, 1.0, v28
v_bfe_u32 v2, v40, 16, 1
v_add3_u32 v40, v40, v2, s60
v_and_b32 v40, 0xffff0000, v40
v_lshlrev_b32 v41, 16, v68
v_mul_f32 v41, v28, v41
v_bfe_u32 v2, v41, 16, 1
v_add3_u32 v41, v41, v2, s60
v_and_b32 v41, 0xffff0000, v41
v_bfe_u32 v2, v136, 16, 1
v_add3_u32 v136, v136, v2, s60
v_and_b32 v136, 0xffff0000, v136
v_mul_f32 v136, v40, v136
v_bfe_u32 v2, v136, 16, 1
v_add3_u32 v136, v136, v2, s60
v_and_b32 v136, 0xffff0000, v136
v_add_f32 v136, v136, v41
v_bfe_u32 v2, v136, 16, 1
v_add3_u32 v136, v136, v2, s60
v_and_b32 v136, 0xffff0000, v136
buffer_store_short_d16_hi v136, v3, s[12:15], s31 offen offset:0
v_lshlrev_b32 v41, 16, v76
v_mul_f32 v41, v28, v41
v_bfe_u32 v2, v41, 16, 1
v_add3_u32 v41, v41, v2, s60
v_and_b32 v41, 0xffff0000, v41
v_bfe_u32 v2, v152, 16, 1
v_add3_u32 v152, v152, v2, s60
v_and_b32 v152, 0xffff0000, v152
v_mul_f32 v152, v40, v152
v_bfe_u32 v2, v152, 16, 1
v_add3_u32 v152, v152, v2, s60
v_and_b32 v152, 0xffff0000, v152
v_add_f32 v152, v152, v41
v_bfe_u32 v2, v152, 16, 1
v_add3_u32 v152, v152, v2, s60
v_and_b32 v152, 0xffff0000, v152
buffer_store_short_d16_hi v152, v3, s[12:15], s31 offen offset:64
s_mov_b32 s31, 34816
v_sub_f32 v40, 1.0, v29
v_bfe_u32 v2, v40, 16, 1
v_add3_u32 v40, v40, v2, s60
v_and_b32 v40, 0xffff0000, v40
v_and_b32 v41, 0xffff0000, v68
v_mul_f32 v41, v29, v41
v_bfe_u32 v2, v41, 16, 1
v_add3_u32 v41, v41, v2, s60
v_and_b32 v41, 0xffff0000, v41
v_bfe_u32 v2, v137, 16, 1
v_add3_u32 v137, v137, v2, s60
v_and_b32 v137, 0xffff0000, v137
v_mul_f32 v137, v40, v137
v_bfe_u32 v2, v137, 16, 1
v_add3_u32 v137, v137, v2, s60
v_and_b32 v137, 0xffff0000, v137
v_add_f32 v137, v137, v41
v_bfe_u32 v2, v137, 16, 1
v_add3_u32 v137, v137, v2, s60
v_and_b32 v137, 0xffff0000, v137
buffer_store_short_d16_hi v137, v3, s[12:15], s31 offen offset:0
v_and_b32 v41, 0xffff0000, v76
v_mul_f32 v41, v29, v41
v_bfe_u32 v2, v41, 16, 1
v_add3_u32 v41, v41, v2, s60
v_and_b32 v41, 0xffff0000, v41
v_bfe_u32 v2, v153, 16, 1
v_add3_u32 v153, v153, v2, s60
v_and_b32 v153, 0xffff0000, v153
v_mul_f32 v153, v40, v153
v_bfe_u32 v2, v153, 16, 1
v_add3_u32 v153, v153, v2, s60
v_and_b32 v153, 0xffff0000, v153
v_add_f32 v153, v153, v41
v_bfe_u32 v2, v153, 16, 1
v_add3_u32 v153, v153, v2, s60
v_and_b32 v153, 0xffff0000, v153
buffer_store_short_d16_hi v153, v3, s[12:15], s31 offen offset:64
s_mov_b32 s31, 36864
v_sub_f32 v40, 1.0, v30
v_bfe_u32 v2, v40, 16, 1
v_add3_u32 v40, v40, v2, s60
v_and_b32 v40, 0xffff0000, v40
v_lshlrev_b32 v41, 16, v69
v_mul_f32 v41, v30, v41
v_bfe_u32 v2, v41, 16, 1
v_add3_u32 v41, v41, v2, s60
v_and_b32 v41, 0xffff0000, v41
v_bfe_u32 v2, v138, 16, 1
v_add3_u32 v138, v138, v2, s60
v_and_b32 v138, 0xffff0000, v138
v_mul_f32 v138, v40, v138
v_bfe_u32 v2, v138, 16, 1
v_add3_u32 v138, v138, v2, s60
v_and_b32 v138, 0xffff0000, v138
v_add_f32 v138, v138, v41
v_bfe_u32 v2, v138, 16, 1
v_add3_u32 v138, v138, v2, s60
v_and_b32 v138, 0xffff0000, v138
buffer_store_short_d16_hi v138, v3, s[12:15], s31 offen offset:0
v_lshlrev_b32 v41, 16, v77
v_mul_f32 v41, v30, v41
v_bfe_u32 v2, v41, 16, 1
v_add3_u32 v41, v41, v2, s60
v_and_b32 v41, 0xffff0000, v41
v_bfe_u32 v2, v154, 16, 1
v_add3_u32 v154, v154, v2, s60
v_and_b32 v154, 0xffff0000, v154
v_mul_f32 v154, v40, v154
v_bfe_u32 v2, v154, 16, 1
v_add3_u32 v154, v154, v2, s60
v_and_b32 v154, 0xffff0000, v154
v_add_f32 v154, v154, v41
v_bfe_u32 v2, v154, 16, 1
v_add3_u32 v154, v154, v2, s60
v_and_b32 v154, 0xffff0000, v154
buffer_store_short_d16_hi v154, v3, s[12:15], s31 offen offset:64
s_mov_b32 s31, 38912
v_sub_f32 v40, 1.0, v31
v_bfe_u32 v2, v40, 16, 1
v_add3_u32 v40, v40, v2, s60
v_and_b32 v40, 0xffff0000, v40
v_and_b32 v41, 0xffff0000, v69
v_mul_f32 v41, v31, v41
v_bfe_u32 v2, v41, 16, 1
v_add3_u32 v41, v41, v2, s60
v_and_b32 v41, 0xffff0000, v41
v_bfe_u32 v2, v139, 16, 1
v_add3_u32 v139, v139, v2, s60
v_and_b32 v139, 0xffff0000, v139
v_mul_f32 v139, v40, v139
v_bfe_u32 v2, v139, 16, 1
v_add3_u32 v139, v139, v2, s60
v_and_b32 v139, 0xffff0000, v139
v_add_f32 v139, v139, v41
v_bfe_u32 v2, v139, 16, 1
v_add3_u32 v139, v139, v2, s60
v_and_b32 v139, 0xffff0000, v139
buffer_store_short_d16_hi v139, v3, s[12:15], s31 offen offset:0
v_and_b32 v41, 0xffff0000, v77
v_mul_f32 v41, v31, v41
v_bfe_u32 v2, v41, 16, 1
v_add3_u32 v41, v41, v2, s60
v_and_b32 v41, 0xffff0000, v41
v_bfe_u32 v2, v155, 16, 1
v_add3_u32 v155, v155, v2, s60
v_and_b32 v155, 0xffff0000, v155
v_mul_f32 v155, v40, v155
v_bfe_u32 v2, v155, 16, 1
v_add3_u32 v155, v155, v2, s60
v_and_b32 v155, 0xffff0000, v155
v_add_f32 v155, v155, v41
v_bfe_u32 v2, v155, 16, 1
v_add3_u32 v155, v155, v2, s60
v_and_b32 v155, 0xffff0000, v155
buffer_store_short_d16_hi v155, v3, s[12:15], s31 offen offset:64
s_mov_b32 s31, 49152
v_sub_f32 v40, 1.0, v32
v_bfe_u32 v2, v40, 16, 1
v_add3_u32 v40, v40, v2, s60
v_and_b32 v40, 0xffff0000, v40
v_lshlrev_b32 v41, 16, v70
v_mul_f32 v41, v32, v41
v_bfe_u32 v2, v41, 16, 1
v_add3_u32 v41, v41, v2, s60
v_and_b32 v41, 0xffff0000, v41
v_bfe_u32 v2, v140, 16, 1
v_add3_u32 v140, v140, v2, s60
v_and_b32 v140, 0xffff0000, v140
v_mul_f32 v140, v40, v140
v_bfe_u32 v2, v140, 16, 1
v_add3_u32 v140, v140, v2, s60
v_and_b32 v140, 0xffff0000, v140
v_add_f32 v140, v140, v41
v_bfe_u32 v2, v140, 16, 1
v_add3_u32 v140, v140, v2, s60
v_and_b32 v140, 0xffff0000, v140
buffer_store_short_d16_hi v140, v3, s[12:15], s31 offen offset:0
v_lshlrev_b32 v41, 16, v78
v_mul_f32 v41, v32, v41
v_bfe_u32 v2, v41, 16, 1
v_add3_u32 v41, v41, v2, s60
v_and_b32 v41, 0xffff0000, v41
v_bfe_u32 v2, v156, 16, 1
v_add3_u32 v156, v156, v2, s60
v_and_b32 v156, 0xffff0000, v156
v_mul_f32 v156, v40, v156
v_bfe_u32 v2, v156, 16, 1
v_add3_u32 v156, v156, v2, s60
v_and_b32 v156, 0xffff0000, v156
v_add_f32 v156, v156, v41
v_bfe_u32 v2, v156, 16, 1
v_add3_u32 v156, v156, v2, s60
v_and_b32 v156, 0xffff0000, v156
buffer_store_short_d16_hi v156, v3, s[12:15], s31 offen offset:64
s_mov_b32 s31, 51200
v_sub_f32 v40, 1.0, v33
v_bfe_u32 v2, v40, 16, 1
v_add3_u32 v40, v40, v2, s60
v_and_b32 v40, 0xffff0000, v40
v_and_b32 v41, 0xffff0000, v70
v_mul_f32 v41, v33, v41
v_bfe_u32 v2, v41, 16, 1
v_add3_u32 v41, v41, v2, s60
v_and_b32 v41, 0xffff0000, v41
v_bfe_u32 v2, v141, 16, 1
v_add3_u32 v141, v141, v2, s60
v_and_b32 v141, 0xffff0000, v141
v_mul_f32 v141, v40, v141
v_bfe_u32 v2, v141, 16, 1
v_add3_u32 v141, v141, v2, s60
v_and_b32 v141, 0xffff0000, v141
v_add_f32 v141, v141, v41
v_bfe_u32 v2, v141, 16, 1
v_add3_u32 v141, v141, v2, s60
v_and_b32 v141, 0xffff0000, v141
buffer_store_short_d16_hi v141, v3, s[12:15], s31 offen offset:0
v_and_b32 v41, 0xffff0000, v78
v_mul_f32 v41, v33, v41
v_bfe_u32 v2, v41, 16, 1
v_add3_u32 v41, v41, v2, s60
v_and_b32 v41, 0xffff0000, v41
v_bfe_u32 v2, v157, 16, 1
v_add3_u32 v157, v157, v2, s60
v_and_b32 v157, 0xffff0000, v157
v_mul_f32 v157, v40, v157
v_bfe_u32 v2, v157, 16, 1
v_add3_u32 v157, v157, v2, s60
v_and_b32 v157, 0xffff0000, v157
v_add_f32 v157, v157, v41
v_bfe_u32 v2, v157, 16, 1
v_add3_u32 v157, v157, v2, s60
v_and_b32 v157, 0xffff0000, v157
buffer_store_short_d16_hi v157, v3, s[12:15], s31 offen offset:64
s_mov_b32 s31, 53248
v_sub_f32 v40, 1.0, v34
v_bfe_u32 v2, v40, 16, 1
v_add3_u32 v40, v40, v2, s60
v_and_b32 v40, 0xffff0000, v40
v_lshlrev_b32 v41, 16, v71
v_mul_f32 v41, v34, v41
v_bfe_u32 v2, v41, 16, 1
v_add3_u32 v41, v41, v2, s60
v_and_b32 v41, 0xffff0000, v41
v_bfe_u32 v2, v142, 16, 1
v_add3_u32 v142, v142, v2, s60
v_and_b32 v142, 0xffff0000, v142
v_mul_f32 v142, v40, v142
v_bfe_u32 v2, v142, 16, 1
v_add3_u32 v142, v142, v2, s60
v_and_b32 v142, 0xffff0000, v142
v_add_f32 v142, v142, v41
v_bfe_u32 v2, v142, 16, 1
v_add3_u32 v142, v142, v2, s60
v_and_b32 v142, 0xffff0000, v142
buffer_store_short_d16_hi v142, v3, s[12:15], s31 offen offset:0
v_lshlrev_b32 v41, 16, v79
v_mul_f32 v41, v34, v41
v_bfe_u32 v2, v41, 16, 1
v_add3_u32 v41, v41, v2, s60
v_and_b32 v41, 0xffff0000, v41
v_bfe_u32 v2, v158, 16, 1
v_add3_u32 v158, v158, v2, s60
v_and_b32 v158, 0xffff0000, v158
v_mul_f32 v158, v40, v158
v_bfe_u32 v2, v158, 16, 1
v_add3_u32 v158, v158, v2, s60
v_and_b32 v158, 0xffff0000, v158
v_add_f32 v158, v158, v41
v_bfe_u32 v2, v158, 16, 1
v_add3_u32 v158, v158, v2, s60
v_and_b32 v158, 0xffff0000, v158
buffer_store_short_d16_hi v158, v3, s[12:15], s31 offen offset:64
s_mov_b32 s31, 55296
v_sub_f32 v40, 1.0, v35
v_bfe_u32 v2, v40, 16, 1
v_add3_u32 v40, v40, v2, s60
v_and_b32 v40, 0xffff0000, v40
v_and_b32 v41, 0xffff0000, v71
v_mul_f32 v41, v35, v41
v_bfe_u32 v2, v41, 16, 1
v_add3_u32 v41, v41, v2, s60
v_and_b32 v41, 0xffff0000, v41
v_bfe_u32 v2, v143, 16, 1
v_add3_u32 v143, v143, v2, s60
v_and_b32 v143, 0xffff0000, v143
v_mul_f32 v143, v40, v143
v_bfe_u32 v2, v143, 16, 1
v_add3_u32 v143, v143, v2, s60
v_and_b32 v143, 0xffff0000, v143
v_add_f32 v143, v143, v41
v_bfe_u32 v2, v143, 16, 1
v_add3_u32 v143, v143, v2, s60
v_and_b32 v143, 0xffff0000, v143
buffer_store_short_d16_hi v143, v3, s[12:15], s31 offen offset:0
v_and_b32 v41, 0xffff0000, v79
v_mul_f32 v41, v35, v41
v_bfe_u32 v2, v41, 16, 1
v_add3_u32 v41, v41, v2, s60
v_and_b32 v41, 0xffff0000, v41
v_bfe_u32 v2, v159, 16, 1
v_add3_u32 v159, v159, v2, s60
v_and_b32 v159, 0xffff0000, v159
v_mul_f32 v159, v40, v159
v_bfe_u32 v2, v159, 16, 1
v_add3_u32 v159, v159, v2, s60
v_and_b32 v159, 0xffff0000, v159
v_add_f32 v159, v159, v41
v_bfe_u32 v2, v159, 16, 1
v_add3_u32 v159, v159, v2, s60
v_and_b32 v159, 0xffff0000, v159
buffer_store_short_d16_hi v159, v3, s[12:15], s31 offen offset:64
K3_END:
s_endpgm
.section .rodata,"a"
.p2align 6
.amdhsa_kernel k1_kernel
  .amdhsa_next_free_vgpr 160
  .amdhsa_next_free_sgpr 102
  .amdhsa_accum_offset 160
  .amdhsa_group_segment_fixed_size 0
  .amdhsa_kernarg_size 128
  .amdhsa_user_sgpr_count 2
  .amdhsa_user_sgpr_kernarg_segment_ptr 1
  .amdhsa_system_sgpr_workgroup_id_x 1
.end_amdhsa_kernel
.p2align 6
.amdhsa_kernel k2_kernel
  .amdhsa_next_free_vgpr 96
  .amdhsa_next_free_sgpr 102
  .amdhsa_accum_offset 96
  .amdhsa_group_segment_fixed_size 0
  .amdhsa_kernarg_size 128
  .amdhsa_user_sgpr_count 2
  .amdhsa_user_sgpr_kernarg_segment_ptr 1
  .amdhsa_system_sgpr_workgroup_id_x 1
.end_amdhsa_kernel
.p2align 6
.amdhsa_kernel k3_kernel
  .amdhsa_next_free_vgpr 184
  .amdhsa_next_free_sgpr 102
  .amdhsa_accum_offset 184
  .amdhsa_group_segment_fixed_size 0
  .amdhsa_kernarg_size 128
  .amdhsa_user_sgpr_count 2
  .amdhsa_user_sgpr_kernarg_segment_ptr 1
  .amdhsa_system_sgpr_workgroup_id_x 1
.end_amdhsa_kernel
```
